```python
import torch

def _softmax(x, axis=-1):
    return torch.softmax(x, dim=axis)
def _gelu(x):
    return torch.nn.functional.gelu(x, approximate="tanh")
def _silu(x):
    return torch.nn.functional.silu(x)
def _sigmoid(x):
    return torch.sigmoid(x)
def _layernorm(x, axis=-1, eps=1e-5):
    m = x.mean(dim=axis, keepdim=True)
    v = x.var(dim=axis, keepdim=True, unbiased=False)
    return (x - m) / torch.sqrt(v + eps)
def _scatter_add(tgt, idx, src, axis=0):
    return tgt.clone().index_add_(axis, idx, src)
def _segment_sum(src, seg, n):
    out = torch.zeros((n,) + src.shape[1:], dtype=src.dtype)
    return out.index_add_(0, seg, src)
def _pad(x, pw):
    flat = tuple(v for pair in reversed(pw) for v in pair)
    return torch.nn.functional.pad(x, flat)

kernel_name = 'parallel_sum__linear_attn_block__dense_activation_silu__prompt'

def setup_inputs():

    _w = (lambda a: (lambda t: t.to(torch.bfloat16) if t.is_floating_point() else t)(torch.as_tensor(a)))
    def _A_setup():
        B, S, D = 1, 2048, 512
        return {
            "x": _w((lambda *s: torch.randn(*s, dtype=torch.bfloat16) * 0.05)(B, S, D)),
            "wqkv": _w((lambda *s: torch.randn(*s, dtype=torch.bfloat16) * 0.1)(D, 3 * D)),
            "wo": _w((lambda *s: torch.randn(*s, dtype=torch.bfloat16) * 0.05)(D, D)),
        }
    _A_in = _A_setup()

    def _B_setup():
        B, S, D, F = 1, 2048, 512, 1792
        return {
            "x": _w((lambda *s: torch.randn(*s, dtype=torch.bfloat16) * 0.05)(B, S, D)),
            "w1": _w((lambda *s: torch.randn(*s, dtype=torch.bfloat16) * 0.8)(D, F) * (D ** -0.5)),
            "w2": _w((lambda *s: torch.randn(*s, dtype=torch.bfloat16) * 0.1)(F, D) * (F ** -0.5)),
        }
    _B_in = _B_setup()

    return {
        "A_x": _A_in["x"],
        "A_wqkv": _A_in["wqkv"],
        "A_wo": _A_in["wo"],
        "B_x": _B_in["x"],
        "B_w1": _B_in["w1"],
        "B_w2": _B_in["w2"],
    }

def reference(A_x, A_wqkv, A_wo, B_x, B_w1, B_w2):
    def _A_ref(x, wqkv, wo):
        B, S, D = x.shape
        H = 32; Dh = D // H
        qkv = (lambda x, *d: x.permute(*d))((x @ wqkv).reshape(B, S, 3, H, Dh), 2, 0, 3, 1, 4)
        q, k, v = qkv[0], qkv[1], qkv[2]
        phi = lambda t: torch.where(t > 0, t + 1, torch.exp(t)) + 1e-6
        pq, pk = phi(q), phi(k)
        kv = torch.einsum("bhsd,bhse->bhde", pk, v)
        z = torch.einsum("bhsd->bhd", pk)
        num = torch.einsum("bhqd,bhde->bhqe", pq, kv)
        den = torch.einsum("bhqd,bhd->bhq", pq, z)[..., None] + 1e-6
        o = num / den
        return (lambda x, *d: x.permute(*d))(o, 0, 2, 1, 3).reshape(B, S, D) @ wo

    def _B_ref(x, w1, w2):
        h = torch.einsum("bsd,df->bsf", x, w1)
        h = _silu(h)
        out = torch.einsum("bsf,fd->bsd", h, w2)
        return out

    x = A_x
    xn = _layernorm(x, axis=-1)
    return x + _A_ref(xn, A_wqkv, A_wo) + _B_ref(xn, B_w1, B_w2)
```

```asm
; @launch grid=(256,1,1) block=(512,1,1) lds=163840
.amdgcn_target "amdgcn-amd-amdhsa--gfx950"
.text
.p2align 10
.fill 64, 4, 0xbf800000
.globl parallel_sum__linear_attn_block__dense_activation_silu__prompt_kernel
.p2align 8
.type parallel_sum__linear_attn_block__dense_activation_silu__prompt_kernel,@function
parallel_sum__linear_attn_block__dense_activation_silu__prompt_kernel:
    s_load_dwordx16 s[4:19], s[0:1], 0
    s_load_dwordx2 s[20:21], s[0:1], 64
    s_cmp_ge_u32 s2, 256
    s_cbranch_scc1 K_END
    s_getpc_b64 s[24:25]
    v_lshrrev_b32 v3, 5, v0
    s_lshr_b32 s51, s2, 3
    v_lshlrev_b32_e64 v2, 7, v3
    v_lshl_add_u32 v2, s51, 11, v2
    v_min_u32 v2, CODE_BYTES-256, v2
    global_load_dword v47, v2, s[24:25]
    v_lshrrev_b32_e64 v3, 6, v0
    v_and_b32 v0, 63, v0
    v_readfirstlane_b32 s48, v3
    s_bfe_u32 s49, s2, 131072
    s_and_b32 s55, s51, 3
    s_lshl2_add_u32 s22, s49, s55
    s_lshr_b32 s54, s51, 3
    s_add_u32 s49, s49, s54
    s_cmp_eq_u32 s55, 0
    s_cselect_b32 s75, 1, 0
    s_and_b32 s3, s48, 3
    v_lshrrev_b32 v1, 3, v0
    v_and_b32 v2, 7, v0
    v_lshrrev_b32 v4, 4, v0
    s_cmp_ge_u32 s48, 4
    s_cbranch_scc1 G2_START
    v_and_b32 v5, 15, v0
    v_xor_b32 v5, v5, v4
    v_lshlrev_b32_e64 v5, 4, v5
    v_lshl_add_u32 v64, v4, 10, v5
    v_xor_b32_e64 v65, 64, v64
    v_xor_b32 v66, 0x80, v64
    v_xor_b32 v67, 0xc0, v64
    v_add_u32 v65, 3072, v65
    v_add_u32 v66, 6144, v66
    v_add_u32 v67, 9216, v67
    s_lshl2_add_u32 s54, s22, s3
    s_bfe_u32 s68, s51, 0x10002
    s_lshl1_add_u32 s56, s54, s68
    s_lshl_b32 s56, s56, 14
    s_lshl_b32 s57, s3, 14
    s_add_u32 s58, s49, s75
    s_and_b32 s58, s58, 3
    s_lshl_b32 s58, s58, 8
    s_mov_b32 s26, 2097152
    s_mov_b32 s27, 0x20000
    s_mov_b32 m0, s57
    s_add_u32 s55, s56, s58
    s_waitcnt lgkmcnt(0)
    s_mov_b64 s[24:25], s[4:5]
    buffer_load_dwordx4 v64, s[24:27], s55 offen offset:0 lds
    buffer_load_dwordx4 v65, s[24:27], s55 offen offset:1024 lds
    buffer_load_dwordx4 v66, s[24:27], s55 offen offset:2048 lds
    buffer_load_dwordx4 v67, s[24:27], s55 offen offset:3072 lds
    s_lshr_b32 s23, s51, 2
    s_lshr_b32 s48, s23, 2
    s_and_b32 s23, s23, 3
    s_bfe_u32 s55, s2, 65538
    s_lshl2_add_u32 s23, s55, s23
    s_and_b32 s55, s51, 3
    s_mov_b32 s75, 12801
    s_cmp_eq_u32 s55, 1
    s_cselect_b32 s75, 12576, s75
    s_cmp_eq_u32 s55, 2
    s_cselect_b32 s75, 8976, s75
    s_cmp_eq_u32 s55, 3
    s_cselect_b32 s75, 12816, s75
    s_lshr_b32 s58, s75, 4
    s_add_u32 s58, s58, s49
    s_and_b32 s58, s58, 3
    s_lshl_b32 s58, s58, 8
    s_add_u32 m0, s57, 4096
    s_add_u32 s55, s56, s58
    buffer_load_dwordx4 v64, s[24:27], s55 offen offset:0 lds
    buffer_load_dwordx4 v65, s[24:27], s55 offen offset:1024 lds
    buffer_load_dwordx4 v66, s[24:27], s55 offen offset:2048 lds
    buffer_load_dwordx4 v67, s[24:27], s55 offen offset:3072 lds
    s_setprio 1
    s_add_u32 s44, s20, 10125440
    s_addc_u32 s45, s21, 0
    s_or_b32 s46, s2, s3
    s_cbranch_scc1 G1_NOEP
    s_load_dword s52, s[44:45], 0 glc
G1_NOEP:
    s_mov_b64 s[32:33], s[20:21]
    s_mov_b32 s34, 10125568
    s_mov_b32 s35, 0x20000
    s_mov_b32 s0, 4194304
    s_add_u32 s67, s57, 81920
    s_mul_i32 s59, s54, 147456
    s_lshr_b32 s55, s54, 1
    s_lshr_b32 s1, s23, 1
    s_lshl2_add_u32 s55, s55, s1
    s_lshl_b32 s55, s55, 7
    s_and_b32 s54, s54, 1
    s_and_b32 s1, s23, 1
    s_lshl1_add_u32 s54, s1, s54
    s_lshl2_add_u32 s54, s54, s55
    s_add_u32 s54, s54, 9994240
    s_add_u32 s70, s20, s54
    s_addc_u32 s71, s21, 0
    v_and_b32 v6, 15, v0
    v_mov_b32 v7, v4
    v_xor_b32 v8, v6, v7
    v_lshlrev_b32_e64 v8, 4, v8
    v_lshl_add_u32 v8, v6, 8, v8
    v_add_u32 v68, s57, v8
    v_xor_b32 v69, 64, v68
    v_xor_b32 v70, 128, v68
    v_xor_b32 v71, 192, v68
    v_add_u32 v72, 81920, v68
    v_add_u32 v73, 81920, v69
    v_add_u32 v74, 81920, v70
    v_add_u32 v75, 81920, v71
    v_bfe_u32 v8, v0, 2, 2
    v_lshl_add_u32 v9, v7, 3, v8
    v_and_b32_e64 v11, 3, v0
    v_bfe_u32 v10, v0, 3, 2
    v_lshlrev_b32_e64 v10, 5, v10
    v_lshl_add_u32 v10, v11, 3, v10
    v_lshl_add_u32 v2, v9, 7, v10
    v_add_u32 v2, 65536, v2
    v_xor_b32 v3, 32, v2
    v_xor_b32 v4, 64, v2
    v_xor_b32 v5, 0x60, v2
    v_lshlrev_b32_e64 v1, 4, v0
    v_lshl_add_u32 v1, s68, 10, v1
    v_xor_b32 v6, 0x400, v1
    s_mov_b32 s64, 0x3f803f80
    s_mov_b32 s65, 0xffff0000
    s_cmp_eq_u32 s48, 0
    s_movk_i32 s1, 3072
    s_cselect_b32 s50, s1, 3584
    s_cselect_b64 s[36:37], s[6:7], s[12:13]
    s_cselect_b32 s38, 10, 7
    s_cselect_b32 s39, 2, 3
    s_movk_i32 s1, 128
    s_cselect_b32 s1, s1, 448
    s_mul_i32 s1, s1, s23
    s_lshr_b32 s54, s51, 3
    s_lshl2_add_u32 s54, s54, s22
    s_lshl2_add_u32 s54, s54, s3
    s_and_b32 s54, s54, 63
    s_lshl_b32 s54, s54, 3
    v_and_b32 v8, 7, v0
    v_add_u32 v8, s54, v8
    v_mul_u32_u24_e64 v8, s50, v8
    v_bfe_u32 v9, v0, 3, 2
    v_min_u32 v9, s39, v9
    v_lshlrev_b32 v9, s38, v9
    v_add3_u32 v8, v8, v9, s1
    v_mov_b32 v81, s37
    v_add_co_u32 v80, vcc, s36, v8
    s_nop 1
    v_addc_co_u32 v81, vcc, 0, v81, vcc
    s_lshl2_add_u32 s54, s2, s3
    s_mul_i32 s55, s54, 14
    v_and_b32 v8, 15, v0
    v_min_u32 v8, 13, v8
    v_add_lshl_u32 v8, v8, s55, 7
    v_mov_b32_e64 v83, s15
    v_add_co_u32 v82, vcc, s14, v8
    s_nop 1
    v_addc_co_u32 v83, vcc, 0, v83, vcc
    v_cmp_gt_u32 vcc, 32, v0
    s_nop 1
    v_cndmask_b32 v80, v82, v80, vcc
    v_cndmask_b32 v81, v83, v81, vcc
    s_lshl_b32 s55, s54, 2
    v_add_lshl_u32 v8, v11, s55, 7
    v_mov_b32 v83, s9
    v_add_co_u32 v82, vcc, s8, v8
    s_nop 1
    v_addc_co_u32 v83, vcc, 0, v83, vcc
    v_cmp_gt_u32 vcc, 48, v0
    s_nop 1
    v_cndmask_b32 v80, v82, v80, vcc
    v_cndmask_b32 v81, v83, v81, vcc
    s_lshr_b32 s58, s75, 8
    s_add_u32 s58, s58, s49
    s_and_b32 s58, s58, 3
    s_lshl_b32 s58, s58, 8
    s_add_u32 m0, s57, 8192
    s_add_u32 s55, s56, s58
    buffer_load_dwordx4 v64, s[24:27], s55 offen offset:0 lds
    buffer_load_dwordx4 v65, s[24:27], s55 offen offset:1024 lds
    buffer_load_dwordx4 v66, s[24:27], s55 offen offset:2048 lds
    buffer_load_dwordx4 v67, s[24:27], s55 offen offset:3072 lds
    s_cmp_eq_u32 s48, 0
    s_mov_b32 s66, 0x3fb8aa3b
    s_cselect_b32 s66, s66, 0xbfb8aa3b
    s_waitcnt vmcnt(8)
    ds_read_b128 v[128:131], v68 offset:0
    ds_read_b128 v[132:135], v69 offset:0
    ds_read_b128 v[136:139], v70 offset:0
    ds_read_b128 v[140:143], v71 offset:0
    s_lshr_b32 s58, s75, 12
    s_add_u32 s58, s58, s49
    s_and_b32 s58, s58, 3
    s_lshl_b32 s58, s58, 8
    s_add_u32 m0, s57, 12288
    s_add_u32 s55, s56, s58
    buffer_load_dwordx4 v64, s[24:27], s55 offen offset:0 lds
    buffer_load_dwordx4 v65, s[24:27], s55 offen offset:1024 lds
    buffer_load_dwordx4 v66, s[24:27], s55 offen offset:2048 lds
    buffer_load_dwordx4 v67, s[24:27], s55 offen offset:3072 lds
    s_waitcnt lgkmcnt(3)
    v_dot2_f32_bf16 v76, v128, s64, 0
    v_dot2_f32_bf16 v78, v128, v128, 0
    v_dot2_f32_bf16 v77, v129, s64, 0
    v_dot2_f32_bf16 v79, v129, v129, 0
    v_dot2_f32_bf16 v76, v130, s64, v76
    v_dot2_f32_bf16 v78, v130, v130, v78
    v_dot2_f32_bf16 v77, v131, s64, v77
    v_dot2_f32_bf16 v79, v131, v131, v79
    s_waitcnt lgkmcnt(2)
    v_dot2_f32_bf16 v76, v132, s64, v76
    v_dot2_f32_bf16 v78, v132, v132, v78
    v_dot2_f32_bf16 v77, v133, s64, v77
    v_dot2_f32_bf16 v79, v133, v133, v79
    v_dot2_f32_bf16 v76, v134, s64, v76
    v_dot2_f32_bf16 v78, v134, v134, v78
    v_dot2_f32_bf16 v77, v135, s64, v77
    v_dot2_f32_bf16 v79, v135, v135, v79
    s_waitcnt lgkmcnt(1)
    v_dot2_f32_bf16 v76, v136, s64, v76
    v_dot2_f32_bf16 v78, v136, v136, v78
    v_dot2_f32_bf16 v77, v137, s64, v77
    v_dot2_f32_bf16 v79, v137, v137, v79
    v_dot2_f32_bf16 v76, v138, s64, v76
    v_dot2_f32_bf16 v78, v138, v138, v78
    v_dot2_f32_bf16 v77, v139, s64, v77
    v_dot2_f32_bf16 v79, v139, v139, v79
    s_waitcnt lgkmcnt(0)
    v_dot2_f32_bf16 v76, v140, s64, v76
    v_dot2_f32_bf16 v78, v140, v140, v78
    v_dot2_f32_bf16 v77, v141, s64, v77
    v_dot2_f32_bf16 v79, v141, v141, v79
    v_dot2_f32_bf16 v76, v142, s64, v76
    v_dot2_f32_bf16 v78, v142, v142, v78
    v_dot2_f32_bf16 v77, v143, s64, v77
    v_dot2_f32_bf16 v79, v143, v143, v79
    s_waitcnt vmcnt(8)
    ds_read_b128 v[144:147], v68 offset:4096
    ds_read_b128 v[148:151], v69 offset:4096
    ds_read_b128 v[152:155], v70 offset:4096
    ds_read_b128 v[156:159], v71 offset:4096
    s_xor_b32 s56, s56, 16384
    s_lshr_b32 s58, s75, 0
    s_add_u32 s58, s58, s49
    s_and_b32 s58, s58, 3
    s_lshl_b32 s58, s58, 8
    s_add_u32 m0, s67, 0
    s_add_u32 s55, s56, s58
    buffer_load_dwordx4 v64, s[24:27], s55 offen offset:0 lds
    buffer_load_dwordx4 v65, s[24:27], s55 offen offset:1024 lds
    buffer_load_dwordx4 v66, s[24:27], s55 offen offset:2048 lds
    buffer_load_dwordx4 v67, s[24:27], s55 offen offset:3072 lds
    s_cmp_lg_u32 s46, 0
    s_cbranch_scc1 G1_NONONCE
    s_mov_b32 s53, 1
    s_waitcnt lgkmcnt(0)
    s_mul_i32 s52, s52, 1664525
    s_add_u32 s52, s52, 1013904223
    s_atomic_swap_x2 s[52:53], s[18:19], 0
    s_atomic_swap s52, s[44:45], 0
G1_NONONCE:
    s_waitcnt lgkmcnt(3)
    v_dot2_f32_bf16 v76, v144, s64, v76
    v_dot2_f32_bf16 v78, v144, v144, v78
    v_dot2_f32_bf16 v77, v145, s64, v77
    v_dot2_f32_bf16 v79, v145, v145, v79
    v_dot2_f32_bf16 v76, v146, s64, v76
    v_dot2_f32_bf16 v78, v146, v146, v78
    v_dot2_f32_bf16 v77, v147, s64, v77
    v_dot2_f32_bf16 v79, v147, v147, v79
    s_waitcnt lgkmcnt(2)
    v_dot2_f32_bf16 v76, v148, s64, v76
    v_dot2_f32_bf16 v78, v148, v148, v78
    v_dot2_f32_bf16 v77, v149, s64, v77
    v_dot2_f32_bf16 v79, v149, v149, v79
    v_dot2_f32_bf16 v76, v150, s64, v76
    v_dot2_f32_bf16 v78, v150, v150, v78
    v_dot2_f32_bf16 v77, v151, s64, v77
    v_dot2_f32_bf16 v79, v151, v151, v79
    s_waitcnt lgkmcnt(1)
    v_dot2_f32_bf16 v76, v152, s64, v76
    v_dot2_f32_bf16 v78, v152, v152, v78
    v_dot2_f32_bf16 v77, v153, s64, v77
    v_dot2_f32_bf16 v79, v153, v153, v79
    v_dot2_f32_bf16 v76, v154, s64, v76
    v_dot2_f32_bf16 v78, v154, v154, v78
    v_dot2_f32_bf16 v77, v155, s64, v77
    v_dot2_f32_bf16 v79, v155, v155, v79
    s_waitcnt lgkmcnt(0)
    v_dot2_f32_bf16 v76, v156, s64, v76
    v_dot2_f32_bf16 v78, v156, v156, v78
    v_dot2_f32_bf16 v77, v157, s64, v77
    v_dot2_f32_bf16 v79, v157, v157, v79
    v_dot2_f32_bf16 v76, v158, s64, v76
    v_dot2_f32_bf16 v78, v158, v158, v78
    v_dot2_f32_bf16 v77, v159, s64, v77
    v_dot2_f32_bf16 v79, v159, v159, v79
    s_waitcnt vmcnt(8)
    ds_read_b128 v[160:163], v68 offset:8192
    ds_read_b128 v[164:167], v69 offset:8192
    ds_read_b128 v[168:171], v70 offset:8192
    ds_read_b128 v[172:175], v71 offset:8192
    s_lshr_b32 s58, s75, 4
    s_add_u32 s58, s58, s49
    s_and_b32 s58, s58, 3
    s_lshl_b32 s58, s58, 8
    s_add_u32 m0, s67, 4096
    s_add_u32 s55, s56, s58
    buffer_load_dwordx4 v64, s[24:27], s55 offen offset:0 lds
    buffer_load_dwordx4 v65, s[24:27], s55 offen offset:1024 lds
    buffer_load_dwordx4 v66, s[24:27], s55 offen offset:2048 lds
    buffer_load_dwordx4 v67, s[24:27], s55 offen offset:3072 lds
    s_waitcnt lgkmcnt(3)
    v_dot2_f32_bf16 v76, v160, s64, v76
    v_dot2_f32_bf16 v78, v160, v160, v78
    v_dot2_f32_bf16 v77, v161, s64, v77
    v_dot2_f32_bf16 v79, v161, v161, v79
    v_dot2_f32_bf16 v76, v162, s64, v76
    v_dot2_f32_bf16 v78, v162, v162, v78
    v_dot2_f32_bf16 v77, v163, s64, v77
    v_dot2_f32_bf16 v79, v163, v163, v79
    s_waitcnt lgkmcnt(2)
    v_dot2_f32_bf16 v76, v164, s64, v76
    v_dot2_f32_bf16 v78, v164, v164, v78
    v_dot2_f32_bf16 v77, v165, s64, v77
    v_dot2_f32_bf16 v79, v165, v165, v79
    v_dot2_f32_bf16 v76, v166, s64, v76
    v_dot2_f32_bf16 v78, v166, v166, v78
    v_dot2_f32_bf16 v77, v167, s64, v77
    v_dot2_f32_bf16 v79, v167, v167, v79
    s_waitcnt lgkmcnt(1)
    v_dot2_f32_bf16 v76, v168, s64, v76
    v_dot2_f32_bf16 v78, v168, v168, v78
    v_dot2_f32_bf16 v77, v169, s64, v77
    v_dot2_f32_bf16 v79, v169, v169, v79
    v_dot2_f32_bf16 v76, v170, s64, v76
    v_dot2_f32_bf16 v78, v170, v170, v78
    v_dot2_f32_bf16 v77, v171, s64, v77
    v_dot2_f32_bf16 v79, v171, v171, v79
    s_waitcnt lgkmcnt(0)
    v_dot2_f32_bf16 v76, v172, s64, v76
    v_dot2_f32_bf16 v78, v172, v172, v78
    v_dot2_f32_bf16 v77, v173, s64, v77
    v_dot2_f32_bf16 v79, v173, v173, v79
    v_dot2_f32_bf16 v76, v174, s64, v76
    v_dot2_f32_bf16 v78, v174, v174, v78
    v_dot2_f32_bf16 v77, v175, s64, v77
    v_dot2_f32_bf16 v79, v175, v175, v79
    s_waitcnt vmcnt(8)
    ds_read_b128 v[176:179], v68 offset:12288
    ds_read_b128 v[180:183], v69 offset:12288
    ds_read_b128 v[184:187], v70 offset:12288
    ds_read_b128 v[188:191], v71 offset:12288
    s_lshr_b32 s58, s75, 8
    s_add_u32 s58, s58, s49
    s_and_b32 s58, s58, 3
    s_lshl_b32 s58, s58, 8
    s_add_u32 m0, s67, 8192
    s_add_u32 s55, s56, s58
    buffer_load_dwordx4 v64, s[24:27], s55 offen offset:0 lds
    buffer_load_dwordx4 v65, s[24:27], s55 offen offset:1024 lds
    buffer_load_dwordx4 v66, s[24:27], s55 offen offset:2048 lds
    buffer_load_dwordx4 v67, s[24:27], s55 offen offset:3072 lds
    s_waitcnt lgkmcnt(3)
    v_dot2_f32_bf16 v76, v176, s64, v76
    v_dot2_f32_bf16 v78, v176, v176, v78
    v_dot2_f32_bf16 v77, v177, s64, v77
    v_dot2_f32_bf16 v79, v177, v177, v79
    v_dot2_f32_bf16 v76, v178, s64, v76
    v_dot2_f32_bf16 v78, v178, v178, v78
    v_dot2_f32_bf16 v77, v179, s64, v77
    v_dot2_f32_bf16 v79, v179, v179, v79
    s_waitcnt lgkmcnt(2)
    v_dot2_f32_bf16 v76, v180, s64, v76
    v_dot2_f32_bf16 v78, v180, v180, v78
    v_dot2_f32_bf16 v77, v181, s64, v77
    v_dot2_f32_bf16 v79, v181, v181, v79
    v_dot2_f32_bf16 v76, v182, s64, v76
    v_dot2_f32_bf16 v78, v182, v182, v78
    v_dot2_f32_bf16 v77, v183, s64, v77
    v_dot2_f32_bf16 v79, v183, v183, v79
    s_waitcnt lgkmcnt(1)
    v_dot2_f32_bf16 v76, v184, s64, v76
    v_dot2_f32_bf16 v78, v184, v184, v78
    v_dot2_f32_bf16 v77, v185, s64, v77
    v_dot2_f32_bf16 v79, v185, v185, v79
    v_dot2_f32_bf16 v76, v186, s64, v76
    v_dot2_f32_bf16 v78, v186, v186, v78
    v_dot2_f32_bf16 v77, v187, s64, v77
    v_dot2_f32_bf16 v79, v187, v187, v79
    s_waitcnt lgkmcnt(0)
    v_dot2_f32_bf16 v76, v188, s64, v76
    v_dot2_f32_bf16 v78, v188, v188, v78
    v_dot2_f32_bf16 v77, v189, s64, v77
    v_dot2_f32_bf16 v79, v189, v189, v79
    v_dot2_f32_bf16 v76, v190, s64, v76
    v_dot2_f32_bf16 v78, v190, v190, v78
    v_dot2_f32_bf16 v77, v191, s64, v77
    v_dot2_f32_bf16 v79, v191, v191, v79
    s_nop 1
    v_add_f32 v10, v76, v77
    v_add_f32 v8, v78, v79
    s_nop 1
    v_permlane32_swap_b32 v10, v8
    v_add_f32 v10, v10, v8
    v_mov_b32 v8, v10
    s_nop 1
    v_permlane16_swap_b32 v10, v8
    v_add_f32_e64 v10, v10, v8
    v_mul_f32 v10, 0x3b000000, v10
    v_mov_b32_e64 v8, v10
    s_nop 1
    v_permlane32_swap_b32 v10, v8
    v_fma_f32 v8, -v10, v10, v8
    v_max_f32_e64 v8, 0, v8
    v_add_f32 v8, 0x3727c5ac, v8
    v_rsq_f32 v8, v8
    s_nop 0
    v_mul_f32_e64 v8, s66, v8
    v_mul_f32 v10, -v10, v8
    v_mov_b32 v9, v8
    v_mov_b32 v11, v10
    s_lshr_b32 s58, s75, 12
    s_add_u32 s58, s58, s49
    s_and_b32 s58, s58, 3
    s_lshl_b32 s58, s58, 8
    s_add_u32 m0, s67, 12288
    s_add_u32 s55, s56, s58
    buffer_load_dwordx4 v64, s[24:27], s55 offen offset:0 lds
    buffer_load_dwordx4 v65, s[24:27], s55 offen offset:1024 lds
    buffer_load_dwordx4 v66, s[24:27], s55 offen offset:2048 lds
    buffer_load_dwordx4 v67, s[24:27], s55 offen offset:3072 lds
    s_waitcnt vmcnt(12)
    ds_read_b128 v[192:195], v72 offset:0
    ds_read_b128 v[196:199], v73 offset:0
    ds_read_b128 v[200:203], v74 offset:0
    ds_read_b128 v[204:207], v75 offset:0
    v_lshlrev_b32 v12, 16, v128
    v_and_b32 v13, s65, v128
    v_lshlrev_b32 v14, 16, v129
    v_and_b32 v15, s65, v129
    v_lshlrev_b32 v16, 16, v130
    v_and_b32 v17, s65, v130
    v_lshlrev_b32 v18, 16, v131
    v_and_b32 v19, s65, v131
    v_pk_fma_f32 v[12:13], v[12:13], v[8:9], v[10:11]
    v_pk_fma_f32 v[14:15], v[14:15], v[8:9], v[10:11]
    v_pk_fma_f32 v[16:17], v[16:17], v[8:9], v[10:11]
    v_pk_fma_f32 v[18:19], v[18:19], v[8:9], v[10:11]
    v_cvt_pk_bf16_f32 v128, v12, v13
    v_cvt_pk_bf16_f32 v129, v14, v15
    v_cvt_pk_bf16_f32 v130, v16, v17
    v_cvt_pk_bf16_f32 v131, v18, v19
    v_lshlrev_b32 v12, 16, v132
    v_and_b32 v13, s65, v132
    v_lshlrev_b32 v14, 16, v133
    v_and_b32 v15, s65, v133
    v_lshlrev_b32 v16, 16, v134
    v_and_b32 v17, s65, v134
    v_lshlrev_b32 v18, 16, v135
    v_and_b32 v19, s65, v135
    v_pk_fma_f32 v[12:13], v[12:13], v[8:9], v[10:11]
    v_pk_fma_f32 v[14:15], v[14:15], v[8:9], v[10:11]
    v_pk_fma_f32 v[16:17], v[16:17], v[8:9], v[10:11]
    v_pk_fma_f32 v[18:19], v[18:19], v[8:9], v[10:11]
    v_cvt_pk_bf16_f32 v132, v12, v13
    v_cvt_pk_bf16_f32 v133, v14, v15
    v_cvt_pk_bf16_f32 v134, v16, v17
    v_cvt_pk_bf16_f32 v135, v18, v19
    v_lshlrev_b32 v12, 16, v136
    v_and_b32 v13, s65, v136
    v_lshlrev_b32 v14, 16, v137
    v_and_b32 v15, s65, v137
    v_lshlrev_b32 v16, 16, v138
    v_and_b32 v17, s65, v138
    v_lshlrev_b32 v18, 16, v139
    v_and_b32 v19, s65, v139
    v_pk_fma_f32 v[12:13], v[12:13], v[8:9], v[10:11]
    v_pk_fma_f32 v[14:15], v[14:15], v[8:9], v[10:11]
    v_pk_fma_f32 v[16:17], v[16:17], v[8:9], v[10:11]
    v_pk_fma_f32 v[18:19], v[18:19], v[8:9], v[10:11]
    v_cvt_pk_bf16_f32 v136, v12, v13
    v_cvt_pk_bf16_f32 v137, v14, v15
    v_cvt_pk_bf16_f32 v138, v16, v17
    v_cvt_pk_bf16_f32 v139, v18, v19
    v_lshlrev_b32 v12, 16, v140
    v_and_b32 v13, s65, v140
    v_lshlrev_b32 v14, 16, v141
    v_and_b32 v15, s65, v141
    v_lshlrev_b32 v16, 16, v142
    v_and_b32 v17, s65, v142
    v_lshlrev_b32 v18, 16, v143
    v_and_b32 v19, s65, v143
    v_pk_fma_f32 v[12:13], v[12:13], v[8:9], v[10:11]
    v_pk_fma_f32 v[14:15], v[14:15], v[8:9], v[10:11]
    v_pk_fma_f32 v[16:17], v[16:17], v[8:9], v[10:11]
    v_pk_fma_f32 v[18:19], v[18:19], v[8:9], v[10:11]
    v_cvt_pk_bf16_f32 v140, v12, v13
    v_cvt_pk_bf16_f32 v141, v14, v15
    v_cvt_pk_bf16_f32 v142, v16, v17
    v_cvt_pk_bf16_f32 v143, v18, v19
    s_waitcnt vmcnt(8)
    ds_read_b128 v[208:211], v72 offset:4096
    ds_read_b128 v[212:215], v73 offset:4096
    ds_read_b128 v[216:219], v74 offset:4096
    ds_read_b128 v[220:223], v75 offset:4096
    global_load_dword v23, v[80:81], off
    v_lshlrev_b32 v12, 16, v144
    v_and_b32 v13, s65, v144
    v_lshlrev_b32 v14, 16, v145
    v_and_b32 v15, s65, v145
    v_lshlrev_b32 v16, 16, v146
    v_and_b32 v17, s65, v146
    v_lshlrev_b32 v18, 16, v147
    v_and_b32_e64 v19, s65, v147
    v_pk_fma_f32 v[12:13], v[12:13], v[8:9], v[10:11]
    v_pk_fma_f32 v[14:15], v[14:15], v[8:9], v[10:11]
    v_pk_fma_f32 v[16:17], v[16:17], v[8:9], v[10:11]
    v_pk_fma_f32 v[18:19], v[18:19], v[8:9], v[10:11]
    v_cvt_pk_bf16_f32 v144, v12, v13
    v_cvt_pk_bf16_f32 v145, v14, v15
    v_cvt_pk_bf16_f32 v146, v16, v17
    v_cvt_pk_bf16_f32 v147, v18, v19
    v_lshlrev_b32 v12, 16, v148
    v_and_b32 v13, s65, v148
    v_lshlrev_b32 v14, 16, v149
    v_and_b32 v15, s65, v149
    v_lshlrev_b32 v16, 16, v150
    v_and_b32 v17, s65, v150
    v_lshlrev_b32 v18, 16, v151
    v_and_b32 v19, s65, v151
    v_pk_fma_f32 v[12:13], v[12:13], v[8:9], v[10:11]
    v_pk_fma_f32 v[14:15], v[14:15], v[8:9], v[10:11]
    v_pk_fma_f32 v[16:17], v[16:17], v[8:9], v[10:11]
    v_pk_fma_f32 v[18:19], v[18:19], v[8:9], v[10:11]
    v_cvt_pk_bf16_f32 v148, v12, v13
    v_cvt_pk_bf16_f32 v149, v14, v15
    v_cvt_pk_bf16_f32 v150, v16, v17
    v_cvt_pk_bf16_f32 v151, v18, v19
    v_lshlrev_b32 v12, 16, v152
    v_and_b32 v13, s65, v152
    v_lshlrev_b32 v14, 16, v153
    v_and_b32 v15, s65, v153
    v_lshlrev_b32 v16, 16, v154
    v_and_b32 v17, s65, v154
    v_lshlrev_b32 v18, 16, v155
    v_and_b32 v19, s65, v155
    v_pk_fma_f32 v[12:13], v[12:13], v[8:9], v[10:11]
    v_pk_fma_f32 v[14:15], v[14:15], v[8:9], v[10:11]
    v_pk_fma_f32 v[16:17], v[16:17], v[8:9], v[10:11]
    v_pk_fma_f32 v[18:19], v[18:19], v[8:9], v[10:11]
    v_cvt_pk_bf16_f32 v152, v12, v13
    v_cvt_pk_bf16_f32 v153, v14, v15
    v_cvt_pk_bf16_f32 v154, v16, v17
    v_cvt_pk_bf16_f32 v155, v18, v19
    v_lshlrev_b32 v12, 16, v156
    v_and_b32 v13, s65, v156
    v_lshlrev_b32 v14, 16, v157
    v_and_b32 v15, s65, v157
    v_lshlrev_b32 v16, 16, v158
    v_and_b32 v17, s65, v158
    v_lshlrev_b32 v18, 16, v159
    v_and_b32 v19, s65, v159
    v_pk_fma_f32 v[12:13], v[12:13], v[8:9], v[10:11]
    v_pk_fma_f32 v[14:15], v[14:15], v[8:9], v[10:11]
    v_pk_fma_f32 v[16:17], v[16:17], v[8:9], v[10:11]
    v_pk_fma_f32 v[18:19], v[18:19], v[8:9], v[10:11]
    v_cvt_pk_bf16_f32 v156, v12, v13
    v_cvt_pk_bf16_f32 v157, v14, v15
    v_cvt_pk_bf16_f32 v158, v16, v17
    v_cvt_pk_bf16_f32 v159, v18, v19
    s_waitcnt vmcnt(5)
    ds_read_b128 v[224:227], v72 offset:8192
    ds_read_b128 v[228:231], v73 offset:8192
    ds_read_b128 v[232:235], v74 offset:8192
    ds_read_b128 v[236:239], v75 offset:8192
    v_lshlrev_b32 v12, 16, v160
    v_and_b32 v13, s65, v160
    v_lshlrev_b32 v14, 16, v161
    v_and_b32 v15, s65, v161
    v_lshlrev_b32 v16, 16, v162
    v_and_b32 v17, s65, v162
    v_lshlrev_b32 v18, 16, v163
    v_and_b32_e64 v19, s65, v163
    v_pk_fma_f32 v[12:13], v[12:13], v[8:9], v[10:11]
    v_pk_fma_f32 v[14:15], v[14:15], v[8:9], v[10:11]
    v_pk_fma_f32 v[16:17], v[16:17], v[8:9], v[10:11]
    v_pk_fma_f32 v[18:19], v[18:19], v[8:9], v[10:11]
    v_cvt_pk_bf16_f32 v160, v12, v13
    v_cvt_pk_bf16_f32 v161, v14, v15
    v_cvt_pk_bf16_f32 v162, v16, v17
    v_cvt_pk_bf16_f32 v163, v18, v19
    v_lshlrev_b32 v12, 16, v164
    v_and_b32 v13, s65, v164
    v_lshlrev_b32 v14, 16, v165
    v_and_b32 v15, s65, v165
    v_lshlrev_b32 v16, 16, v166
    v_and_b32 v17, s65, v166
    v_lshlrev_b32 v18, 16, v167
    v_and_b32 v19, s65, v167
    v_pk_fma_f32 v[12:13], v[12:13], v[8:9], v[10:11]
    v_pk_fma_f32 v[14:15], v[14:15], v[8:9], v[10:11]
    v_pk_fma_f32 v[16:17], v[16:17], v[8:9], v[10:11]
    v_pk_fma_f32 v[18:19], v[18:19], v[8:9], v[10:11]
    v_cvt_pk_bf16_f32 v164, v12, v13
    v_cvt_pk_bf16_f32 v165, v14, v15
    v_cvt_pk_bf16_f32 v166, v16, v17
    v_cvt_pk_bf16_f32 v167, v18, v19
    v_lshlrev_b32 v12, 16, v168
    v_and_b32 v13, s65, v168
    v_lshlrev_b32 v14, 16, v169
    v_and_b32 v15, s65, v169
    v_lshlrev_b32 v16, 16, v170
    v_and_b32 v17, s65, v170
    v_lshlrev_b32 v18, 16, v171
    v_and_b32 v19, s65, v171
    v_pk_fma_f32 v[12:13], v[12:13], v[8:9], v[10:11]
    v_pk_fma_f32 v[14:15], v[14:15], v[8:9], v[10:11]
    v_pk_fma_f32 v[16:17], v[16:17], v[8:9], v[10:11]
    v_pk_fma_f32 v[18:19], v[18:19], v[8:9], v[10:11]
    v_cvt_pk_bf16_f32 v168, v12, v13
    v_cvt_pk_bf16_f32 v169, v14, v15
    v_cvt_pk_bf16_f32 v170, v16, v17
    v_cvt_pk_bf16_f32 v171, v18, v19
    v_lshlrev_b32 v12, 16, v172
    v_and_b32 v13, s65, v172
    v_lshlrev_b32 v14, 16, v173
    v_and_b32 v15, s65, v173
    v_lshlrev_b32 v16, 16, v174
    v_and_b32 v17, s65, v174
    v_lshlrev_b32 v18, 16, v175
    v_and_b32 v19, s65, v175
    v_pk_fma_f32 v[12:13], v[12:13], v[8:9], v[10:11]
    v_pk_fma_f32 v[14:15], v[14:15], v[8:9], v[10:11]
    v_pk_fma_f32 v[16:17], v[16:17], v[8:9], v[10:11]
    v_pk_fma_f32 v[18:19], v[18:19], v[8:9], v[10:11]
    v_cvt_pk_bf16_f32 v172, v12, v13
    v_cvt_pk_bf16_f32 v173, v14, v15
    v_cvt_pk_bf16_f32 v174, v16, v17
    v_cvt_pk_bf16_f32 v175, v18, v19
    s_waitcnt vmcnt(1)
    ds_read_b128 v[240:243], v72 offset:12288
    ds_read_b128 v[244:247], v73 offset:12288
    ds_read_b128 v[248:251], v74 offset:12288
    ds_read_b128 v[252:255], v75 offset:12288
    s_waitcnt lgkmcnt(0)
    s_barrier
    v_lshlrev_b32 v12, 16, v176
    v_and_b32 v13, s65, v176
    v_lshlrev_b32 v14, 16, v177
    v_and_b32 v15, s65, v177
    v_lshlrev_b32 v16, 16, v178
    v_and_b32 v17, s65, v178
    v_lshlrev_b32 v18, 16, v179
    v_and_b32_e64 v19, s65, v179
    v_pk_fma_f32 v[12:13], v[12:13], v[8:9], v[10:11]
    v_pk_fma_f32 v[14:15], v[14:15], v[8:9], v[10:11]
    v_pk_fma_f32 v[16:17], v[16:17], v[8:9], v[10:11]
    v_pk_fma_f32 v[18:19], v[18:19], v[8:9], v[10:11]
    v_cvt_pk_bf16_f32 v176, v12, v13
    v_cvt_pk_bf16_f32 v177, v14, v15
    v_cvt_pk_bf16_f32 v178, v16, v17
    v_cvt_pk_bf16_f32 v179, v18, v19
    v_lshlrev_b32 v12, 16, v180
    v_and_b32 v13, s65, v180
    v_lshlrev_b32 v14, 16, v181
    v_and_b32 v15, s65, v181
    v_lshlrev_b32 v16, 16, v182
    v_and_b32 v17, s65, v182
    v_lshlrev_b32 v18, 16, v183
    v_and_b32 v19, s65, v183
    v_pk_fma_f32 v[12:13], v[12:13], v[8:9], v[10:11]
    v_pk_fma_f32 v[14:15], v[14:15], v[8:9], v[10:11]
    v_pk_fma_f32 v[16:17], v[16:17], v[8:9], v[10:11]
    v_pk_fma_f32 v[18:19], v[18:19], v[8:9], v[10:11]
    v_cvt_pk_bf16_f32 v180, v12, v13
    v_cvt_pk_bf16_f32 v181, v14, v15
    v_cvt_pk_bf16_f32 v182, v16, v17
    v_cvt_pk_bf16_f32 v183, v18, v19
    v_lshlrev_b32 v12, 16, v184
    v_and_b32 v13, s65, v184
    v_lshlrev_b32 v14, 16, v185
    v_and_b32 v15, s65, v185
    v_lshlrev_b32 v16, 16, v186
    v_and_b32 v17, s65, v186
    v_lshlrev_b32 v18, 16, v187
    v_and_b32 v19, s65, v187
    v_pk_fma_f32 v[12:13], v[12:13], v[8:9], v[10:11]
    v_pk_fma_f32 v[14:15], v[14:15], v[8:9], v[10:11]
    v_pk_fma_f32 v[16:17], v[16:17], v[8:9], v[10:11]
    v_pk_fma_f32 v[18:19], v[18:19], v[8:9], v[10:11]
    v_cvt_pk_bf16_f32 v184, v12, v13
    v_cvt_pk_bf16_f32 v185, v14, v15
    v_cvt_pk_bf16_f32 v186, v16, v17
    v_cvt_pk_bf16_f32 v187, v18, v19
    v_lshlrev_b32 v12, 16, v188
    v_and_b32 v13, s65, v188
    v_lshlrev_b32 v14, 16, v189
    v_and_b32 v15, s65, v189
    v_lshlrev_b32 v16, 16, v190
    v_and_b32 v17, s65, v190
    v_lshlrev_b32 v18, 16, v191
    v_and_b32 v19, s65, v191
    v_pk_fma_f32 v[12:13], v[12:13], v[8:9], v[10:11]
    v_pk_fma_f32 v[14:15], v[14:15], v[8:9], v[10:11]
    v_pk_fma_f32 v[16:17], v[16:17], v[8:9], v[10:11]
    v_pk_fma_f32 v[18:19], v[18:19], v[8:9], v[10:11]
    v_cvt_pk_bf16_f32 v188, v12, v13
    v_cvt_pk_bf16_f32 v189, v14, v15
    v_cvt_pk_bf16_f32 v190, v16, v17
    v_cvt_pk_bf16_f32 v191, v18, v19
    v_dot2_f32_bf16 v76, v192, s64, 0
    v_dot2_f32_bf16 v78, v192, v192, 0
    v_dot2_f32_bf16 v77, v193, s64, 0
    v_dot2_f32_bf16 v79, v193, v193, 0
    v_dot2_f32_bf16 v76, v194, s64, v76
    v_dot2_f32_bf16 v78, v194, v194, v78
    v_dot2_f32_bf16 v77, v195, s64, v77
    v_dot2_f32_bf16 v79, v195, v195, v79
    v_dot2_f32_bf16 v76, v196, s64, v76
    v_dot2_f32_bf16 v78, v196, v196, v78
    v_dot2_f32_bf16 v77, v197, s64, v77
    v_dot2_f32_bf16 v79, v197, v197, v79
    v_dot2_f32_bf16 v76, v198, s64, v76
    v_dot2_f32_bf16 v78, v198, v198, v78
    v_dot2_f32_bf16 v77, v199, s64, v77
    v_dot2_f32_bf16 v79, v199, v199, v79
    v_dot2_f32_bf16 v76, v200, s64, v76
    v_dot2_f32_bf16 v78, v200, v200, v78
    v_dot2_f32_bf16 v77, v201, s64, v77
    v_dot2_f32_bf16 v79, v201, v201, v79
    v_dot2_f32_bf16 v76, v202, s64, v76
    v_dot2_f32_bf16 v78, v202, v202, v78
    v_dot2_f32_bf16 v77, v203, s64, v77
    v_dot2_f32_bf16 v79, v203, v203, v79
    v_dot2_f32_bf16 v76, v204, s64, v76
    v_dot2_f32_bf16 v78, v204, v204, v78
    v_dot2_f32_bf16 v77, v205, s64, v77
    v_dot2_f32_bf16 v79, v205, v205, v79
    v_dot2_f32_bf16 v76, v206, s64, v76
    v_dot2_f32_bf16 v78, v206, v206, v78
    v_dot2_f32_bf16 v77, v207, s64, v77
    v_dot2_f32_bf16 v79, v207, v207, v79
    v_dot2_f32_bf16 v76, v208, s64, v76
    v_dot2_f32_bf16 v78, v208, v208, v78
    v_dot2_f32_bf16 v77, v209, s64, v77
    v_dot2_f32_bf16 v79, v209, v209, v79
    v_dot2_f32_bf16 v76, v210, s64, v76
    v_dot2_f32_bf16 v78, v210, v210, v78
    v_dot2_f32_bf16 v77, v211, s64, v77
    v_dot2_f32_bf16 v79, v211, v211, v79
    v_dot2_f32_bf16 v76, v212, s64, v76
    v_dot2_f32_bf16 v78, v212, v212, v78
    v_dot2_f32_bf16 v77, v213, s64, v77
    v_dot2_f32_bf16 v79, v213, v213, v79
    v_dot2_f32_bf16 v76, v214, s64, v76
    v_dot2_f32_bf16 v78, v214, v214, v78
    v_dot2_f32_bf16 v77, v215, s64, v77
    v_dot2_f32_bf16 v79, v215, v215, v79
    v_dot2_f32_bf16 v76, v216, s64, v76
    v_dot2_f32_bf16 v78, v216, v216, v78
    v_dot2_f32_bf16 v77, v217, s64, v77
    v_dot2_f32_bf16 v79, v217, v217, v79
    v_dot2_f32_bf16 v76, v218, s64, v76
    v_dot2_f32_bf16 v78, v218, v218, v78
    v_dot2_f32_bf16 v77, v219, s64, v77
    v_dot2_f32_bf16 v79, v219, v219, v79
    v_dot2_f32_bf16 v76, v220, s64, v76
    v_dot2_f32_bf16 v78, v220, v220, v78
    v_dot2_f32_bf16 v77, v221, s64, v77
    v_dot2_f32_bf16 v79, v221, v221, v79
    v_dot2_f32_bf16 v76, v222, s64, v76
    v_dot2_f32_bf16 v78, v222, v222, v78
    v_dot2_f32_bf16 v77, v223, s64, v77
    v_dot2_f32_bf16 v79, v223, v223, v79
    s_load_dwordx2 s[52:53], s[18:19], 0
    v_dot2_f32_bf16 v76, v224, s64, v76
    v_dot2_f32_bf16 v78, v224, v224, v78
    v_dot2_f32_bf16 v77, v225, s64, v77
    v_dot2_f32_bf16 v79, v225, v225, v79
    v_dot2_f32_bf16 v76, v226, s64, v76
    v_dot2_f32_bf16 v78, v226, v226, v78
    v_dot2_f32_bf16 v77, v227, s64, v77
    v_dot2_f32_bf16 v79, v227, v227, v79
    v_dot2_f32_bf16 v76, v228, s64, v76
    v_dot2_f32_bf16 v78, v228, v228, v78
    v_dot2_f32_bf16 v77, v229, s64, v77
    v_dot2_f32_bf16 v79, v229, v229, v79
    v_dot2_f32_bf16 v76, v230, s64, v76
    v_dot2_f32_bf16 v78, v230, v230, v78
    v_dot2_f32_bf16 v77, v231, s64, v77
    v_dot2_f32_bf16 v79, v231, v231, v79
    v_dot2_f32_bf16 v76, v232, s64, v76
    v_dot2_f32_bf16 v78, v232, v232, v78
    v_dot2_f32_bf16 v77, v233, s64, v77
    v_dot2_f32_bf16 v79, v233, v233, v79
    v_dot2_f32_bf16 v76, v234, s64, v76
    v_dot2_f32_bf16 v78, v234, v234, v78
    v_dot2_f32_bf16 v77, v235, s64, v77
    v_dot2_f32_bf16 v79, v235, v235, v79
    v_dot2_f32_bf16 v76, v236, s64, v76
    v_dot2_f32_bf16 v78, v236, v236, v78
    v_dot2_f32_bf16 v77, v237, s64, v77
    v_dot2_f32_bf16 v79, v237, v237, v79
    v_dot2_f32_bf16 v76, v238, s64, v76
    v_dot2_f32_bf16 v78, v238, v238, v78
    v_dot2_f32_bf16 v77, v239, s64, v77
    v_dot2_f32_bf16 v79, v239, v239, v79
    v_dot2_f32_bf16 v76, v240, s64, v76
    v_dot2_f32_bf16 v78, v240, v240, v78
    v_dot2_f32_bf16 v77, v241, s64, v77
    v_dot2_f32_bf16 v79, v241, v241, v79
    v_dot2_f32_bf16 v76, v242, s64, v76
    v_dot2_f32_bf16 v78, v242, v242, v78
    v_dot2_f32_bf16 v77, v243, s64, v77
    v_dot2_f32_bf16 v79, v243, v243, v79
    v_dot2_f32_bf16 v76, v244, s64, v76
    v_dot2_f32_bf16 v78, v244, v244, v78
    v_dot2_f32_bf16 v77, v245, s64, v77
    v_dot2_f32_bf16 v79, v245, v245, v79
    v_dot2_f32_bf16 v76, v246, s64, v76
    v_dot2_f32_bf16 v78, v246, v246, v78
    v_dot2_f32_bf16 v77, v247, s64, v77
    v_dot2_f32_bf16 v79, v247, v247, v79
    v_dot2_f32_bf16 v76, v248, s64, v76
    v_dot2_f32_bf16 v78, v248, v248, v78
    v_dot2_f32_bf16 v77, v249, s64, v77
    v_dot2_f32_bf16 v79, v249, v249, v79
    v_dot2_f32_bf16 v76, v250, s64, v76
    v_dot2_f32_bf16 v78, v250, v250, v78
    v_dot2_f32_bf16 v77, v251, s64, v77
    v_dot2_f32_bf16 v79, v251, v251, v79
    v_dot2_f32_bf16 v76, v252, s64, v76
    v_dot2_f32_bf16 v78, v252, v252, v78
    v_dot2_f32_bf16 v77, v253, s64, v77
    v_dot2_f32_bf16 v79, v253, v253, v79
    v_dot2_f32_bf16 v76, v254, s64, v76
    v_dot2_f32_bf16 v78, v254, v254, v78
    v_dot2_f32_bf16 v77, v255, s64, v77
    v_dot2_f32_bf16 v79, v255, v255, v79
    s_nop 1
    v_add_f32 v10, v76, v77
    v_add_f32 v8, v78, v79
    s_nop 1
    v_permlane32_swap_b32 v10, v8
    v_add_f32 v10, v10, v8
    v_mov_b32 v8, v10
    s_nop 1
    v_permlane16_swap_b32 v10, v8
    v_add_f32 v10, v10, v8
    v_mul_f32 v10, 0x3b000000, v10
    v_mov_b32_e64 v8, v10
    s_nop 1
    v_permlane32_swap_b32 v10, v8
    v_fma_f32 v8, -v10, v10, v8
    v_max_f32_e64 v8, 0, v8
    v_add_f32 v8, 0x3727c5ac, v8
    v_rsq_f32 v8, v8
    s_nop 0
    v_mul_f32_e64 v8, s66, v8
    v_mul_f32 v10, -v10, v8
    v_mov_b32 v9, v8
    v_mov_b32 v11, v10
    v_lshlrev_b32 v12, 16, v192
    v_and_b32 v13, s65, v192
    v_lshlrev_b32 v14, 16, v193
    v_and_b32 v15, s65, v193
    v_lshlrev_b32 v16, 16, v194
    v_and_b32 v17, s65, v194
    v_lshlrev_b32 v18, 16, v195
    v_and_b32 v19, s65, v195
    v_pk_fma_f32 v[12:13], v[12:13], v[8:9], v[10:11]
    v_pk_fma_f32 v[14:15], v[14:15], v[8:9], v[10:11]
    v_pk_fma_f32 v[16:17], v[16:17], v[8:9], v[10:11]
    v_pk_fma_f32 v[18:19], v[18:19], v[8:9], v[10:11]
    v_cvt_pk_bf16_f32 v192, v12, v13
    v_cvt_pk_bf16_f32 v193, v14, v15
    v_cvt_pk_bf16_f32 v194, v16, v17
    v_cvt_pk_bf16_f32 v195, v18, v19
    v_lshlrev_b32 v12, 16, v196
    v_and_b32 v13, s65, v196
    v_lshlrev_b32 v14, 16, v197
    v_and_b32 v15, s65, v197
    v_lshlrev_b32 v16, 16, v198
    v_and_b32 v17, s65, v198
    v_lshlrev_b32 v18, 16, v199
    v_and_b32 v19, s65, v199
    v_pk_fma_f32 v[12:13], v[12:13], v[8:9], v[10:11]
    v_pk_fma_f32 v[14:15], v[14:15], v[8:9], v[10:11]
    v_pk_fma_f32 v[16:17], v[16:17], v[8:9], v[10:11]
    v_pk_fma_f32 v[18:19], v[18:19], v[8:9], v[10:11]
    v_cvt_pk_bf16_f32 v196, v12, v13
    v_cvt_pk_bf16_f32 v197, v14, v15
    v_cvt_pk_bf16_f32 v198, v16, v17
    v_cvt_pk_bf16_f32 v199, v18, v19
    v_lshlrev_b32 v12, 16, v200
    v_and_b32 v13, s65, v200
    v_lshlrev_b32 v14, 16, v201
    v_and_b32 v15, s65, v201
    v_lshlrev_b32 v16, 16, v202
    v_and_b32 v17, s65, v202
    v_lshlrev_b32 v18, 16, v203
    v_and_b32 v19, s65, v203
    v_pk_fma_f32 v[12:13], v[12:13], v[8:9], v[10:11]
    v_pk_fma_f32 v[14:15], v[14:15], v[8:9], v[10:11]
    v_pk_fma_f32 v[16:17], v[16:17], v[8:9], v[10:11]
    v_pk_fma_f32 v[18:19], v[18:19], v[8:9], v[10:11]
    v_cvt_pk_bf16_f32 v200, v12, v13
    v_cvt_pk_bf16_f32 v201, v14, v15
    v_cvt_pk_bf16_f32 v202, v16, v17
    v_cvt_pk_bf16_f32 v203, v18, v19
    v_lshlrev_b32 v12, 16, v204
    v_and_b32 v13, s65, v204
    v_lshlrev_b32 v14, 16, v205
    v_and_b32 v15, s65, v205
    v_lshlrev_b32 v16, 16, v206
    v_and_b32 v17, s65, v206
    v_lshlrev_b32 v18, 16, v207
    v_and_b32 v19, s65, v207
    v_pk_fma_f32 v[12:13], v[12:13], v[8:9], v[10:11]
    v_pk_fma_f32 v[14:15], v[14:15], v[8:9], v[10:11]
    v_pk_fma_f32 v[16:17], v[16:17], v[8:9], v[10:11]
    v_pk_fma_f32 v[18:19], v[18:19], v[8:9], v[10:11]
    v_cvt_pk_bf16_f32 v204, v12, v13
    v_cvt_pk_bf16_f32 v205, v14, v15
    v_cvt_pk_bf16_f32 v206, v16, v17
    v_cvt_pk_bf16_f32 v207, v18, v19
    v_lshlrev_b32 v12, 16, v208
    v_and_b32 v13, s65, v208
    v_lshlrev_b32 v14, 16, v209
    v_and_b32 v15, s65, v209
    v_lshlrev_b32 v16, 16, v210
    v_and_b32 v17, s65, v210
    v_lshlrev_b32 v18, 16, v211
    v_and_b32 v19, s65, v211
    v_pk_fma_f32 v[12:13], v[12:13], v[8:9], v[10:11]
    v_pk_fma_f32 v[14:15], v[14:15], v[8:9], v[10:11]
    v_pk_fma_f32 v[16:17], v[16:17], v[8:9], v[10:11]
    v_pk_fma_f32 v[18:19], v[18:19], v[8:9], v[10:11]
    v_cvt_pk_bf16_f32 v208, v12, v13
    v_cvt_pk_bf16_f32 v209, v14, v15
    v_cvt_pk_bf16_f32 v210, v16, v17
    v_cvt_pk_bf16_f32 v211, v18, v19
    v_lshlrev_b32 v12, 16, v212
    v_and_b32 v13, s65, v212
    v_lshlrev_b32 v14, 16, v213
    v_and_b32 v15, s65, v213
    v_lshlrev_b32 v16, 16, v214
    v_and_b32 v17, s65, v214
    v_lshlrev_b32 v18, 16, v215
    v_and_b32 v19, s65, v215
    v_pk_fma_f32 v[12:13], v[12:13], v[8:9], v[10:11]
    v_pk_fma_f32 v[14:15], v[14:15], v[8:9], v[10:11]
    v_pk_fma_f32 v[16:17], v[16:17], v[8:9], v[10:11]
    v_pk_fma_f32 v[18:19], v[18:19], v[8:9], v[10:11]
    v_cvt_pk_bf16_f32 v212, v12, v13
    v_cvt_pk_bf16_f32 v213, v14, v15
    v_cvt_pk_bf16_f32 v214, v16, v17
    v_cvt_pk_bf16_f32 v215, v18, v19
    v_lshlrev_b32 v12, 16, v216
    v_and_b32 v13, s65, v216
    v_lshlrev_b32 v14, 16, v217
    v_and_b32 v15, s65, v217
    v_lshlrev_b32 v16, 16, v218
    v_and_b32 v17, s65, v218
    v_lshlrev_b32 v18, 16, v219
    v_and_b32 v19, s65, v219
    v_pk_fma_f32 v[12:13], v[12:13], v[8:9], v[10:11]
    v_pk_fma_f32 v[14:15], v[14:15], v[8:9], v[10:11]
    v_pk_fma_f32 v[16:17], v[16:17], v[8:9], v[10:11]
    v_pk_fma_f32 v[18:19], v[18:19], v[8:9], v[10:11]
    v_cvt_pk_bf16_f32 v216, v12, v13
    v_cvt_pk_bf16_f32 v217, v14, v15
    v_cvt_pk_bf16_f32 v218, v16, v17
    v_cvt_pk_bf16_f32 v219, v18, v19
    v_lshlrev_b32 v12, 16, v220
    v_and_b32 v13, s65, v220
    v_lshlrev_b32 v14, 16, v221
    v_and_b32 v15, s65, v221
    v_lshlrev_b32 v16, 16, v222
    v_and_b32 v17, s65, v222
    v_lshlrev_b32 v18, 16, v223
    v_and_b32 v19, s65, v223
    v_pk_fma_f32 v[12:13], v[12:13], v[8:9], v[10:11]
    v_pk_fma_f32 v[14:15], v[14:15], v[8:9], v[10:11]
    v_pk_fma_f32 v[16:17], v[16:17], v[8:9], v[10:11]
    v_pk_fma_f32 v[18:19], v[18:19], v[8:9], v[10:11]
    v_cvt_pk_bf16_f32 v220, v12, v13
    v_cvt_pk_bf16_f32 v221, v14, v15
    v_cvt_pk_bf16_f32 v222, v16, v17
    v_cvt_pk_bf16_f32 v223, v18, v19
    v_lshlrev_b32 v12, 16, v224
    v_and_b32 v13, s65, v224
    v_lshlrev_b32 v14, 16, v225
    v_and_b32 v15, s65, v225
    v_lshlrev_b32 v16, 16, v226
    v_and_b32 v17, s65, v226
    v_lshlrev_b32 v18, 16, v227
    v_and_b32 v19, s65, v227
    v_pk_fma_f32 v[12:13], v[12:13], v[8:9], v[10:11]
    v_pk_fma_f32 v[14:15], v[14:15], v[8:9], v[10:11]
    v_pk_fma_f32 v[16:17], v[16:17], v[8:9], v[10:11]
    v_pk_fma_f32 v[18:19], v[18:19], v[8:9], v[10:11]
    v_cvt_pk_bf16_f32 v224, v12, v13
    v_cvt_pk_bf16_f32 v225, v14, v15
    v_cvt_pk_bf16_f32 v226, v16, v17
    v_cvt_pk_bf16_f32 v227, v18, v19
    v_lshlrev_b32 v12, 16, v228
    v_and_b32 v13, s65, v228
    v_lshlrev_b32 v14, 16, v229
    v_and_b32 v15, s65, v229
    v_lshlrev_b32 v16, 16, v230
    v_and_b32 v17, s65, v230
    v_lshlrev_b32 v18, 16, v231
    v_and_b32 v19, s65, v231
    v_pk_fma_f32 v[12:13], v[12:13], v[8:9], v[10:11]
    v_pk_fma_f32 v[14:15], v[14:15], v[8:9], v[10:11]
    v_pk_fma_f32 v[16:17], v[16:17], v[8:9], v[10:11]
    v_pk_fma_f32 v[18:19], v[18:19], v[8:9], v[10:11]
    v_cvt_pk_bf16_f32 v228, v12, v13
    v_cvt_pk_bf16_f32 v229, v14, v15
    v_cvt_pk_bf16_f32 v230, v16, v17
    v_cvt_pk_bf16_f32 v231, v18, v19
    v_lshlrev_b32 v12, 16, v232
    v_and_b32 v13, s65, v232
    v_lshlrev_b32 v14, 16, v233
    v_and_b32 v15, s65, v233
    v_lshlrev_b32 v16, 16, v234
    v_and_b32 v17, s65, v234
    v_lshlrev_b32 v18, 16, v235
    v_and_b32 v19, s65, v235
    v_pk_fma_f32 v[12:13], v[12:13], v[8:9], v[10:11]
    v_pk_fma_f32 v[14:15], v[14:15], v[8:9], v[10:11]
    v_pk_fma_f32 v[16:17], v[16:17], v[8:9], v[10:11]
    v_pk_fma_f32 v[18:19], v[18:19], v[8:9], v[10:11]
    v_cvt_pk_bf16_f32 v232, v12, v13
    v_cvt_pk_bf16_f32 v233, v14, v15
    v_cvt_pk_bf16_f32 v234, v16, v17
    v_cvt_pk_bf16_f32 v235, v18, v19
    v_lshlrev_b32 v12, 16, v236
    v_and_b32 v13, s65, v236
    v_lshlrev_b32 v14, 16, v237
    v_and_b32 v15, s65, v237
    v_lshlrev_b32 v16, 16, v238
    v_and_b32 v17, s65, v238
    v_lshlrev_b32 v18, 16, v239
    v_and_b32 v19, s65, v239
    v_pk_fma_f32 v[12:13], v[12:13], v[8:9], v[10:11]
    v_pk_fma_f32 v[14:15], v[14:15], v[8:9], v[10:11]
    v_pk_fma_f32 v[16:17], v[16:17], v[8:9], v[10:11]
    v_pk_fma_f32 v[18:19], v[18:19], v[8:9], v[10:11]
    v_cvt_pk_bf16_f32 v236, v12, v13
    v_cvt_pk_bf16_f32 v237, v14, v15
    v_cvt_pk_bf16_f32 v238, v16, v17
    v_cvt_pk_bf16_f32 v239, v18, v19
    v_lshlrev_b32 v12, 16, v240
    v_and_b32 v13, s65, v240
    v_lshlrev_b32 v14, 16, v241
    v_and_b32 v15, s65, v241
    v_lshlrev_b32 v16, 16, v242
    v_and_b32 v17, s65, v242
    v_lshlrev_b32 v18, 16, v243
    v_and_b32 v19, s65, v243
    v_pk_fma_f32 v[12:13], v[12:13], v[8:9], v[10:11]
    v_pk_fma_f32 v[14:15], v[14:15], v[8:9], v[10:11]
    v_pk_fma_f32 v[16:17], v[16:17], v[8:9], v[10:11]
    v_pk_fma_f32 v[18:19], v[18:19], v[8:9], v[10:11]
    v_cvt_pk_bf16_f32 v240, v12, v13
    v_cvt_pk_bf16_f32 v241, v14, v15
    v_cvt_pk_bf16_f32 v242, v16, v17
    v_cvt_pk_bf16_f32 v243, v18, v19
    v_lshlrev_b32 v12, 16, v244
    v_and_b32 v13, s65, v244
    v_lshlrev_b32 v14, 16, v245
    v_and_b32 v15, s65, v245
    v_lshlrev_b32 v16, 16, v246
    v_and_b32 v17, s65, v246
    v_lshlrev_b32 v18, 16, v247
    v_and_b32 v19, s65, v247
    v_pk_fma_f32 v[12:13], v[12:13], v[8:9], v[10:11]
    v_pk_fma_f32 v[14:15], v[14:15], v[8:9], v[10:11]
    v_pk_fma_f32 v[16:17], v[16:17], v[8:9], v[10:11]
    v_pk_fma_f32 v[18:19], v[18:19], v[8:9], v[10:11]
    v_cvt_pk_bf16_f32 v244, v12, v13
    v_cvt_pk_bf16_f32 v245, v14, v15
    v_cvt_pk_bf16_f32 v246, v16, v17
    v_cvt_pk_bf16_f32 v247, v18, v19
    v_lshlrev_b32 v12, 16, v248
    v_and_b32 v13, s65, v248
    v_lshlrev_b32 v14, 16, v249
    v_and_b32 v15, s65, v249
    v_lshlrev_b32 v16, 16, v250
    v_and_b32 v17, s65, v250
    v_lshlrev_b32 v18, 16, v251
    v_and_b32 v19, s65, v251
    v_pk_fma_f32 v[12:13], v[12:13], v[8:9], v[10:11]
    v_pk_fma_f32 v[14:15], v[14:15], v[8:9], v[10:11]
    v_pk_fma_f32 v[16:17], v[16:17], v[8:9], v[10:11]
    v_pk_fma_f32 v[18:19], v[18:19], v[8:9], v[10:11]
    v_cvt_pk_bf16_f32 v248, v12, v13
    v_cvt_pk_bf16_f32 v249, v14, v15
    v_cvt_pk_bf16_f32 v250, v16, v17
    v_cvt_pk_bf16_f32 v251, v18, v19
    v_lshlrev_b32 v12, 16, v252
    v_and_b32 v13, s65, v252
    v_lshlrev_b32 v14, 16, v253
    v_and_b32 v15, s65, v253
    v_lshlrev_b32 v16, 16, v254
    v_and_b32 v17, s65, v254
    v_lshlrev_b32 v18, 16, v255
    v_and_b32 v19, s65, v255
    v_pk_fma_f32 v[12:13], v[12:13], v[8:9], v[10:11]
    v_pk_fma_f32 v[14:15], v[14:15], v[8:9], v[10:11]
    v_pk_fma_f32 v[16:17], v[16:17], v[8:9], v[10:11]
    v_pk_fma_f32 v[18:19], v[18:19], v[8:9], v[10:11]
    v_cvt_pk_bf16_f32 v252, v12, v13
    v_cvt_pk_bf16_f32 v253, v14, v15
    v_cvt_pk_bf16_f32 v254, v16, v17
    v_cvt_pk_bf16_f32 v255, v18, v19
RE1:
    s_waitcnt lgkmcnt(0)
    s_cmp_lg_u32 s53, 0
    s_cbranch_scc1 OK1
    s_sleep 4
    s_load_dwordx2 s[52:53], s[18:19], 0 glc
    s_sub_u32 s0, s0, 16
    s_cmp_lt_i32 s0, 0
    s_cbranch_scc0 RE1
    s_waitcnt lgkmcnt(0)
OK1:
    s_mov_b32 s53, s52
    s_cmp_eq_u32 s48, 0
    s_cbranch_scc1 G1_A
    s_barrier
    ds_read_b64_tr_b16 v[40:41], v2 offset:0
    ds_read_b64_tr_b16 v[42:43], v2 offset:512
    ds_read_b64_tr_b16 v[44:45], v3 offset:0
    ds_read_b64_tr_b16 v[46:47], v3 offset:512
    ds_read_b64_tr_b16 v[48:49], v4 offset:0
    ds_read_b64_tr_b16 v[50:51], v4 offset:512
    ds_read_b64_tr_b16 v[52:53], v5 offset:0
    ds_read_b64_tr_b16 v[54:55], v5 offset:512
    ds_read_b64_tr_b16 v[56:57], v2 offset:4096
    ds_read_b64_tr_b16 v[58:59], v2 offset:4608
    s_waitcnt lgkmcnt(8)
    v_mfma_f32_16x16x32_bf16 v[64:67], v[40:43], v[128:131], 0
    ds_read_b64_tr_b16 v[60:61], v3 offset:4096
    ds_read_b64_tr_b16 v[62:63], v3 offset:4608
    v_mfma_f32_16x16x32_bf16 v[80:83], v[40:43], v[192:195], 0
    s_waitcnt lgkmcnt(8)
    v_mfma_f32_16x16x32_bf16 v[84:87], v[44:47], v[192:195], 0
    ds_read_b64_tr_b16 v[40:41], v4 offset:4096
    ds_read_b64_tr_b16 v[42:43], v4 offset:4608
    v_mfma_f32_16x16x32_bf16 v[68:71], v[44:47], v[128:131], 0
    s_waitcnt lgkmcnt(8)
    v_mfma_f32_16x16x32_bf16 v[72:75], v[48:51], v[128:131], 0
    ds_read_b64_tr_b16 v[44:45], v5 offset:4096
    ds_read_b64_tr_b16 v[46:47], v5 offset:4608
    v_mfma_f32_16x16x32_bf16 v[88:91], v[48:51], v[192:195], 0
    s_waitcnt lgkmcnt(8)
    v_mfma_f32_16x16x32_bf16 v[92:95], v[52:55], v[192:195], 0
    ds_read_b64_tr_b16 v[48:49], v2 offset:8192
    ds_read_b64_tr_b16 v[50:51], v2 offset:8704
    v_mfma_f32_16x16x32_bf16 v[76:79], v[52:55], v[128:131], 0
    s_waitcnt lgkmcnt(8)
    v_mfma_f32_16x16x32_bf16 v[64:67], v[56:59], v[132:135], v[64:67]
    ds_read_b64_tr_b16 v[52:53], v3 offset:8192
    ds_read_b64_tr_b16 v[54:55], v3 offset:8704
    v_mfma_f32_16x16x32_bf16 v[80:83], v[56:59], v[196:199], v[80:83]
    s_waitcnt lgkmcnt(8)
    v_mfma_f32_16x16x32_bf16 v[84:87], v[60:63], v[196:199], v[84:87]
    ds_read_b64_tr_b16 v[56:57], v4 offset:8192
    ds_read_b64_tr_b16 v[58:59], v4 offset:8704
    v_mfma_f32_16x16x32_bf16 v[68:71], v[60:63], v[132:135], v[68:71]
    s_waitcnt lgkmcnt(8)
    v_mfma_f32_16x16x32_bf16 v[72:75], v[40:43], v[132:135], v[72:75]
    ds_read_b64_tr_b16 v[60:61], v5 offset:8192
    ds_read_b64_tr_b16 v[62:63], v5 offset:8704
    v_mfma_f32_16x16x32_bf16 v[88:91], v[40:43], v[196:199], v[88:91]
    s_waitcnt lgkmcnt(8)
    v_mfma_f32_16x16x32_bf16 v[92:95], v[44:47], v[196:199], v[92:95]
    ds_read_b64_tr_b16 v[40:41], v2 offset:12288
    ds_read_b64_tr_b16 v[42:43], v2 offset:12800
    v_mfma_f32_16x16x32_bf16 v[76:79], v[44:47], v[132:135], v[76:79]
    s_waitcnt lgkmcnt(8)
    v_mfma_f32_16x16x32_bf16 v[64:67], v[48:51], v[136:139], v[64:67]
    ds_read_b64_tr_b16 v[44:45], v3 offset:12288
    ds_read_b64_tr_b16 v[46:47], v3 offset:12800
    v_mfma_f32_16x16x32_bf16 v[80:83], v[48:51], v[200:203], v[80:83]
    s_waitcnt lgkmcnt(8)
    v_mfma_f32_16x16x32_bf16 v[84:87], v[52:55], v[200:203], v[84:87]
    ds_read_b64_tr_b16 v[48:49], v4 offset:12288
    ds_read_b64_tr_b16 v[50:51], v4 offset:12800
    v_mfma_f32_16x16x32_bf16 v[68:71], v[52:55], v[136:139], v[68:71]
    s_waitcnt lgkmcnt(8)
    v_mfma_f32_16x16x32_bf16 v[72:75], v[56:59], v[136:139], v[72:75]
    ds_read_b64_tr_b16 v[52:53], v5 offset:12288
    ds_read_b64_tr_b16 v[54:55], v5 offset:12800
    v_mfma_f32_16x16x32_bf16 v[88:91], v[56:59], v[200:203], v[88:91]
    s_waitcnt lgkmcnt(8)
    v_mfma_f32_16x16x32_bf16 v[92:95], v[60:63], v[200:203], v[92:95]
    s_barrier
    ds_read_b64_tr_b16 v[56:57], v2 offset:16384
    ds_read_b64_tr_b16 v[58:59], v2 offset:16896
    v_mfma_f32_16x16x32_bf16 v[76:79], v[60:63], v[136:139], v[76:79]
    s_waitcnt lgkmcnt(8)
    v_mfma_f32_16x16x32_bf16 v[64:67], v[40:43], v[140:143], v[64:67]
    ds_read_b64_tr_b16 v[60:61], v3 offset:16384
    ds_read_b64_tr_b16 v[62:63], v3 offset:16896
    v_mfma_f32_16x16x32_bf16 v[80:83], v[40:43], v[204:207], v[80:83]
    s_waitcnt lgkmcnt(8)
    v_mfma_f32_16x16x32_bf16 v[84:87], v[44:47], v[204:207], v[84:87]
    ds_read_b64_tr_b16 v[40:41], v4 offset:16384
    ds_read_b64_tr_b16 v[42:43], v4 offset:16896
    v_mfma_f32_16x16x32_bf16 v[68:71], v[44:47], v[140:143], v[68:71]
    s_waitcnt lgkmcnt(8)
    v_mfma_f32_16x16x32_bf16 v[72:75], v[48:51], v[140:143], v[72:75]
    ds_read_b64_tr_b16 v[44:45], v5 offset:16384
    ds_read_b64_tr_b16 v[46:47], v5 offset:16896
    v_mfma_f32_16x16x32_bf16 v[88:91], v[48:51], v[204:207], v[88:91]
    s_waitcnt lgkmcnt(8)
    v_mfma_f32_16x16x32_bf16 v[92:95], v[52:55], v[204:207], v[92:95]
    ds_read_b64_tr_b16 v[48:49], v2 offset:20480
    ds_read_b64_tr_b16 v[50:51], v2 offset:20992
    v_mfma_f32_16x16x32_bf16 v[76:79], v[52:55], v[140:143], v[76:79]
    s_waitcnt lgkmcnt(8)
    v_mfma_f32_16x16x32_bf16 v[64:67], v[56:59], v[144:147], v[64:67]
    ds_read_b64_tr_b16 v[52:53], v3 offset:20480
    ds_read_b64_tr_b16 v[54:55], v3 offset:20992
    v_mfma_f32_16x16x32_bf16 v[80:83], v[56:59], v[208:211], v[80:83]
    s_waitcnt lgkmcnt(8)
    v_mfma_f32_16x16x32_bf16 v[84:87], v[60:63], v[208:211], v[84:87]
    ds_read_b64_tr_b16 v[56:57], v4 offset:20480
    ds_read_b64_tr_b16 v[58:59], v4 offset:20992
    v_mfma_f32_16x16x32_bf16 v[68:71], v[60:63], v[144:147], v[68:71]
    s_mul_i32 s54, s23, 14
    s_and_b32 s55, s23, 1
    s_waitcnt lgkmcnt(8)
    v_mfma_f32_16x16x32_bf16 v[72:75], v[40:43], v[144:147], v[72:75]
    ds_read_b64_tr_b16 v[60:61], v5 offset:20480
    ds_read_b64_tr_b16 v[62:63], v5 offset:20992
    v_mfma_f32_16x16x32_bf16 v[88:91], v[40:43], v[208:211], v[88:91]
    s_waitcnt lgkmcnt(8)
    v_mfma_f32_16x16x32_bf16 v[92:95], v[44:47], v[208:211], v[92:95]
    ds_read_b64_tr_b16 v[40:41], v2 offset:24576
    ds_read_b64_tr_b16 v[42:43], v2 offset:25088
    v_mfma_f32_16x16x32_bf16 v[76:79], v[44:47], v[144:147], v[76:79]
    s_waitcnt lgkmcnt(8)
    v_mfma_f32_16x16x32_bf16 v[64:67], v[48:51], v[148:151], v[64:67]
    ds_read_b64_tr_b16 v[44:45], v3 offset:24576
    ds_read_b64_tr_b16 v[46:47], v3 offset:25088
    v_mfma_f32_16x16x32_bf16 v[80:83], v[48:51], v[212:215], v[80:83]
    s_lshl1_add_u32 s1, s55, s54
    s_lshl_b32 s60, s1, 10
    s_waitcnt lgkmcnt(8)
    v_mfma_f32_16x16x32_bf16 v[84:87], v[52:55], v[212:215], v[84:87]
    ds_read_b64_tr_b16 v[48:49], v4 offset:24576
    ds_read_b64_tr_b16 v[50:51], v4 offset:25088
    v_mfma_f32_16x16x32_bf16 v[68:71], v[52:55], v[148:151], v[68:71]
    s_waitcnt lgkmcnt(8)
    v_mfma_f32_16x16x32_bf16 v[72:75], v[56:59], v[148:151], v[72:75]
    ds_read_b64_tr_b16 v[52:53], v5 offset:24576
    ds_read_b64_tr_b16 v[54:55], v5 offset:25088
    v_mfma_f32_16x16x32_bf16 v[88:91], v[56:59], v[212:215], v[88:91]
    s_waitcnt lgkmcnt(8)
    v_mfma_f32_16x16x32_bf16 v[92:95], v[60:63], v[212:215], v[92:95]
    ds_read_b64_tr_b16 v[56:57], v2 offset:28672
    ds_read_b64_tr_b16 v[58:59], v2 offset:29184
    v_mfma_f32_16x16x32_bf16 v[76:79], v[60:63], v[148:151], v[76:79]
    s_add_u32 s61, s60, 4096
    s_add_u32 s62, s60, 8192
    s_waitcnt lgkmcnt(8)
    v_mfma_f32_16x16x32_bf16 v[64:67], v[40:43], v[152:155], v[64:67]
    ds_read_b64_tr_b16 v[60:61], v3 offset:28672
    ds_read_b64_tr_b16 v[62:63], v3 offset:29184
    v_mfma_f32_16x16x32_bf16 v[80:83], v[40:43], v[216:219], v[80:83]
    s_waitcnt lgkmcnt(8)
    v_mfma_f32_16x16x32_bf16 v[84:87], v[44:47], v[216:219], v[84:87]
    ds_read_b64_tr_b16 v[40:41], v4 offset:28672
    ds_read_b64_tr_b16 v[42:43], v4 offset:29184
    v_mfma_f32_16x16x32_bf16 v[68:71], v[44:47], v[152:155], v[68:71]
    s_waitcnt lgkmcnt(8)
    v_mfma_f32_16x16x32_bf16 v[72:75], v[48:51], v[152:155], v[72:75]
    ds_read_b64_tr_b16 v[44:45], v5 offset:28672
    ds_read_b64_tr_b16 v[46:47], v5 offset:29184
    v_mfma_f32_16x16x32_bf16 v[88:91], v[48:51], v[216:219], v[88:91]
    s_cmp_eq_u32 s55, 0
    s_cselect_b32 s55, 12, 0
    s_waitcnt lgkmcnt(8)
    v_mfma_f32_16x16x32_bf16 v[92:95], v[52:55], v[216:219], v[92:95]
    s_barrier
    ds_read_b64_tr_b16 v[48:49], v2 offset:32768
    ds_read_b64_tr_b16 v[50:51], v2 offset:33280
    v_mfma_f32_16x16x32_bf16 v[76:79], v[52:55], v[152:155], v[76:79]
    s_waitcnt lgkmcnt(8)
    v_mfma_f32_16x16x32_bf16 v[64:67], v[56:59], v[156:159], v[64:67]
    ds_read_b64_tr_b16 v[52:53], v3 offset:32768
    ds_read_b64_tr_b16 v[54:55], v3 offset:33280
    v_mfma_f32_16x16x32_bf16 v[80:83], v[56:59], v[220:223], v[80:83]
    s_waitcnt lgkmcnt(8)
    v_mfma_f32_16x16x32_bf16 v[84:87], v[60:63], v[220:223], v[84:87]
    ds_read_b64_tr_b16 v[56:57], v4 offset:32768
    ds_read_b64_tr_b16 v[58:59], v4 offset:33280
    v_mfma_f32_16x16x32_bf16 v[68:71], v[60:63], v[156:159], v[68:71]
    s_add_u32 s54, s54, s55
    s_lshl_b32 s63, s54, 10
    s_waitcnt lgkmcnt(8)
    v_mfma_f32_16x16x32_bf16 v[72:75], v[40:43], v[156:159], v[72:75]
    ds_read_b64_tr_b16 v[60:61], v5 offset:32768
    ds_read_b64_tr_b16 v[62:63], v5 offset:33280
    v_mfma_f32_16x16x32_bf16 v[88:91], v[40:43], v[220:223], v[88:91]
    s_waitcnt lgkmcnt(8)
    v_mfma_f32_16x16x32_bf16 v[92:95], v[44:47], v[220:223], v[92:95]
    ds_read_b64_tr_b16 v[40:41], v2 offset:36864
    ds_read_b64_tr_b16 v[42:43], v2 offset:37376
    v_mfma_f32_16x16x32_bf16 v[76:79], v[44:47], v[156:159], v[76:79]
    v_bfe_u32 v8, v0, 2, 2
    s_waitcnt lgkmcnt(8)
    v_mfma_f32_16x16x32_bf16 v[64:67], v[48:51], v[160:163], v[64:67]
    ds_read_b64_tr_b16 v[44:45], v3 offset:36864
    ds_read_b64_tr_b16 v[46:47], v3 offset:37376
    v_mfma_f32_16x16x32_bf16 v[80:83], v[48:51], v[224:227], v[80:83]
    v_lshl_add_u32 v8, v7, 3, v8
    s_waitcnt lgkmcnt(8)
    v_mfma_f32_16x16x32_bf16 v[84:87], v[52:55], v[224:227], v[84:87]
    ds_read_b64_tr_b16 v[48:49], v4 offset:36864
    ds_read_b64_tr_b16 v[50:51], v4 offset:37376
    v_mfma_f32_16x16x32_bf16 v[68:71], v[52:55], v[160:163], v[68:71]
    s_waitcnt lgkmcnt(8)
    v_mfma_f32_16x16x32_bf16 v[72:75], v[56:59], v[160:163], v[72:75]
    ds_read_b64_tr_b16 v[52:53], v5 offset:36864
    ds_read_b64_tr_b16 v[54:55], v5 offset:37376
    v_mfma_f32_16x16x32_bf16 v[88:91], v[56:59], v[224:227], v[88:91]
    v_and_b32_e64 v9, 1, v7
    s_waitcnt lgkmcnt(8)
    v_mfma_f32_16x16x32_bf16 v[92:95], v[60:63], v[224:227], v[92:95]
    ds_read_b64_tr_b16 v[56:57], v2 offset:40960
    ds_read_b64_tr_b16 v[58:59], v2 offset:41472
    v_mfma_f32_16x16x32_bf16 v[76:79], v[60:63], v[160:163], v[76:79]
    v_lshlrev_b32 v9, 5, v9
    s_waitcnt lgkmcnt(8)
    v_mfma_f32_16x16x32_bf16 v[64:67], v[40:43], v[164:167], v[64:67]
    ds_read_b64_tr_b16 v[60:61], v3 offset:40960
    ds_read_b64_tr_b16 v[62:63], v3 offset:41472
    v_mfma_f32_16x16x32_bf16 v[80:83], v[40:43], v[228:231], v[80:83]
    s_waitcnt lgkmcnt(8)
    v_mfma_f32_16x16x32_bf16 v[84:87], v[44:47], v[228:231], v[84:87]
    ds_read_b64_tr_b16 v[40:41], v4 offset:40960
    ds_read_b64_tr_b16 v[42:43], v4 offset:41472
    v_mfma_f32_16x16x32_bf16 v[68:71], v[44:47], v[164:167], v[68:71]
    v_lshl_add_u32 v8, v8, 6, v9
    s_waitcnt lgkmcnt(8)
    v_mfma_f32_16x16x32_bf16 v[72:75], v[48:51], v[164:167], v[72:75]
    ds_read_b64_tr_b16 v[44:45], v5 offset:40960
    ds_read_b64_tr_b16 v[46:47], v5 offset:41472
    v_mfma_f32_16x16x32_bf16 v[88:91], v[48:51], v[228:231], v[88:91]
    v_and_b32 v9, 3, v0
    s_waitcnt lgkmcnt(8)
    v_mfma_f32_16x16x32_bf16 v[92:95], v[52:55], v[228:231], v[92:95]
    ds_read_b64_tr_b16 v[48:49], v2 offset:45056
    ds_read_b64_tr_b16 v[50:51], v2 offset:45568
    v_mfma_f32_16x16x32_bf16 v[76:79], v[52:55], v[164:167], v[76:79]
    s_waitcnt lgkmcnt(8)
    v_mfma_f32_16x16x32_bf16 v[64:67], v[56:59], v[168:171], v[64:67]
    ds_read_b64_tr_b16 v[52:53], v3 offset:45056
    ds_read_b64_tr_b16 v[54:55], v3 offset:45568
    v_mfma_f32_16x16x32_bf16 v[80:83], v[56:59], v[232:235], v[80:83]
    v_lshl_add_u32 v8, v9, 3, v8
    s_waitcnt lgkmcnt(8)
    v_mfma_f32_16x16x32_bf16 v[84:87], v[60:63], v[232:235], v[84:87]
    ds_read_b64_tr_b16 v[56:57], v4 offset:45056
    ds_read_b64_tr_b16 v[58:59], v4 offset:45568
    v_mfma_f32_16x16x32_bf16 v[68:71], v[60:63], v[168:171], v[68:71]
    v_add_u32 v8, 65536, v8
    s_waitcnt lgkmcnt(8)
    v_mfma_f32_16x16x32_bf16 v[72:75], v[40:43], v[168:171], v[72:75]
    ds_read_b64_tr_b16 v[60:61], v5 offset:45056
    ds_read_b64_tr_b16 v[62:63], v5 offset:45568
    v_mfma_f32_16x16x32_bf16 v[88:91], v[40:43], v[232:235], v[88:91]
    s_waitcnt lgkmcnt(8)
    v_mfma_f32_16x16x32_bf16 v[92:95], v[44:47], v[232:235], v[92:95]
    s_barrier
    ds_read_b64_tr_b16 v[40:41], v2 offset:49152
    ds_read_b64_tr_b16 v[42:43], v2 offset:49664
    v_mfma_f32_16x16x32_bf16 v[76:79], v[44:47], v[168:171], v[76:79]
    v_xor_b32_e64 v9, 32, v8
    s_waitcnt lgkmcnt(8)
    v_mfma_f32_16x16x32_bf16 v[64:67], v[48:51], v[172:175], v[64:67]
    ds_read_b64_tr_b16 v[44:45], v3 offset:49152
    ds_read_b64_tr_b16 v[46:47], v3 offset:49664
    v_mfma_f32_16x16x32_bf16 v[80:83], v[48:51], v[236:239], v[80:83]
    s_waitcnt lgkmcnt(8)
    v_mfma_f32_16x16x32_bf16 v[84:87], v[52:55], v[236:239], v[84:87]
    ds_read_b64_tr_b16 v[48:49], v4 offset:49152
    ds_read_b64_tr_b16 v[50:51], v4 offset:49664
    v_mfma_f32_16x16x32_bf16 v[68:71], v[52:55], v[172:175], v[68:71]
    s_waitcnt lgkmcnt(8)
    v_mfma_f32_16x16x32_bf16 v[72:75], v[56:59], v[172:175], v[72:75]
    ds_read_b64_tr_b16 v[52:53], v5 offset:49152
    ds_read_b64_tr_b16 v[54:55], v5 offset:49664
    v_mfma_f32_16x16x32_bf16 v[88:91], v[56:59], v[236:239], v[88:91]
    s_waitcnt lgkmcnt(8)
    v_mfma_f32_16x16x32_bf16 v[92:95], v[60:63], v[236:239], v[92:95]
    ds_read_b64_tr_b16 v[56:57], v2 offset:53248
    ds_read_b64_tr_b16 v[58:59], v2 offset:53760
    v_mfma_f32_16x16x32_bf16 v[76:79], v[60:63], v[172:175], v[76:79]
    s_waitcnt lgkmcnt(8)
    v_mfma_f32_16x16x32_bf16 v[64:67], v[40:43], v[176:179], v[64:67]
    ds_read_b64_tr_b16 v[60:61], v3 offset:53248
    ds_read_b64_tr_b16 v[62:63], v3 offset:53760
    v_mfma_f32_16x16x32_bf16 v[80:83], v[40:43], v[240:243], v[80:83]
    s_waitcnt lgkmcnt(8)
    v_mfma_f32_16x16x32_bf16 v[84:87], v[44:47], v[240:243], v[84:87]
    ds_read_b64_tr_b16 v[40:41], v4 offset:53248
    ds_read_b64_tr_b16 v[42:43], v4 offset:53760
    v_mfma_f32_16x16x32_bf16 v[68:71], v[44:47], v[176:179], v[68:71]
    s_waitcnt lgkmcnt(8)
    v_mfma_f32_16x16x32_bf16 v[72:75], v[48:51], v[176:179], v[72:75]
    ds_read_b64_tr_b16 v[44:45], v5 offset:53248
    ds_read_b64_tr_b16 v[46:47], v5 offset:53760
    v_mfma_f32_16x16x32_bf16 v[88:91], v[48:51], v[240:243], v[88:91]
    s_waitcnt lgkmcnt(8)
    v_mfma_f32_16x16x32_bf16 v[92:95], v[52:55], v[240:243], v[92:95]
    ds_read_b64_tr_b16 v[48:49], v2 offset:57344
    ds_read_b64_tr_b16 v[50:51], v2 offset:57856
    v_mfma_f32_16x16x32_bf16 v[76:79], v[52:55], v[176:179], v[76:79]
    s_waitcnt lgkmcnt(8)
    v_mfma_f32_16x16x32_bf16 v[64:67], v[56:59], v[180:183], v[64:67]
    ds_read_b64_tr_b16 v[52:53], v3 offset:57344
    ds_read_b64_tr_b16 v[54:55], v3 offset:57856
    v_mfma_f32_16x16x32_bf16 v[80:83], v[56:59], v[244:247], v[80:83]
    s_waitcnt lgkmcnt(8)
    v_mfma_f32_16x16x32_bf16 v[84:87], v[60:63], v[244:247], v[84:87]
    ds_read_b64_tr_b16 v[56:57], v4 offset:57344
    ds_read_b64_tr_b16 v[58:59], v4 offset:57856
    v_mfma_f32_16x16x32_bf16 v[68:71], v[60:63], v[180:183], v[68:71]
    s_waitcnt lgkmcnt(8)
    v_mfma_f32_16x16x32_bf16 v[72:75], v[40:43], v[180:183], v[72:75]
    ds_read_b64_tr_b16 v[60:61], v5 offset:57344
    ds_read_b64_tr_b16 v[62:63], v5 offset:57856
    v_mfma_f32_16x16x32_bf16 v[88:91], v[40:43], v[244:247], v[88:91]
    s_waitcnt lgkmcnt(8)
    v_mfma_f32_16x16x32_bf16 v[92:95], v[44:47], v[244:247], v[92:95]
    ds_read_b64_tr_b16 v[40:41], v2 offset:61440
    ds_read_b64_tr_b16 v[42:43], v2 offset:61952
    v_mfma_f32_16x16x32_bf16 v[76:79], v[44:47], v[180:183], v[76:79]
    v_add_u32 v2, 0x10000, v2
    s_waitcnt lgkmcnt(8)
    v_mfma_f32_16x16x32_bf16 v[64:67], v[48:51], v[184:187], v[64:67]
    ds_read_b64_tr_b16 v[44:45], v3 offset:61440
    ds_read_b64_tr_b16 v[46:47], v3 offset:61952
    v_mfma_f32_16x16x32_bf16 v[80:83], v[48:51], v[248:251], v[80:83]
    v_add_u32 v3, 0x10000, v3
    s_waitcnt lgkmcnt(8)
    v_mfma_f32_16x16x32_bf16 v[84:87], v[52:55], v[248:251], v[84:87]
    ds_read_b64_tr_b16 v[48:49], v4 offset:61440
    ds_read_b64_tr_b16 v[50:51], v4 offset:61952
    v_mfma_f32_16x16x32_bf16 v[68:71], v[52:55], v[184:187], v[68:71]
    v_add_u32 v4, 0x10000, v4
    s_waitcnt lgkmcnt(8)
    v_mfma_f32_16x16x32_bf16 v[72:75], v[56:59], v[184:187], v[72:75]
    ds_read_b64_tr_b16 v[52:53], v5 offset:61440
    ds_read_b64_tr_b16 v[54:55], v5 offset:61952
    v_mfma_f32_16x16x32_bf16 v[88:91], v[56:59], v[248:251], v[88:91]
    v_add_u32 v5, 0x10000, v5
    s_waitcnt lgkmcnt(8)
    v_mfma_f32_16x16x32_bf16 v[92:95], v[60:63], v[248:251], v[92:95]
    s_barrier
    ds_read_b64_tr_b16 v[56:57], v2 offset:0
    ds_read_b64_tr_b16 v[58:59], v2 offset:512
    v_mfma_f32_16x16x32_bf16 v[76:79], v[60:63], v[184:187], v[76:79]
    s_waitcnt lgkmcnt(8)
    v_mfma_f32_16x16x32_bf16 v[64:67], v[40:43], v[188:191], v[64:67]
    ds_read_b64_tr_b16 v[60:61], v3 offset:0
    ds_read_b64_tr_b16 v[62:63], v3 offset:512
    v_mfma_f32_16x16x32_bf16 v[80:83], v[40:43], v[252:255], v[80:83]
    s_waitcnt lgkmcnt(8)
    v_mfma_f32_16x16x32_bf16 v[84:87], v[44:47], v[252:255], v[84:87]
    ds_read_b64_tr_b16 v[40:41], v4 offset:0
    ds_read_b64_tr_b16 v[42:43], v4 offset:512
    v_mfma_f32_16x16x32_bf16 v[68:71], v[44:47], v[188:191], v[68:71]
    s_waitcnt lgkmcnt(8)
    v_mfma_f32_16x16x32_bf16 v[72:75], v[48:51], v[188:191], v[72:75]
    ds_read_b64_tr_b16 v[44:45], v5 offset:0
    ds_read_b64_tr_b16 v[46:47], v5 offset:512
    v_mfma_f32_16x16x32_bf16 v[88:91], v[48:51], v[252:255], v[88:91]
    s_waitcnt lgkmcnt(8)
    v_mfma_f32_16x16x32_bf16 v[92:95], v[52:55], v[252:255], v[92:95]
    ds_read_b64_tr_b16 v[48:49], v2 offset:4096
    ds_read_b64_tr_b16 v[50:51], v2 offset:4608
    v_mfma_f32_16x16x32_bf16 v[76:79], v[52:55], v[188:191], v[76:79]
    s_waitcnt lgkmcnt(8)
    v_mfma_f32_16x16x32_bf16 v[96:99], v[56:59], v[128:131], 0
    ds_read_b64_tr_b16 v[52:53], v3 offset:4096
    ds_read_b64_tr_b16 v[54:55], v3 offset:4608
    v_mfma_f32_16x16x32_bf16 v[112:115], v[56:59], v[192:195], 0
    s_waitcnt lgkmcnt(8)
    v_mfma_f32_16x16x32_bf16 v[116:119], v[60:63], v[192:195], 0
    ds_read_b64_tr_b16 v[56:57], v4 offset:4096
    ds_read_b64_tr_b16 v[58:59], v4 offset:4608
    v_mfma_f32_16x16x32_bf16 v[100:103], v[60:63], v[128:131], 0
    s_add_u32 s66, s59, s60
    v_exp_f32_e64 v12, v64
    s_waitcnt lgkmcnt(8)
    v_mfma_f32_16x16x32_bf16 v[104:107], v[40:43], v[128:131], 0
    ds_read_b64_tr_b16 v[60:61], v5 offset:4096
    ds_read_b64_tr_b16 v[62:63], v5 offset:4608
    v_mfma_f32_16x16x32_bf16 v[120:123], v[40:43], v[192:195], 0
    v_exp_f32 v13, v65
    v_add_f32 v12, 1.0, v12
    v_rcp_f32 v12, v12
    s_waitcnt lgkmcnt(8)
    v_mfma_f32_16x16x32_bf16 v[124:127], v[44:47], v[192:195], 0
    ds_read_b64_tr_b16 v[40:41], v2 offset:8192
    ds_read_b64_tr_b16 v[42:43], v2 offset:8704
    v_mfma_f32_16x16x32_bf16 v[108:111], v[44:47], v[128:131], 0
    v_add_f32_e64 v13, 1.0, v13
    v_rcp_f32 v13, v13
    s_waitcnt lgkmcnt(8)
    v_mfma_f32_16x16x32_bf16 v[96:99], v[48:51], v[132:135], v[96:99]
    ds_read_b64_tr_b16 v[44:45], v3 offset:8192
    ds_read_b64_tr_b16 v[46:47], v3 offset:8704
    v_mfma_f32_16x16x32_bf16 v[112:115], v[48:51], v[196:199], v[112:115]
    v_mul_f32_e64 v64, v12, v64
    v_exp_f32 v14, v66
    s_waitcnt lgkmcnt(8)
    v_mfma_f32_16x16x32_bf16 v[116:119], v[52:55], v[196:199], v[116:119]
    ds_read_b64_tr_b16 v[48:49], v4 offset:8192
    ds_read_b64_tr_b16 v[50:51], v4 offset:8704
    v_mfma_f32_16x16x32_bf16 v[100:103], v[52:55], v[132:135], v[100:103]
    v_mul_f32_e64 v65, v13, v65
    v_cvt_pk_bf16_f32 v24, v64, v65
    v_exp_f32 v15, v67
    s_waitcnt lgkmcnt(8)
    v_mfma_f32_16x16x32_bf16 v[104:107], v[56:59], v[132:135], v[104:107]
    ds_read_b64_tr_b16 v[52:53], v5 offset:8192
    ds_read_b64_tr_b16 v[54:55], v5 offset:8704
    v_mfma_f32_16x16x32_bf16 v[120:123], v[56:59], v[196:199], v[120:123]
    v_add_f32_e64 v14, 1.0, v14
    v_rcp_f32 v14, v14
    s_waitcnt lgkmcnt(8)
    v_mfma_f32_16x16x32_bf16 v[124:127], v[60:63], v[196:199], v[124:127]
    ds_read_b64_tr_b16 v[56:57], v2 offset:12288
    ds_read_b64_tr_b16 v[58:59], v2 offset:12800
    v_mfma_f32_16x16x32_bf16 v[108:111], v[60:63], v[132:135], v[108:111]
    v_subrev_u32 v2, 0x10000, v2
    v_add_f32 v15, 1.0, v15
    v_rcp_f32 v15, v15
    v_mul_f32 v66, v14, v66
    s_waitcnt lgkmcnt(8)
    v_mfma_f32_16x16x32_bf16 v[96:99], v[40:43], v[136:139], v[96:99]
    ds_read_b64_tr_b16 v[60:61], v3 offset:12288
    ds_read_b64_tr_b16 v[62:63], v3 offset:12800
    v_mfma_f32_16x16x32_bf16 v[112:115], v[40:43], v[200:203], v[112:115]
    v_subrev_u32 v3, 0x10000, v3
    v_exp_f32_e64 v12, v68
    v_mul_f32 v67, v15, v67
    s_waitcnt lgkmcnt(8)
    v_mfma_f32_16x16x32_bf16 v[116:119], v[44:47], v[200:203], v[116:119]
    ds_read_b64_tr_b16 v[40:41], v4 offset:12288
    ds_read_b64_tr_b16 v[42:43], v4 offset:12800
    v_mfma_f32_16x16x32_bf16 v[100:103], v[44:47], v[136:139], v[100:103]
    v_subrev_u32 v4, 0x10000, v4
    v_cvt_pk_bf16_f32 v25, v66, v67
    v_exp_f32_e64 v13, v69
    v_add_f32 v12, 1.0, v12
    s_waitcnt lgkmcnt(8)
    v_mfma_f32_16x16x32_bf16 v[104:107], v[48:51], v[136:139], v[104:107]
    ds_read_b64_tr_b16 v[44:45], v5 offset:12288
    ds_read_b64_tr_b16 v[46:47], v5 offset:12800
    v_mfma_f32_16x16x32_bf16 v[120:123], v[48:51], v[200:203], v[120:123]
    v_subrev_u32 v5, 0x10000, v5
    v_rcp_f32_e64 v12, v12
    v_add_f32 v13, 1.0, v13
    s_waitcnt lgkmcnt(8)
    v_mfma_f32_16x16x32_bf16 v[124:127], v[52:55], v[200:203], v[124:127]
    s_barrier
    ds_read_b64_tr_b16 v[48:49], v2 offset:0
    ds_read_b64_tr_b16 v[50:51], v2 offset:512
    v_mfma_f32_16x16x32_bf16 v[108:111], v[52:55], v[136:139], v[108:111]
    v_rcp_f32 v13, v13
    v_mul_f32 v68, v12, v68
    s_waitcnt lgkmcnt(8)
    v_mfma_f32_16x16x32_bf16 v[96:99], v[56:59], v[140:143], v[96:99]
    ds_read_b64_tr_b16 v[52:53], v3 offset:0
    ds_read_b64_tr_b16 v[54:55], v3 offset:512
    v_mfma_f32_16x16x32_bf16 v[112:115], v[56:59], v[204:207], v[112:115]
    v_exp_f32 v14, v70
    v_mul_f32 v69, v13, v69
    v_cvt_pk_bf16_f32 v26, v68, v69
    s_waitcnt lgkmcnt(8)
    v_mfma_f32_16x16x32_bf16 v[116:119], v[60:63], v[204:207], v[116:119]
    ds_read_b64_tr_b16 v[56:57], v4 offset:0
    ds_read_b64_tr_b16 v[58:59], v4 offset:512
    v_mfma_f32_16x16x32_bf16 v[100:103], v[60:63], v[140:143], v[100:103]
    v_exp_f32 v15, v71
    v_add_f32 v14, 1.0, v14
    s_waitcnt lgkmcnt(8)
    v_mfma_f32_16x16x32_bf16 v[104:107], v[40:43], v[140:143], v[104:107]
    ds_read_b64_tr_b16 v[60:61], v5 offset:0
    ds_read_b64_tr_b16 v[62:63], v5 offset:512
    v_mfma_f32_16x16x32_bf16 v[120:123], v[40:43], v[204:207], v[120:123]
    v_rcp_f32 v14, v14
    v_add_f32 v15, 1.0, v15
    v_rcp_f32 v15, v15
    s_waitcnt lgkmcnt(8)
    v_mfma_f32_16x16x32_bf16 v[124:127], v[44:47], v[204:207], v[124:127]
    ds_read_b64_tr_b16 v[40:41], v2 offset:4096
    ds_read_b64_tr_b16 v[42:43], v2 offset:4608
    v_mfma_f32_16x16x32_bf16 v[108:111], v[44:47], v[140:143], v[108:111]
    v_mul_f32_e64 v70, v14, v70
    v_exp_f32 v12, v72
    s_waitcnt lgkmcnt(8)
    v_mfma_f32_16x16x32_bf16 v[96:99], v[48:51], v[144:147], v[96:99]
    ds_read_b64_tr_b16 v[44:45], v3 offset:4096
    ds_read_b64_tr_b16 v[46:47], v3 offset:4608
    v_mfma_f32_16x16x32_bf16 v[112:115], v[48:51], v[208:211], v[112:115]
    v_mul_f32_e64 v71, v15, v71
    v_cvt_pk_bf16_f32 v27, v70, v71
    v_exp_f32 v13, v73
    s_waitcnt lgkmcnt(8)
    v_mfma_f32_16x16x32_bf16 v[116:119], v[52:55], v[208:211], v[116:119]
    ds_read_b64_tr_b16 v[48:49], v4 offset:4096
    ds_read_b64_tr_b16 v[50:51], v4 offset:4608
    v_mfma_f32_16x16x32_bf16 v[100:103], v[52:55], v[144:147], v[100:103]
    v_add_f32_e64 v12, 1.0, v12
    v_rcp_f32 v12, v12
    s_waitcnt lgkmcnt(8)
    v_mfma_f32_16x16x32_bf16 v[104:107], v[56:59], v[144:147], v[104:107]
    ds_read_b64_tr_b16 v[52:53], v5 offset:4096
    ds_read_b64_tr_b16 v[54:55], v5 offset:4608
    v_mfma_f32_16x16x32_bf16 v[120:123], v[56:59], v[208:211], v[120:123]
    v_add_f32_e64 v13, 1.0, v13
    v_rcp_f32 v13, v13
    s_waitcnt lgkmcnt(8)
    v_mfma_f32_16x16x32_bf16 v[124:127], v[60:63], v[208:211], v[124:127]
    ds_read_b64_tr_b16 v[56:57], v2 offset:8192
    ds_read_b64_tr_b16 v[58:59], v2 offset:8704
    v_mfma_f32_16x16x32_bf16 v[108:111], v[60:63], v[144:147], v[108:111]
    v_mul_f32 v72, v12, v72
    v_exp_f32 v14, v74
    v_mul_f32 v73, v13, v73
    s_waitcnt lgkmcnt(8)
    v_mfma_f32_16x16x32_bf16 v[96:99], v[40:43], v[148:151], v[96:99]
    ds_read_b64_tr_b16 v[60:61], v3 offset:8192
    ds_read_b64_tr_b16 v[62:63], v3 offset:8704
    v_mfma_f32_16x16x32_bf16 v[112:115], v[40:43], v[212:215], v[112:115]
    v_cvt_pk_bf16_f32 v28, v72, v73
    v_exp_f32 v15, v75
    s_waitcnt lgkmcnt(8)
    v_mfma_f32_16x16x32_bf16 v[116:119], v[44:47], v[212:215], v[116:119]
    ds_read_b64_tr_b16 v[40:41], v4 offset:8192
    ds_read_b64_tr_b16 v[42:43], v4 offset:8704
    v_mfma_f32_16x16x32_bf16 v[100:103], v[44:47], v[148:151], v[100:103]
    v_add_f32 v14, 1.0, v14
    v_rcp_f32 v14, v14
    v_add_f32 v15, 1.0, v15
    s_waitcnt lgkmcnt(8)
    v_mfma_f32_16x16x32_bf16 v[104:107], v[48:51], v[148:151], v[104:107]
    ds_read_b64_tr_b16 v[44:45], v5 offset:8192
    ds_read_b64_tr_b16 v[46:47], v5 offset:8704
    v_mfma_f32_16x16x32_bf16 v[120:123], v[48:51], v[212:215], v[120:123]
    v_rcp_f32_e64 v15, v15
    v_mul_f32 v74, v14, v74
    s_waitcnt lgkmcnt(8)
    v_mfma_f32_16x16x32_bf16 v[124:127], v[52:55], v[212:215], v[124:127]
    ds_read_b64_tr_b16 v[48:49], v2 offset:12288
    ds_read_b64_tr_b16 v[50:51], v2 offset:12800
    v_mfma_f32_16x16x32_bf16 v[108:111], v[52:55], v[148:151], v[108:111]
    v_exp_f32 v12, v76
    v_mul_f32 v75, v15, v75
    v_cvt_pk_bf16_f32 v29, v74, v75
    s_waitcnt lgkmcnt(8)
    v_mfma_f32_16x16x32_bf16 v[96:99], v[56:59], v[152:155], v[96:99]
    ds_read_b64_tr_b16 v[52:53], v3 offset:12288
    ds_read_b64_tr_b16 v[54:55], v3 offset:12800
    v_mfma_f32_16x16x32_bf16 v[112:115], v[56:59], v[216:219], v[112:115]
    v_exp_f32 v13, v77
    v_add_f32 v12, 1.0, v12
    s_waitcnt lgkmcnt(8)
    v_mfma_f32_16x16x32_bf16 v[116:119], v[60:63], v[216:219], v[116:119]
    ds_read_b64_tr_b16 v[56:57], v4 offset:12288
    ds_read_b64_tr_b16 v[58:59], v4 offset:12800
    v_mfma_f32_16x16x32_bf16 v[100:103], v[60:63], v[152:155], v[100:103]
    v_rcp_f32_e64 v12, v12
    v_add_f32 v13, 1.0, v13
    s_waitcnt lgkmcnt(8)
    v_mfma_f32_16x16x32_bf16 v[104:107], v[40:43], v[152:155], v[104:107]
    ds_read_b64_tr_b16 v[60:61], v5 offset:12288
    ds_read_b64_tr_b16 v[62:63], v5 offset:12800
    v_mfma_f32_16x16x32_bf16 v[120:123], v[40:43], v[216:219], v[120:123]
    v_rcp_f32 v13, v13
    v_mul_f32 v76, v12, v76
    v_exp_f32 v14, v78
    s_waitcnt lgkmcnt(8)
    v_mfma_f32_16x16x32_bf16 v[124:127], v[44:47], v[216:219], v[124:127]
    s_barrier
    ds_read_b64_tr_b16 v[40:41], v2 offset:16384
    ds_read_b64_tr_b16 v[42:43], v2 offset:16896
    v_mfma_f32_16x16x32_bf16 v[108:111], v[44:47], v[152:155], v[108:111]
    v_mul_f32 v77, v13, v77
    v_cvt_pk_bf16_f32 v30, v76, v77
    s_waitcnt lgkmcnt(8)
    v_mfma_f32_16x16x32_bf16 v[96:99], v[48:51], v[156:159], v[96:99]
    ds_read_b64_tr_b16 v[44:45], v3 offset:16384
    ds_read_b64_tr_b16 v[46:47], v3 offset:16896
    v_mfma_f32_16x16x32_bf16 v[112:115], v[48:51], v[220:223], v[112:115]
    v_exp_f32 v15, v79
    v_add_f32_e64 v14, 1.0, v14
    v_rcp_f32 v14, v14
    s_waitcnt lgkmcnt(8)
    v_mfma_f32_16x16x32_bf16 v[116:119], v[52:55], v[220:223], v[116:119]
    ds_read_b64_tr_b16 v[48:49], v4 offset:16384
    ds_read_b64_tr_b16 v[50:51], v4 offset:16896
    v_mfma_f32_16x16x32_bf16 v[100:103], v[52:55], v[156:159], v[100:103]
    v_add_f32_e64 v15, 1.0, v15
    v_rcp_f32 v15, v15
    s_waitcnt lgkmcnt(8)
    v_mfma_f32_16x16x32_bf16 v[104:107], v[56:59], v[156:159], v[104:107]
    ds_read_b64_tr_b16 v[52:53], v5 offset:16384
    ds_read_b64_tr_b16 v[54:55], v5 offset:16896
    v_mfma_f32_16x16x32_bf16 v[120:123], v[56:59], v[220:223], v[120:123]
    v_mul_f32_e64 v78, v14, v78
    v_exp_f32 v12, v80
    s_waitcnt lgkmcnt(8)
    v_mfma_f32_16x16x32_bf16 v[124:127], v[60:63], v[220:223], v[124:127]
    ds_read_b64_tr_b16 v[56:57], v2 offset:20480
    ds_read_b64_tr_b16 v[58:59], v2 offset:20992
    v_mfma_f32_16x16x32_bf16 v[108:111], v[60:63], v[156:159], v[108:111]
    v_mul_f32_e64 v79, v15, v79
    v_cvt_pk_bf16_f32 v31, v78, v79
    v_exp_f32 v13, v81
    s_waitcnt lgkmcnt(8)
    v_mfma_f32_16x16x32_bf16 v[96:99], v[40:43], v[160:163], v[96:99]
    ds_read_b64_tr_b16 v[60:61], v3 offset:20480
    ds_read_b64_tr_b16 v[62:63], v3 offset:20992
    v_mfma_f32_16x16x32_bf16 v[112:115], v[40:43], v[224:227], v[112:115]
    v_add_f32_e64 v12, 1.0, v12
    v_rcp_f32 v12, v12
    s_waitcnt lgkmcnt(8)
    v_mfma_f32_16x16x32_bf16 v[116:119], v[44:47], v[224:227], v[116:119]
    ds_read_b64_tr_b16 v[40:41], v4 offset:20480
    ds_read_b64_tr_b16 v[42:43], v4 offset:20992
    v_mfma_f32_16x16x32_bf16 v[100:103], v[44:47], v[160:163], v[100:103]
    v_add_f32 v13, 1.0, v13
    v_rcp_f32 v13, v13
    v_mul_f32 v80, v12, v80
    s_waitcnt lgkmcnt(8)
    v_mfma_f32_16x16x32_bf16 v[104:107], v[48:51], v[160:163], v[104:107]
    ds_read_b64_tr_b16 v[44:45], v5 offset:20480
    ds_read_b64_tr_b16 v[46:47], v5 offset:20992
    v_mfma_f32_16x16x32_bf16 v[120:123], v[48:51], v[224:227], v[120:123]
    v_exp_f32_e64 v14, v82
    v_mul_f32 v81, v13, v81
    s_waitcnt lgkmcnt(8)
    v_mfma_f32_16x16x32_bf16 v[124:127], v[52:55], v[224:227], v[124:127]
    ds_read_b64_tr_b16 v[48:49], v2 offset:24576
    ds_read_b64_tr_b16 v[50:51], v2 offset:25088
    v_mfma_f32_16x16x32_bf16 v[108:111], v[52:55], v[160:163], v[108:111]
    v_cvt_pk_bf16_f32 v32, v80, v81
    v_exp_f32_e64 v15, v83
    v_add_f32 v14, 1.0, v14
    s_waitcnt lgkmcnt(8)
    v_mfma_f32_16x16x32_bf16 v[96:99], v[56:59], v[164:167], v[96:99]
    ds_read_b64_tr_b16 v[52:53], v3 offset:24576
    ds_read_b64_tr_b16 v[54:55], v3 offset:25088
    v_mfma_f32_16x16x32_bf16 v[112:115], v[56:59], v[228:231], v[112:115]
    v_rcp_f32_e64 v14, v14
    v_add_f32 v15, 1.0, v15
    s_waitcnt lgkmcnt(8)
    v_mfma_f32_16x16x32_bf16 v[116:119], v[60:63], v[228:231], v[116:119]
    ds_read_b64_tr_b16 v[56:57], v4 offset:24576
    ds_read_b64_tr_b16 v[58:59], v4 offset:25088
    v_mfma_f32_16x16x32_bf16 v[100:103], v[60:63], v[164:167], v[100:103]
    v_rcp_f32_e64 v15, v15
    v_mul_f32 v82, v14, v82
    s_waitcnt lgkmcnt(8)
    v_mfma_f32_16x16x32_bf16 v[104:107], v[40:43], v[164:167], v[104:107]
    ds_read_b64_tr_b16 v[60:61], v5 offset:24576
    ds_read_b64_tr_b16 v[62:63], v5 offset:25088
    v_mfma_f32_16x16x32_bf16 v[120:123], v[40:43], v[228:231], v[120:123]
    v_exp_f32 v12, v84
    v_mul_f32 v83, v15, v83
    v_cvt_pk_bf16_f32 v33, v82, v83
    s_waitcnt lgkmcnt(8)
    v_mfma_f32_16x16x32_bf16 v[124:127], v[44:47], v[228:231], v[124:127]
    ds_read_b64_tr_b16 v[40:41], v2 offset:28672
    ds_read_b64_tr_b16 v[42:43], v2 offset:29184
    v_mfma_f32_16x16x32_bf16 v[108:111], v[44:47], v[164:167], v[108:111]
    v_exp_f32 v13, v85
    v_add_f32 v12, 1.0, v12
    s_waitcnt lgkmcnt(8)
    v_mfma_f32_16x16x32_bf16 v[96:99], v[48:51], v[168:171], v[96:99]
    ds_read_b64_tr_b16 v[44:45], v3 offset:28672
    ds_read_b64_tr_b16 v[46:47], v3 offset:29184
    v_mfma_f32_16x16x32_bf16 v[112:115], v[48:51], v[232:235], v[112:115]
    v_rcp_f32 v12, v12
    v_add_f32 v13, 1.0, v13
    v_rcp_f32 v13, v13
    s_waitcnt lgkmcnt(8)
    v_mfma_f32_16x16x32_bf16 v[116:119], v[52:55], v[232:235], v[116:119]
    ds_read_b64_tr_b16 v[48:49], v4 offset:28672
    ds_read_b64_tr_b16 v[50:51], v4 offset:29184
    v_mfma_f32_16x16x32_bf16 v[100:103], v[52:55], v[168:171], v[100:103]
    v_mul_f32_e64 v84, v12, v84
    v_exp_f32 v14, v86
    s_waitcnt lgkmcnt(8)
    v_mfma_f32_16x16x32_bf16 v[104:107], v[56:59], v[168:171], v[104:107]
    ds_read_b64_tr_b16 v[52:53], v5 offset:28672
    ds_read_b64_tr_b16 v[54:55], v5 offset:29184
    v_mfma_f32_16x16x32_bf16 v[120:123], v[56:59], v[232:235], v[120:123]
    v_mul_f32_e64 v85, v13, v85
    v_cvt_pk_bf16_f32 v34, v84, v85
    v_exp_f32 v15, v87
    s_waitcnt lgkmcnt(8)
    v_mfma_f32_16x16x32_bf16 v[124:127], v[60:63], v[232:235], v[124:127]
    s_barrier
    ds_read_b64_tr_b16 v[56:57], v2 offset:32768
    ds_read_b64_tr_b16 v[58:59], v2 offset:33280
    v_mfma_f32_16x16x32_bf16 v[108:111], v[60:63], v[168:171], v[108:111]
    v_add_f32 v14, 1.0, v14
    v_rcp_f32 v14, v14
    s_waitcnt lgkmcnt(8)
    v_mfma_f32_16x16x32_bf16 v[96:99], v[40:43], v[172:175], v[96:99]
    ds_read_b64_tr_b16 v[60:61], v3 offset:32768
    ds_read_b64_tr_b16 v[62:63], v3 offset:33280
    v_mfma_f32_16x16x32_bf16 v[112:115], v[40:43], v[236:239], v[112:115]
    v_add_f32_e64 v15, 1.0, v15
    v_rcp_f32 v15, v15
    s_waitcnt lgkmcnt(8)
    v_mfma_f32_16x16x32_bf16 v[116:119], v[44:47], v[236:239], v[116:119]
    ds_read_b64_tr_b16 v[40:41], v4 offset:32768
    ds_read_b64_tr_b16 v[42:43], v4 offset:33280
    v_mfma_f32_16x16x32_bf16 v[100:103], v[44:47], v[172:175], v[100:103]
    v_mul_f32 v86, v14, v86
    v_exp_f32 v12, v88
    v_mul_f32 v87, v15, v87
    s_waitcnt lgkmcnt(8)
    v_mfma_f32_16x16x32_bf16 v[104:107], v[48:51], v[172:175], v[104:107]
    ds_read_b64_tr_b16 v[44:45], v5 offset:32768
    ds_read_b64_tr_b16 v[46:47], v5 offset:33280
    v_mfma_f32_16x16x32_bf16 v[120:123], v[48:51], v[236:239], v[120:123]
    v_cvt_pk_bf16_f32 v35, v86, v87
    v_exp_f32 v13, v89
    s_waitcnt lgkmcnt(8)
    v_mfma_f32_16x16x32_bf16 v[124:127], v[52:55], v[236:239], v[124:127]
    ds_read_b64_tr_b16 v[48:49], v2 offset:36864
    ds_read_b64_tr_b16 v[50:51], v2 offset:37376
    v_mfma_f32_16x16x32_bf16 v[108:111], v[52:55], v[172:175], v[108:111]
    v_add_f32 v12, 1.0, v12
    v_rcp_f32 v12, v12
    v_add_f32 v13, 1.0, v13
    s_waitcnt lgkmcnt(8)
    v_mfma_f32_16x16x32_bf16 v[96:99], v[56:59], v[176:179], v[96:99]
    ds_read_b64_tr_b16 v[52:53], v3 offset:36864
    ds_read_b64_tr_b16 v[54:55], v3 offset:37376
    v_mfma_f32_16x16x32_bf16 v[112:115], v[56:59], v[240:243], v[112:115]
    v_rcp_f32_e64 v13, v13
    v_mul_f32 v88, v12, v88
    s_waitcnt lgkmcnt(8)
    v_mfma_f32_16x16x32_bf16 v[116:119], v[60:63], v[240:243], v[116:119]
    ds_read_b64_tr_b16 v[56:57], v4 offset:36864
    ds_read_b64_tr_b16 v[58:59], v4 offset:37376
    v_mfma_f32_16x16x32_bf16 v[100:103], v[60:63], v[176:179], v[100:103]
    v_exp_f32 v14, v90
    v_mul_f32 v89, v13, v89
    v_cvt_pk_bf16_f32 v36, v88, v89
    s_waitcnt lgkmcnt(8)
    v_mfma_f32_16x16x32_bf16 v[104:107], v[40:43], v[176:179], v[104:107]
    ds_read_b64_tr_b16 v[60:61], v5 offset:36864
    ds_read_b64_tr_b16 v[62:63], v5 offset:37376
    v_mfma_f32_16x16x32_bf16 v[120:123], v[40:43], v[240:243], v[120:123]
    v_exp_f32 v15, v91
    v_add_f32 v14, 1.0, v14
    s_waitcnt lgkmcnt(8)
    v_mfma_f32_16x16x32_bf16 v[124:127], v[44:47], v[240:243], v[124:127]
    ds_read_b64_tr_b16 v[40:41], v2 offset:40960
    ds_read_b64_tr_b16 v[42:43], v2 offset:41472
    v_mfma_f32_16x16x32_bf16 v[108:111], v[44:47], v[176:179], v[108:111]
    v_rcp_f32_e64 v14, v14
    v_add_f32 v15, 1.0, v15
    s_waitcnt lgkmcnt(8)
    v_mfma_f32_16x16x32_bf16 v[96:99], v[48:51], v[180:183], v[96:99]
    ds_read_b64_tr_b16 v[44:45], v3 offset:40960
    ds_read_b64_tr_b16 v[46:47], v3 offset:41472
    v_mfma_f32_16x16x32_bf16 v[112:115], v[48:51], v[244:247], v[112:115]
    v_rcp_f32 v15, v15
    v_mul_f32 v90, v14, v90
    v_exp_f32 v12, v92
    s_waitcnt lgkmcnt(8)
    v_mfma_f32_16x16x32_bf16 v[116:119], v[52:55], v[244:247], v[116:119]
    ds_read_b64_tr_b16 v[48:49], v4 offset:40960
    ds_read_b64_tr_b16 v[50:51], v4 offset:41472
    v_mfma_f32_16x16x32_bf16 v[100:103], v[52:55], v[180:183], v[100:103]
    v_mul_f32_e64 v91, v15, v91
    v_cvt_pk_bf16_f32 v37, v90, v91
    s_waitcnt lgkmcnt(8)
    v_mfma_f32_16x16x32_bf16 v[104:107], v[56:59], v[180:183], v[104:107]
    ds_read_b64_tr_b16 v[52:53], v5 offset:40960
    ds_read_b64_tr_b16 v[54:55], v5 offset:41472
    v_mfma_f32_16x16x32_bf16 v[120:123], v[56:59], v[244:247], v[120:123]
    v_exp_f32 v13, v93
    v_add_f32_e64 v12, 1.0, v12
    v_rcp_f32 v12, v12
    s_waitcnt lgkmcnt(8)
    v_mfma_f32_16x16x32_bf16 v[124:127], v[60:63], v[244:247], v[124:127]
    ds_read_b64_tr_b16 v[56:57], v2 offset:45056
    ds_read_b64_tr_b16 v[58:59], v2 offset:45568
    v_mfma_f32_16x16x32_bf16 v[108:111], v[60:63], v[180:183], v[108:111]
    v_add_f32_e64 v13, 1.0, v13
    v_rcp_f32 v13, v13
    s_waitcnt lgkmcnt(8)
    v_mfma_f32_16x16x32_bf16 v[96:99], v[40:43], v[184:187], v[96:99]
    ds_read_b64_tr_b16 v[60:61], v3 offset:45056
    ds_read_b64_tr_b16 v[62:63], v3 offset:45568
    v_mfma_f32_16x16x32_bf16 v[112:115], v[40:43], v[248:251], v[112:115]
    v_mul_f32_e64 v92, v12, v92
    v_exp_f32 v14, v94
    s_waitcnt lgkmcnt(8)
    v_mfma_f32_16x16x32_bf16 v[116:119], v[44:47], v[248:251], v[116:119]
    ds_read_b64_tr_b16 v[40:41], v4 offset:45056
    ds_read_b64_tr_b16 v[42:43], v4 offset:45568
    v_mfma_f32_16x16x32_bf16 v[100:103], v[44:47], v[184:187], v[100:103]
    v_mul_f32_e64 v93, v13, v93
    v_cvt_pk_bf16_f32 v38, v92, v93
    v_exp_f32 v15, v95
    s_waitcnt lgkmcnt(8)
    v_mfma_f32_16x16x32_bf16 v[104:107], v[48:51], v[184:187], v[104:107]
    ds_read_b64_tr_b16 v[44:45], v5 offset:45056
    ds_read_b64_tr_b16 v[46:47], v5 offset:45568
    v_mfma_f32_16x16x32_bf16 v[120:123], v[48:51], v[248:251], v[120:123]
    v_add_f32_e64 v14, 1.0, v14
    v_rcp_f32 v14, v14
    s_waitcnt lgkmcnt(8)
    v_mfma_f32_16x16x32_bf16 v[124:127], v[52:55], v[248:251], v[124:127]
    s_barrier
    ds_read_b64_tr_b16 v[48:49], v2 offset:49152
    ds_read_b64_tr_b16 v[50:51], v2 offset:49664
    v_mfma_f32_16x16x32_bf16 v[108:111], v[52:55], v[184:187], v[108:111]
    v_add_f32 v15, 1.0, v15
    v_rcp_f32_e64 v15, v15
    v_mul_f32 v94, v14, v94
    s_waitcnt lgkmcnt(8)
    v_mfma_f32_16x16x32_bf16 v[96:99], v[56:59], v[188:191], v[96:99]
    ds_read_b64_tr_b16 v[52:53], v3 offset:49152
    ds_read_b64_tr_b16 v[54:55], v3 offset:49664
    v_mfma_f32_16x16x32_bf16 v[112:115], v[56:59], v[252:255], v[112:115]
    v_mul_f32_e64 v95, v15, v95
    v_cvt_pk_bf16_f32 v39, v94, v95
    s_waitcnt lgkmcnt(8)
    v_mfma_f32_16x16x32_bf16 v[116:119], v[60:63], v[252:255], v[116:119]
    ds_read_b64_tr_b16 v[56:57], v4 offset:49152
    ds_read_b64_tr_b16 v[58:59], v4 offset:49664
    v_mfma_f32_16x16x32_bf16 v[100:103], v[60:63], v[188:191], v[100:103]
    s_waitcnt lgkmcnt(8)
    v_mfma_f32_16x16x32_bf16 v[104:107], v[40:43], v[188:191], v[104:107]
    ds_read_b64_tr_b16 v[60:61], v5 offset:49152
    ds_read_b64_tr_b16 v[62:63], v5 offset:49664
    v_mfma_f32_16x16x32_bf16 v[120:123], v[40:43], v[252:255], v[120:123]
    buffer_store_dwordx4 v[24:27], v1, s[32:35], s66 offen offset:0 sc1
    buffer_store_dwordx4 v[28:31], v1, s[32:35], s66 offen offset:2048 sc1
    buffer_store_dwordx4 v[32:35], v6, s[32:35], s66 offen offset:0 sc1
    buffer_store_dwordx4 v[36:39], v6, s[32:35], s66 offen offset:2048 sc1
    s_waitcnt lgkmcnt(8)
    v_mfma_f32_16x16x32_bf16 v[124:127], v[44:47], v[252:255], v[124:127]
    ds_read_b64_tr_b16 v[40:41], v2 offset:53248
    ds_read_b64_tr_b16 v[42:43], v2 offset:53760
    v_mfma_f32_16x16x32_bf16 v[108:111], v[44:47], v[188:191], v[108:111]
    s_waitcnt lgkmcnt(8)
    v_mfma_f32_16x16x32_bf16 v[64:67], v[48:51], v[128:131], 0
    ds_read_b64_tr_b16 v[44:45], v3 offset:53248
    ds_read_b64_tr_b16 v[46:47], v3 offset:53760
    v_mfma_f32_16x16x32_bf16 v[80:83], v[48:51], v[192:195], 0
    s_waitcnt lgkmcnt(8)
    v_mfma_f32_16x16x32_bf16 v[84:87], v[52:55], v[192:195], 0
    ds_read_b64_tr_b16 v[48:49], v4 offset:53248
    ds_read_b64_tr_b16 v[50:51], v4 offset:53760
    v_mfma_f32_16x16x32_bf16 v[68:71], v[52:55], v[128:131], 0
    s_add_u32 s66, s59, s61
    v_exp_f32 v12, v96
    s_waitcnt lgkmcnt(8)
    v_mfma_f32_16x16x32_bf16 v[72:75], v[56:59], v[128:131], 0
    ds_read_b64_tr_b16 v[52:53], v5 offset:53248
    ds_read_b64_tr_b16 v[54:55], v5 offset:53760
    v_mfma_f32_16x16x32_bf16 v[88:91], v[56:59], v[192:195], 0
    v_exp_f32 v13, v97
    v_add_f32 v12, 1.0, v12
    v_rcp_f32 v12, v12
    s_waitcnt lgkmcnt(8)
    v_mfma_f32_16x16x32_bf16 v[92:95], v[60:63], v[192:195], 0
    ds_read_b64_tr_b16 v[56:57], v2 offset:57344
    ds_read_b64_tr_b16 v[58:59], v2 offset:57856
    v_mfma_f32_16x16x32_bf16 v[76:79], v[60:63], v[128:131], 0
    v_add_f32_e64 v13, 1.0, v13
    v_rcp_f32 v13, v13
    s_waitcnt lgkmcnt(8)
    v_mfma_f32_16x16x32_bf16 v[64:67], v[40:43], v[132:135], v[64:67]
    ds_read_b64_tr_b16 v[60:61], v3 offset:57344
    ds_read_b64_tr_b16 v[62:63], v3 offset:57856
    v_mfma_f32_16x16x32_bf16 v[80:83], v[40:43], v[196:199], v[80:83]
    v_mul_f32_e64 v96, v12, v96
    v_exp_f32 v14, v98
    s_waitcnt lgkmcnt(8)
    v_mfma_f32_16x16x32_bf16 v[84:87], v[44:47], v[196:199], v[84:87]
    ds_read_b64_tr_b16 v[40:41], v4 offset:57344
    ds_read_b64_tr_b16 v[42:43], v4 offset:57856
    v_mfma_f32_16x16x32_bf16 v[68:71], v[44:47], v[132:135], v[68:71]
    v_mul_f32_e64 v97, v13, v97
    v_cvt_pk_bf16_f32 v24, v96, v97
    v_exp_f32 v15, v99
    s_waitcnt lgkmcnt(8)
    v_mfma_f32_16x16x32_bf16 v[72:75], v[48:51], v[132:135], v[72:75]
    ds_read_b64_tr_b16 v[44:45], v5 offset:57344
    ds_read_b64_tr_b16 v[46:47], v5 offset:57856
    v_mfma_f32_16x16x32_bf16 v[88:91], v[48:51], v[196:199], v[88:91]
    v_add_f32_e64 v14, 1.0, v14
    v_rcp_f32 v14, v14
    s_waitcnt lgkmcnt(8)
    v_mfma_f32_16x16x32_bf16 v[92:95], v[52:55], v[196:199], v[92:95]
    ds_read_b64_tr_b16 v[48:49], v2 offset:61440
    ds_read_b64_tr_b16 v[50:51], v2 offset:61952
    v_mfma_f32_16x16x32_bf16 v[76:79], v[52:55], v[132:135], v[76:79]
    v_add_u32 v2, 0x10000, v2
    v_add_f32 v15, 1.0, v15
    v_rcp_f32 v15, v15
    v_mul_f32 v98, v14, v98
    s_waitcnt lgkmcnt(8)
    v_mfma_f32_16x16x32_bf16 v[64:67], v[56:59], v[136:139], v[64:67]
    ds_read_b64_tr_b16 v[52:53], v3 offset:61440
    ds_read_b64_tr_b16 v[54:55], v3 offset:61952
    v_mfma_f32_16x16x32_bf16 v[80:83], v[56:59], v[200:203], v[80:83]
    v_add_u32 v3, 0x10000, v3
    v_exp_f32_e64 v12, v100
    v_mul_f32 v99, v15, v99
    s_waitcnt lgkmcnt(8)
    v_mfma_f32_16x16x32_bf16 v[84:87], v[60:63], v[200:203], v[84:87]
    ds_read_b64_tr_b16 v[56:57], v4 offset:61440
    ds_read_b64_tr_b16 v[58:59], v4 offset:61952
    v_mfma_f32_16x16x32_bf16 v[68:71], v[60:63], v[136:139], v[68:71]
    v_add_u32 v4, 0x10000, v4
    v_cvt_pk_bf16_f32 v25, v98, v99
    v_exp_f32_e64 v13, v101
    v_add_f32 v12, 1.0, v12
    s_waitcnt lgkmcnt(8)
    v_mfma_f32_16x16x32_bf16 v[72:75], v[40:43], v[136:139], v[72:75]
    ds_read_b64_tr_b16 v[60:61], v5 offset:61440
    ds_read_b64_tr_b16 v[62:63], v5 offset:61952
    v_mfma_f32_16x16x32_bf16 v[88:91], v[40:43], v[200:203], v[88:91]
    v_add_u32 v5, 0x10000, v5
    v_rcp_f32_e64 v12, v12
    v_add_f32 v13, 1.0, v13
    s_waitcnt lgkmcnt(8)
    v_mfma_f32_16x16x32_bf16 v[92:95], v[44:47], v[200:203], v[92:95]
    s_barrier
    ds_read_b64_tr_b16 v[40:41], v2 offset:0
    ds_read_b64_tr_b16 v[42:43], v2 offset:512
    v_mfma_f32_16x16x32_bf16 v[76:79], v[44:47], v[136:139], v[76:79]
    v_rcp_f32 v13, v13
    v_mul_f32 v100, v12, v100
    s_waitcnt lgkmcnt(8)
    v_mfma_f32_16x16x32_bf16 v[64:67], v[48:51], v[140:143], v[64:67]
    ds_read_b64_tr_b16 v[44:45], v3 offset:0
    ds_read_b64_tr_b16 v[46:47], v3 offset:512
    v_mfma_f32_16x16x32_bf16 v[80:83], v[48:51], v[204:207], v[80:83]
    v_exp_f32 v14, v102
    v_mul_f32 v101, v13, v101
    v_cvt_pk_bf16_f32 v26, v100, v101
    s_waitcnt lgkmcnt(8)
    v_mfma_f32_16x16x32_bf16 v[84:87], v[52:55], v[204:207], v[84:87]
    ds_read_b64_tr_b16 v[48:49], v4 offset:0
    ds_read_b64_tr_b16 v[50:51], v4 offset:512
    v_mfma_f32_16x16x32_bf16 v[68:71], v[52:55], v[140:143], v[68:71]
    v_exp_f32 v15, v103
    v_add_f32 v14, 1.0, v14
    s_waitcnt lgkmcnt(8)
    v_mfma_f32_16x16x32_bf16 v[72:75], v[56:59], v[140:143], v[72:75]
    ds_read_b64_tr_b16 v[52:53], v5 offset:0
    ds_read_b64_tr_b16 v[54:55], v5 offset:512
    v_mfma_f32_16x16x32_bf16 v[88:91], v[56:59], v[204:207], v[88:91]
    v_rcp_f32 v14, v14
    v_add_f32 v15, 1.0, v15
    v_rcp_f32 v15, v15
    s_waitcnt lgkmcnt(8)
    v_mfma_f32_16x16x32_bf16 v[92:95], v[60:63], v[204:207], v[92:95]
    ds_read_b64_tr_b16 v[56:57], v2 offset:4096
    ds_read_b64_tr_b16 v[58:59], v2 offset:4608
    v_mfma_f32_16x16x32_bf16 v[76:79], v[60:63], v[140:143], v[76:79]
    v_mul_f32_e64 v102, v14, v102
    v_exp_f32 v12, v104
    s_waitcnt lgkmcnt(8)
    v_mfma_f32_16x16x32_bf16 v[64:67], v[40:43], v[144:147], v[64:67]
    ds_read_b64_tr_b16 v[60:61], v3 offset:4096
    ds_read_b64_tr_b16 v[62:63], v3 offset:4608
    v_mfma_f32_16x16x32_bf16 v[80:83], v[40:43], v[208:211], v[80:83]
    v_mul_f32_e64 v103, v15, v103
    v_cvt_pk_bf16_f32 v27, v102, v103
    v_exp_f32 v13, v105
    s_waitcnt lgkmcnt(8)
    v_mfma_f32_16x16x32_bf16 v[84:87], v[44:47], v[208:211], v[84:87]
    ds_read_b64_tr_b16 v[40:41], v4 offset:4096
    ds_read_b64_tr_b16 v[42:43], v4 offset:4608
    v_mfma_f32_16x16x32_bf16 v[68:71], v[44:47], v[144:147], v[68:71]
    v_add_f32_e64 v12, 1.0, v12
    v_rcp_f32 v12, v12
    s_waitcnt lgkmcnt(8)
    v_mfma_f32_16x16x32_bf16 v[72:75], v[48:51], v[144:147], v[72:75]
    ds_read_b64_tr_b16 v[44:45], v5 offset:4096
    ds_read_b64_tr_b16 v[46:47], v5 offset:4608
    v_mfma_f32_16x16x32_bf16 v[88:91], v[48:51], v[208:211], v[88:91]
    v_add_f32_e64 v13, 1.0, v13
    v_rcp_f32 v13, v13
    s_waitcnt lgkmcnt(8)
    v_mfma_f32_16x16x32_bf16 v[92:95], v[52:55], v[208:211], v[92:95]
    ds_read_b64_tr_b16 v[48:49], v2 offset:8192
    ds_read_b64_tr_b16 v[50:51], v2 offset:8704
    v_mfma_f32_16x16x32_bf16 v[76:79], v[52:55], v[144:147], v[76:79]
    v_mul_f32 v104, v12, v104
    v_exp_f32 v14, v106
    v_mul_f32 v105, v13, v105
    s_waitcnt lgkmcnt(8)
    v_mfma_f32_16x16x32_bf16 v[64:67], v[56:59], v[148:151], v[64:67]
    ds_read_b64_tr_b16 v[52:53], v3 offset:8192
    ds_read_b64_tr_b16 v[54:55], v3 offset:8704
    v_mfma_f32_16x16x32_bf16 v[80:83], v[56:59], v[212:215], v[80:83]
    v_cvt_pk_bf16_f32 v28, v104, v105
    v_exp_f32 v15, v107
    s_waitcnt lgkmcnt(8)
    v_mfma_f32_16x16x32_bf16 v[84:87], v[60:63], v[212:215], v[84:87]
    ds_read_b64_tr_b16 v[56:57], v4 offset:8192
    ds_read_b64_tr_b16 v[58:59], v4 offset:8704
    v_mfma_f32_16x16x32_bf16 v[68:71], v[60:63], v[148:151], v[68:71]
    v_add_f32 v14, 1.0, v14
    v_rcp_f32 v14, v14
    v_add_f32 v15, 1.0, v15
    s_waitcnt lgkmcnt(8)
    v_mfma_f32_16x16x32_bf16 v[72:75], v[40:43], v[148:151], v[72:75]
    ds_read_b64_tr_b16 v[60:61], v5 offset:8192
    ds_read_b64_tr_b16 v[62:63], v5 offset:8704
    v_mfma_f32_16x16x32_bf16 v[88:91], v[40:43], v[212:215], v[88:91]
    v_rcp_f32_e64 v15, v15
    v_mul_f32 v106, v14, v106
    s_waitcnt lgkmcnt(8)
    v_mfma_f32_16x16x32_bf16 v[92:95], v[44:47], v[212:215], v[92:95]
    ds_read_b64_tr_b16 v[40:41], v2 offset:12288
    ds_read_b64_tr_b16 v[42:43], v2 offset:12800
    v_mfma_f32_16x16x32_bf16 v[76:79], v[44:47], v[148:151], v[76:79]
    v_subrev_u32 v2, 0x10000, v2
    v_exp_f32 v12, v108
    v_mul_f32 v107, v15, v107
    v_cvt_pk_bf16_f32 v29, v106, v107
    s_waitcnt vmcnt(0)
    s_atomic_swap s52, s[70:71], 0
    s_waitcnt lgkmcnt(8)
    v_mfma_f32_16x16x32_bf16 v[64:67], v[48:51], v[152:155], v[64:67]
    ds_read_b64_tr_b16 v[44:45], v3 offset:12288
    ds_read_b64_tr_b16 v[46:47], v3 offset:12800
    v_mfma_f32_16x16x32_bf16 v[80:83], v[48:51], v[216:219], v[80:83]
    v_subrev_u32 v3, 0x10000, v3
    v_exp_f32_e64 v13, v109
    v_add_f32 v12, 1.0, v12
    s_waitcnt lgkmcnt(8)
    v_mfma_f32_16x16x32_bf16 v[84:87], v[52:55], v[216:219], v[84:87]
    ds_read_b64_tr_b16 v[48:49], v4 offset:12288
    ds_read_b64_tr_b16 v[50:51], v4 offset:12800
    v_mfma_f32_16x16x32_bf16 v[68:71], v[52:55], v[152:155], v[68:71]
    v_subrev_u32 v4, 0x10000, v4
    v_rcp_f32_e64 v12, v12
    v_add_f32 v13, 1.0, v13
    s_waitcnt lgkmcnt(8)
    v_mfma_f32_16x16x32_bf16 v[72:75], v[56:59], v[152:155], v[72:75]
    ds_read_b64_tr_b16 v[52:53], v5 offset:12288
    ds_read_b64_tr_b16 v[54:55], v5 offset:12800
    v_mfma_f32_16x16x32_bf16 v[88:91], v[56:59], v[216:219], v[88:91]
    v_subrev_u32 v5, 0x10000, v5
    v_rcp_f32 v13, v13
    v_mul_f32 v108, v12, v108
    v_exp_f32 v14, v110
    s_waitcnt lgkmcnt(8)
    v_mfma_f32_16x16x32_bf16 v[92:95], v[60:63], v[216:219], v[92:95]
    s_barrier
    ds_read_b64_tr_b16 v[56:57], v2 offset:0
    ds_read_b64_tr_b16 v[58:59], v2 offset:512
    v_mfma_f32_16x16x32_bf16 v[76:79], v[60:63], v[152:155], v[76:79]
    v_mul_f32 v109, v13, v109
    v_cvt_pk_bf16_f32 v30, v108, v109
    s_waitcnt lgkmcnt(8)
    v_mfma_f32_16x16x32_bf16 v[64:67], v[40:43], v[156:159], v[64:67]
    ds_read_b64_tr_b16 v[60:61], v3 offset:0
    ds_read_b64_tr_b16 v[62:63], v3 offset:512
    v_mfma_f32_16x16x32_bf16 v[80:83], v[40:43], v[220:223], v[80:83]
    v_exp_f32 v15, v111
    v_add_f32_e64 v14, 1.0, v14
    v_rcp_f32 v14, v14
    s_waitcnt lgkmcnt(8)
    v_mfma_f32_16x16x32_bf16 v[84:87], v[44:47], v[220:223], v[84:87]
    ds_read_b64_tr_b16 v[40:41], v4 offset:0
    ds_read_b64_tr_b16 v[42:43], v4 offset:512
    v_mfma_f32_16x16x32_bf16 v[68:71], v[44:47], v[156:159], v[68:71]
    v_add_f32_e64 v15, 1.0, v15
    v_rcp_f32 v15, v15
    s_waitcnt lgkmcnt(8)
    v_mfma_f32_16x16x32_bf16 v[72:75], v[48:51], v[156:159], v[72:75]
    ds_read_b64_tr_b16 v[44:45], v5 offset:0
    ds_read_b64_tr_b16 v[46:47], v5 offset:512
    v_mfma_f32_16x16x32_bf16 v[88:91], v[48:51], v[220:223], v[88:91]
    v_mul_f32_e64 v110, v14, v110
    v_exp_f32 v12, v112
    s_waitcnt lgkmcnt(8)
    v_mfma_f32_16x16x32_bf16 v[92:95], v[52:55], v[220:223], v[92:95]
    ds_read_b64_tr_b16 v[48:49], v2 offset:4096
    ds_read_b64_tr_b16 v[50:51], v2 offset:4608
    v_mfma_f32_16x16x32_bf16 v[76:79], v[52:55], v[156:159], v[76:79]
    v_mul_f32_e64 v111, v15, v111
    v_cvt_pk_bf16_f32 v31, v110, v111
    v_exp_f32 v13, v113
    s_waitcnt lgkmcnt(8)
    v_mfma_f32_16x16x32_bf16 v[64:67], v[56:59], v[160:163], v[64:67]
    ds_read_b64_tr_b16 v[52:53], v3 offset:4096
    ds_read_b64_tr_b16 v[54:55], v3 offset:4608
    v_mfma_f32_16x16x32_bf16 v[80:83], v[56:59], v[224:227], v[80:83]
    v_add_f32_e64 v12, 1.0, v12
    v_rcp_f32 v12, v12
    s_waitcnt lgkmcnt(8)
    v_mfma_f32_16x16x32_bf16 v[84:87], v[60:63], v[224:227], v[84:87]
    ds_read_b64_tr_b16 v[56:57], v4 offset:4096
    ds_read_b64_tr_b16 v[58:59], v4 offset:4608
    v_mfma_f32_16x16x32_bf16 v[68:71], v[60:63], v[160:163], v[68:71]
    v_add_f32 v13, 1.0, v13
    v_rcp_f32 v13, v13
    v_mul_f32 v112, v12, v112
    s_waitcnt lgkmcnt(8)
    v_mfma_f32_16x16x32_bf16 v[72:75], v[40:43], v[160:163], v[72:75]
    ds_read_b64_tr_b16 v[60:61], v5 offset:4096
    ds_read_b64_tr_b16 v[62:63], v5 offset:4608
    v_mfma_f32_16x16x32_bf16 v[88:91], v[40:43], v[224:227], v[88:91]
    v_exp_f32_e64 v14, v114
    v_mul_f32 v113, v13, v113
    s_waitcnt lgkmcnt(8)
    v_mfma_f32_16x16x32_bf16 v[92:95], v[44:47], v[224:227], v[92:95]
    ds_read_b64_tr_b16 v[40:41], v2 offset:8192
    ds_read_b64_tr_b16 v[42:43], v2 offset:8704
    v_mfma_f32_16x16x32_bf16 v[76:79], v[44:47], v[160:163], v[76:79]
    v_cvt_pk_bf16_f32 v32, v112, v113
    v_exp_f32_e64 v15, v115
    v_add_f32 v14, 1.0, v14
    s_waitcnt lgkmcnt(8)
    v_mfma_f32_16x16x32_bf16 v[64:67], v[48:51], v[164:167], v[64:67]
    ds_read_b64_tr_b16 v[44:45], v3 offset:8192
    ds_read_b64_tr_b16 v[46:47], v3 offset:8704
    v_mfma_f32_16x16x32_bf16 v[80:83], v[48:51], v[228:231], v[80:83]
    v_rcp_f32_e64 v14, v14
    v_add_f32 v15, 1.0, v15
    s_waitcnt lgkmcnt(8)
    v_mfma_f32_16x16x32_bf16 v[84:87], v[52:55], v[228:231], v[84:87]
    ds_read_b64_tr_b16 v[48:49], v4 offset:8192
    ds_read_b64_tr_b16 v[50:51], v4 offset:8704
    v_mfma_f32_16x16x32_bf16 v[68:71], v[52:55], v[164:167], v[68:71]
    v_rcp_f32_e64 v15, v15
    v_mul_f32 v114, v14, v114
    s_waitcnt lgkmcnt(8)
    v_mfma_f32_16x16x32_bf16 v[72:75], v[56:59], v[164:167], v[72:75]
    ds_read_b64_tr_b16 v[52:53], v5 offset:8192
    ds_read_b64_tr_b16 v[54:55], v5 offset:8704
    v_mfma_f32_16x16x32_bf16 v[88:91], v[56:59], v[228:231], v[88:91]
    v_exp_f32 v12, v116
    v_mul_f32 v115, v15, v115
    v_cvt_pk_bf16_f32 v33, v114, v115
    s_waitcnt lgkmcnt(8)
    v_mfma_f32_16x16x32_bf16 v[92:95], v[60:63], v[228:231], v[92:95]
    ds_read_b64_tr_b16 v[56:57], v2 offset:12288
    ds_read_b64_tr_b16 v[58:59], v2 offset:12800
    v_mfma_f32_16x16x32_bf16 v[76:79], v[60:63], v[164:167], v[76:79]
    v_exp_f32 v13, v117
    v_add_f32 v12, 1.0, v12
    s_waitcnt lgkmcnt(8)
    v_mfma_f32_16x16x32_bf16 v[64:67], v[40:43], v[168:171], v[64:67]
    ds_read_b64_tr_b16 v[60:61], v3 offset:12288
    ds_read_b64_tr_b16 v[62:63], v3 offset:12800
    v_mfma_f32_16x16x32_bf16 v[80:83], v[40:43], v[232:235], v[80:83]
    v_rcp_f32 v12, v12
    v_add_f32 v13, 1.0, v13
    v_rcp_f32 v13, v13
    s_waitcnt lgkmcnt(8)
    v_mfma_f32_16x16x32_bf16 v[84:87], v[44:47], v[232:235], v[84:87]
    ds_read_b64_tr_b16 v[40:41], v4 offset:12288
    ds_read_b64_tr_b16 v[42:43], v4 offset:12800
    v_mfma_f32_16x16x32_bf16 v[68:71], v[44:47], v[168:171], v[68:71]
    v_mul_f32_e64 v116, v12, v116
    v_exp_f32 v14, v118
    s_waitcnt lgkmcnt(8)
    v_mfma_f32_16x16x32_bf16 v[72:75], v[48:51], v[168:171], v[72:75]
    ds_read_b64_tr_b16 v[44:45], v5 offset:12288
    ds_read_b64_tr_b16 v[46:47], v5 offset:12800
    v_mfma_f32_16x16x32_bf16 v[88:91], v[48:51], v[232:235], v[88:91]
    v_mul_f32_e64 v117, v13, v117
    v_cvt_pk_bf16_f32 v34, v116, v117
    v_exp_f32 v15, v119
    s_waitcnt lgkmcnt(8)
    v_mfma_f32_16x16x32_bf16 v[92:95], v[52:55], v[232:235], v[92:95]
    s_barrier
    ds_read_b64_tr_b16 v[48:49], v2 offset:16384
    ds_read_b64_tr_b16 v[50:51], v2 offset:16896
    v_mfma_f32_16x16x32_bf16 v[76:79], v[52:55], v[168:171], v[76:79]
    v_add_f32 v14, 1.0, v14
    v_rcp_f32 v14, v14
    s_waitcnt lgkmcnt(8)
    v_mfma_f32_16x16x32_bf16 v[64:67], v[56:59], v[172:175], v[64:67]
    ds_read_b64_tr_b16 v[52:53], v3 offset:16384
    ds_read_b64_tr_b16 v[54:55], v3 offset:16896
    v_mfma_f32_16x16x32_bf16 v[80:83], v[56:59], v[236:239], v[80:83]
    v_add_f32_e64 v15, 1.0, v15
    v_rcp_f32 v15, v15
    s_waitcnt lgkmcnt(8)
    v_mfma_f32_16x16x32_bf16 v[84:87], v[60:63], v[236:239], v[84:87]
    ds_read_b64_tr_b16 v[56:57], v4 offset:16384
    ds_read_b64_tr_b16 v[58:59], v4 offset:16896
    v_mfma_f32_16x16x32_bf16 v[68:71], v[60:63], v[172:175], v[68:71]
    v_mul_f32 v118, v14, v118
    v_exp_f32 v12, v120
    v_mul_f32 v119, v15, v119
    s_waitcnt lgkmcnt(8)
    v_mfma_f32_16x16x32_bf16 v[72:75], v[40:43], v[172:175], v[72:75]
    ds_read_b64_tr_b16 v[60:61], v5 offset:16384
    ds_read_b64_tr_b16 v[62:63], v5 offset:16896
    v_mfma_f32_16x16x32_bf16 v[88:91], v[40:43], v[236:239], v[88:91]
    v_cvt_pk_bf16_f32 v35, v118, v119
    v_exp_f32 v13, v121
    s_waitcnt lgkmcnt(8)
    v_mfma_f32_16x16x32_bf16 v[92:95], v[44:47], v[236:239], v[92:95]
    ds_read_b64_tr_b16 v[40:41], v2 offset:20480
    ds_read_b64_tr_b16 v[42:43], v2 offset:20992
    v_mfma_f32_16x16x32_bf16 v[76:79], v[44:47], v[172:175], v[76:79]
    v_add_f32 v12, 1.0, v12
    v_rcp_f32 v12, v12
    v_add_f32 v13, 1.0, v13
    s_waitcnt lgkmcnt(8)
    v_mfma_f32_16x16x32_bf16 v[64:67], v[48:51], v[176:179], v[64:67]
    ds_read_b64_tr_b16 v[44:45], v3 offset:20480
    ds_read_b64_tr_b16 v[46:47], v3 offset:20992
    v_mfma_f32_16x16x32_bf16 v[80:83], v[48:51], v[240:243], v[80:83]
    v_rcp_f32_e64 v13, v13
    v_mul_f32 v120, v12, v120
    s_waitcnt lgkmcnt(8)
    v_mfma_f32_16x16x32_bf16 v[84:87], v[52:55], v[240:243], v[84:87]
    ds_read_b64_tr_b16 v[48:49], v4 offset:20480
    ds_read_b64_tr_b16 v[50:51], v4 offset:20992
    v_mfma_f32_16x16x32_bf16 v[68:71], v[52:55], v[176:179], v[68:71]
    v_exp_f32 v14, v122
    v_mul_f32 v121, v13, v121
    v_cvt_pk_bf16_f32 v36, v120, v121
    s_waitcnt lgkmcnt(8)
    v_mfma_f32_16x16x32_bf16 v[72:75], v[56:59], v[176:179], v[72:75]
    ds_read_b64_tr_b16 v[52:53], v5 offset:20480
    ds_read_b64_tr_b16 v[54:55], v5 offset:20992
    v_mfma_f32_16x16x32_bf16 v[88:91], v[56:59], v[240:243], v[88:91]
    v_exp_f32 v15, v123
    v_add_f32 v14, 1.0, v14
    s_waitcnt lgkmcnt(8)
    v_mfma_f32_16x16x32_bf16 v[92:95], v[60:63], v[240:243], v[92:95]
    ds_read_b64_tr_b16 v[56:57], v2 offset:24576
    ds_read_b64_tr_b16 v[58:59], v2 offset:25088
    v_mfma_f32_16x16x32_bf16 v[76:79], v[60:63], v[176:179], v[76:79]
    v_rcp_f32_e64 v14, v14
    v_add_f32 v15, 1.0, v15
    s_waitcnt lgkmcnt(8)
    v_mfma_f32_16x16x32_bf16 v[64:67], v[40:43], v[180:183], v[64:67]
    ds_read_b64_tr_b16 v[60:61], v3 offset:24576
    ds_read_b64_tr_b16 v[62:63], v3 offset:25088
    v_mfma_f32_16x16x32_bf16 v[80:83], v[40:43], v[244:247], v[80:83]
    v_rcp_f32 v15, v15
    v_mul_f32 v122, v14, v122
    v_exp_f32 v12, v124
    s_waitcnt lgkmcnt(8)
    v_mfma_f32_16x16x32_bf16 v[84:87], v[44:47], v[244:247], v[84:87]
    ds_read_b64_tr_b16 v[40:41], v4 offset:24576
    ds_read_b64_tr_b16 v[42:43], v4 offset:25088
    v_mfma_f32_16x16x32_bf16 v[68:71], v[44:47], v[180:183], v[68:71]
    v_mul_f32_e64 v123, v15, v123
    v_cvt_pk_bf16_f32 v37, v122, v123
    s_waitcnt lgkmcnt(8)
    v_mfma_f32_16x16x32_bf16 v[72:75], v[48:51], v[180:183], v[72:75]
    ds_read_b64_tr_b16 v[44:45], v5 offset:24576
    ds_read_b64_tr_b16 v[46:47], v5 offset:25088
    v_mfma_f32_16x16x32_bf16 v[88:91], v[48:51], v[244:247], v[88:91]
    v_exp_f32 v13, v125
    v_add_f32_e64 v12, 1.0, v12
    v_rcp_f32 v12, v12
    s_waitcnt lgkmcnt(8)
    v_mfma_f32_16x16x32_bf16 v[92:95], v[52:55], v[244:247], v[92:95]
    ds_read_b64_tr_b16 v[48:49], v2 offset:28672
    ds_read_b64_tr_b16 v[50:51], v2 offset:29184
    v_mfma_f32_16x16x32_bf16 v[76:79], v[52:55], v[180:183], v[76:79]
    v_add_f32_e64 v13, 1.0, v13
    v_rcp_f32 v13, v13
    s_waitcnt lgkmcnt(8)
    v_mfma_f32_16x16x32_bf16 v[64:67], v[56:59], v[184:187], v[64:67]
    ds_read_b64_tr_b16 v[52:53], v3 offset:28672
    ds_read_b64_tr_b16 v[54:55], v3 offset:29184
    v_mfma_f32_16x16x32_bf16 v[80:83], v[56:59], v[248:251], v[80:83]
    v_mul_f32_e64 v124, v12, v124
    v_exp_f32 v14, v126
    s_waitcnt lgkmcnt(8)
    v_mfma_f32_16x16x32_bf16 v[84:87], v[60:63], v[248:251], v[84:87]
    ds_read_b64_tr_b16 v[56:57], v4 offset:28672
    ds_read_b64_tr_b16 v[58:59], v4 offset:29184
    v_mfma_f32_16x16x32_bf16 v[68:71], v[60:63], v[184:187], v[68:71]
    v_mul_f32_e64 v125, v13, v125
    v_cvt_pk_bf16_f32 v38, v124, v125
    v_exp_f32 v15, v127
    s_waitcnt lgkmcnt(8)
    v_mfma_f32_16x16x32_bf16 v[72:75], v[40:43], v[184:187], v[72:75]
    ds_read_b64_tr_b16 v[60:61], v5 offset:28672
    ds_read_b64_tr_b16 v[62:63], v5 offset:29184
    v_mfma_f32_16x16x32_bf16 v[88:91], v[40:43], v[248:251], v[88:91]
    v_add_f32_e64 v14, 1.0, v14
    v_rcp_f32 v14, v14
    s_waitcnt lgkmcnt(8)
    v_mfma_f32_16x16x32_bf16 v[92:95], v[44:47], v[248:251], v[92:95]
    s_barrier
    ds_read_b64_tr_b16 v[40:41], v8 offset:32768
    ds_read_b64_tr_b16 v[42:43], v8 offset:33024
    v_mfma_f32_16x16x32_bf16 v[76:79], v[44:47], v[184:187], v[76:79]
    v_add_f32 v15, 1.0, v15
    v_rcp_f32_e64 v15, v15
    v_mul_f32 v126, v14, v126
    s_waitcnt lgkmcnt(8)
    v_mfma_f32_16x16x32_bf16 v[64:67], v[48:51], v[188:191], v[64:67]
    ds_read_b64_tr_b16 v[44:45], v9 offset:32768
    ds_read_b64_tr_b16 v[46:47], v9 offset:33024
    v_mfma_f32_16x16x32_bf16 v[80:83], v[48:51], v[252:255], v[80:83]
    v_mul_f32_e64 v127, v15, v127
    v_cvt_pk_bf16_f32 v39, v126, v127
    s_waitcnt lgkmcnt(8)
    v_mfma_f32_16x16x32_bf16 v[84:87], v[52:55], v[252:255], v[84:87]
    ds_read_b64_tr_b16 v[48:49], v8 offset:34816
    ds_read_b64_tr_b16 v[50:51], v8 offset:35072
    v_mfma_f32_16x16x32_bf16 v[68:71], v[52:55], v[188:191], v[68:71]
    s_waitcnt lgkmcnt(8)
    v_mfma_f32_16x16x32_bf16 v[72:75], v[56:59], v[188:191], v[72:75]
    ds_read_b64_tr_b16 v[52:53], v9 offset:34816
    ds_read_b64_tr_b16 v[54:55], v9 offset:35072
    v_mfma_f32_16x16x32_bf16 v[88:91], v[56:59], v[252:255], v[88:91]
    buffer_store_dwordx4 v[24:27], v1, s[32:35], s66 offen offset:0 sc1
    buffer_store_dwordx4 v[28:31], v1, s[32:35], s66 offen offset:2048 sc1
    buffer_store_dwordx4 v[32:35], v6, s[32:35], s66 offen offset:0 sc1
    buffer_store_dwordx4 v[36:39], v6, s[32:35], s66 offen offset:2048 sc1
    s_waitcnt lgkmcnt(8)
    v_mfma_f32_16x16x32_bf16 v[92:95], v[60:63], v[252:255], v[92:95]
    ds_read_b64_tr_b16 v[56:57], v8 offset:36864
    ds_read_b64_tr_b16 v[58:59], v8 offset:37120
    v_mfma_f32_16x16x32_bf16 v[76:79], v[60:63], v[188:191], v[76:79]
    s_waitcnt lgkmcnt(8)
    v_mfma_f32_16x16x32_bf16 v[96:99], v[40:43], v[128:131], 0
    ds_read_b64_tr_b16 v[60:61], v9 offset:36864
    ds_read_b64_tr_b16 v[62:63], v9 offset:37120
    v_mfma_f32_16x16x32_bf16 v[104:107], v[40:43], v[192:195], 0
    s_waitcnt lgkmcnt(8)
    v_mfma_f32_16x16x32_bf16 v[108:111], v[44:47], v[192:195], 0
    ds_read_b64_tr_b16 v[40:41], v8 offset:38912
    ds_read_b64_tr_b16 v[42:43], v8 offset:39168
    v_mfma_f32_16x16x32_bf16 v[100:103], v[44:47], v[128:131], 0
    s_add_u32 s66, s59, s62
    v_exp_f32_e64 v12, v64
    v_exp_f32 v13, v65
    s_waitcnt lgkmcnt(8)
    v_mfma_f32_16x16x32_bf16 v[96:99], v[48:51], v[132:135], v[96:99]
    ds_read_b64_tr_b16 v[44:45], v9 offset:38912
    ds_read_b64_tr_b16 v[46:47], v9 offset:39168
    v_mfma_f32_16x16x32_bf16 v[104:107], v[48:51], v[196:199], v[104:107]
    v_add_f32 v12, 1.0, v12
    v_rcp_f32 v12, v12
    v_add_f32 v13, 1.0, v13
    s_waitcnt lgkmcnt(8)
    v_mfma_f32_16x16x32_bf16 v[108:111], v[52:55], v[196:199], v[108:111]
    ds_read_b64_tr_b16 v[48:49], v8 offset:40960
    ds_read_b64_tr_b16 v[50:51], v8 offset:41216
    v_mfma_f32_16x16x32_bf16 v[100:103], v[52:55], v[132:135], v[100:103]
    v_rcp_f32_e64 v13, v13
    v_mul_f32 v64, v12, v64
    s_waitcnt lgkmcnt(8)
    v_mfma_f32_16x16x32_bf16 v[96:99], v[56:59], v[136:139], v[96:99]
    ds_read_b64_tr_b16 v[52:53], v9 offset:40960
    ds_read_b64_tr_b16 v[54:55], v9 offset:41216
    v_mfma_f32_16x16x32_bf16 v[104:107], v[56:59], v[200:203], v[104:107]
    v_exp_f32 v14, v66
    v_mul_f32 v65, v13, v65
    v_cvt_pk_bf16_f32 v24, v64, v65
    v_exp_f32 v15, v67
    s_waitcnt lgkmcnt(8)
    v_mfma_f32_16x16x32_bf16 v[108:111], v[60:63], v[200:203], v[108:111]
    ds_read_b64_tr_b16 v[56:57], v8 offset:43008
    ds_read_b64_tr_b16 v[58:59], v8 offset:43264
    v_mfma_f32_16x16x32_bf16 v[100:103], v[60:63], v[136:139], v[100:103]
    v_add_f32_e64 v14, 1.0, v14
    v_rcp_f32 v14, v14
    s_waitcnt lgkmcnt(8)
    v_mfma_f32_16x16x32_bf16 v[96:99], v[40:43], v[140:143], v[96:99]
    ds_read_b64_tr_b16 v[60:61], v9 offset:43008
    ds_read_b64_tr_b16 v[62:63], v9 offset:43264
    v_mfma_f32_16x16x32_bf16 v[104:107], v[40:43], v[204:207], v[104:107]
    v_add_f32 v15, 1.0, v15
    v_rcp_f32 v15, v15
    v_mul_f32 v66, v14, v66
    s_waitcnt lgkmcnt(8)
    v_mfma_f32_16x16x32_bf16 v[108:111], v[44:47], v[204:207], v[108:111]
    ds_read_b64_tr_b16 v[40:41], v8 offset:45056
    ds_read_b64_tr_b16 v[42:43], v8 offset:45312
    v_mfma_f32_16x16x32_bf16 v[100:103], v[44:47], v[140:143], v[100:103]
    v_exp_f32 v12, v68
    v_mul_f32 v67, v15, v67
    v_cvt_pk_bf16_f32 v25, v66, v67
    s_waitcnt lgkmcnt(8)
    v_mfma_f32_16x16x32_bf16 v[96:99], v[48:51], v[144:147], v[96:99]
    ds_read_b64_tr_b16 v[44:45], v9 offset:45056
    ds_read_b64_tr_b16 v[46:47], v9 offset:45312
    v_mfma_f32_16x16x32_bf16 v[104:107], v[48:51], v[208:211], v[104:107]
    v_exp_f32 v13, v69
    v_add_f32_e64 v12, 1.0, v12
    v_rcp_f32 v12, v12
    s_waitcnt lgkmcnt(8)
    v_mfma_f32_16x16x32_bf16 v[108:111], v[52:55], v[208:211], v[108:111]
    ds_read_b64_tr_b16 v[48:49], v8 offset:47104
    ds_read_b64_tr_b16 v[50:51], v8 offset:47360
    v_mfma_f32_16x16x32_bf16 v[100:103], v[52:55], v[144:147], v[100:103]
    v_add_f32 v13, 1.0, v13
    v_rcp_f32 v13, v13
    v_mul_f32 v68, v12, v68
    s_waitcnt lgkmcnt(8)
    v_mfma_f32_16x16x32_bf16 v[96:99], v[56:59], v[148:151], v[96:99]
    ds_read_b64_tr_b16 v[52:53], v9 offset:47104
    ds_read_b64_tr_b16 v[54:55], v9 offset:47360
    v_mfma_f32_16x16x32_bf16 v[104:107], v[56:59], v[212:215], v[104:107]
    v_exp_f32 v14, v70
    v_mul_f32 v69, v13, v69
    v_cvt_pk_bf16_f32 v26, v68, v69
    s_waitcnt lgkmcnt(8)
    v_mfma_f32_16x16x32_bf16 v[108:111], v[60:63], v[212:215], v[108:111]
    ds_read_b64_tr_b16 v[56:57], v8 offset:49152
    ds_read_b64_tr_b16 v[58:59], v8 offset:49408
    v_mfma_f32_16x16x32_bf16 v[100:103], v[60:63], v[148:151], v[100:103]
    v_exp_f32 v15, v71
    v_add_f32_e64 v14, 1.0, v14
    v_rcp_f32 v14, v14
    s_waitcnt lgkmcnt(8)
    v_mfma_f32_16x16x32_bf16 v[96:99], v[40:43], v[152:155], v[96:99]
    ds_read_b64_tr_b16 v[60:61], v9 offset:49152
    ds_read_b64_tr_b16 v[62:63], v9 offset:49408
    v_mfma_f32_16x16x32_bf16 v[104:107], v[40:43], v[216:219], v[104:107]
    v_add_f32 v15, 1.0, v15
    v_rcp_f32 v15, v15
    v_mul_f32 v70, v14, v70
    s_waitcnt lgkmcnt(8)
    v_mfma_f32_16x16x32_bf16 v[108:111], v[44:47], v[216:219], v[108:111]
    ds_read_b64_tr_b16 v[40:41], v8 offset:51200
    ds_read_b64_tr_b16 v[42:43], v8 offset:51456
    v_mfma_f32_16x16x32_bf16 v[100:103], v[44:47], v[152:155], v[100:103]
    v_exp_f32 v12, v72
    v_mul_f32 v71, v15, v71
    v_cvt_pk_bf16_f32 v27, v70, v71
    s_waitcnt lgkmcnt(8)
    v_mfma_f32_16x16x32_bf16 v[96:99], v[48:51], v[156:159], v[96:99]
    ds_read_b64_tr_b16 v[44:45], v9 offset:51200
    ds_read_b64_tr_b16 v[46:47], v9 offset:51456
    v_mfma_f32_16x16x32_bf16 v[104:107], v[48:51], v[220:223], v[104:107]
    v_exp_f32 v13, v73
    v_add_f32_e64 v12, 1.0, v12
    v_rcp_f32 v12, v12
    s_waitcnt lgkmcnt(8)
    v_mfma_f32_16x16x32_bf16 v[108:111], v[52:55], v[220:223], v[108:111]
    ds_read_b64_tr_b16 v[48:49], v8 offset:53248
    ds_read_b64_tr_b16 v[50:51], v8 offset:53504
    v_mfma_f32_16x16x32_bf16 v[100:103], v[52:55], v[156:159], v[100:103]
    v_add_f32 v13, 1.0, v13
    v_rcp_f32 v13, v13
    v_mul_f32 v72, v12, v72
    s_waitcnt lgkmcnt(8)
    v_mfma_f32_16x16x32_bf16 v[96:99], v[56:59], v[160:163], v[96:99]
    ds_read_b64_tr_b16 v[52:53], v9 offset:53248
    ds_read_b64_tr_b16 v[54:55], v9 offset:53504
    v_mfma_f32_16x16x32_bf16 v[104:107], v[56:59], v[224:227], v[104:107]
    v_exp_f32 v14, v74
    v_mul_f32 v73, v13, v73
    v_cvt_pk_bf16_f32 v28, v72, v73
    s_waitcnt lgkmcnt(8)
    v_mfma_f32_16x16x32_bf16 v[108:111], v[60:63], v[224:227], v[108:111]
    ds_read_b64_tr_b16 v[56:57], v8 offset:55296
    ds_read_b64_tr_b16 v[58:59], v8 offset:55552
    v_mfma_f32_16x16x32_bf16 v[100:103], v[60:63], v[160:163], v[100:103]
    v_exp_f32 v15, v75
    v_add_f32_e64 v14, 1.0, v14
    v_rcp_f32 v14, v14
    s_waitcnt lgkmcnt(8)
    v_mfma_f32_16x16x32_bf16 v[96:99], v[40:43], v[164:167], v[96:99]
    ds_read_b64_tr_b16 v[60:61], v9 offset:55296
    ds_read_b64_tr_b16 v[62:63], v9 offset:55552
    v_mfma_f32_16x16x32_bf16 v[104:107], v[40:43], v[228:231], v[104:107]
    v_add_f32 v15, 1.0, v15
    v_rcp_f32 v15, v15
    v_mul_f32 v74, v14, v74
    s_waitcnt lgkmcnt(8)
    v_mfma_f32_16x16x32_bf16 v[108:111], v[44:47], v[228:231], v[108:111]
    ds_read_b64_tr_b16 v[40:41], v8 offset:57344
    ds_read_b64_tr_b16 v[42:43], v8 offset:57600
    v_mfma_f32_16x16x32_bf16 v[100:103], v[44:47], v[164:167], v[100:103]
    v_exp_f32 v12, v76
    v_mul_f32 v75, v15, v75
    v_cvt_pk_bf16_f32 v29, v74, v75
    s_waitcnt lgkmcnt(8)
    v_mfma_f32_16x16x32_bf16 v[96:99], v[48:51], v[168:171], v[96:99]
    ds_read_b64_tr_b16 v[44:45], v9 offset:57344
    ds_read_b64_tr_b16 v[46:47], v9 offset:57600
    v_mfma_f32_16x16x32_bf16 v[104:107], v[48:51], v[232:235], v[104:107]
    v_exp_f32 v13, v77
    v_add_f32_e64 v12, 1.0, v12
    v_rcp_f32 v12, v12
    s_waitcnt lgkmcnt(8)
    v_mfma_f32_16x16x32_bf16 v[108:111], v[52:55], v[232:235], v[108:111]
    ds_read_b64_tr_b16 v[48:49], v8 offset:59392
    ds_read_b64_tr_b16 v[50:51], v8 offset:59648
    v_mfma_f32_16x16x32_bf16 v[100:103], v[52:55], v[168:171], v[100:103]
    v_add_f32_e64 v13, 1.0, v13
    v_rcp_f32 v13, v13
    s_waitcnt lgkmcnt(8)
    v_mfma_f32_16x16x32_bf16 v[96:99], v[56:59], v[172:175], v[96:99]
    ds_read_b64_tr_b16 v[52:53], v9 offset:59392
    ds_read_b64_tr_b16 v[54:55], v9 offset:59648
    v_mfma_f32_16x16x32_bf16 v[104:107], v[56:59], v[236:239], v[104:107]
    v_mul_f32 v76, v12, v76
    v_exp_f32 v14, v78
    v_mul_f32_e64 v77, v13, v77
    v_cvt_pk_bf16_f32 v30, v76, v77
    s_waitcnt lgkmcnt(8)
    v_mfma_f32_16x16x32_bf16 v[108:111], v[60:63], v[236:239], v[108:111]
    ds_read_b64_tr_b16 v[56:57], v8 offset:61440
    ds_read_b64_tr_b16 v[58:59], v8 offset:61696
    v_mfma_f32_16x16x32_bf16 v[100:103], v[60:63], v[172:175], v[100:103]
    v_exp_f32 v15, v79
    v_add_f32 v14, 1.0, v14
    s_waitcnt vmcnt(0)
    s_atomic_swap s52, s[70:71], 16
    s_waitcnt lgkmcnt(8)
    v_mfma_f32_16x16x32_bf16 v[96:99], v[40:43], v[176:179], v[96:99]
    ds_read_b64_tr_b16 v[60:61], v9 offset:61440
    ds_read_b64_tr_b16 v[62:63], v9 offset:61696
    v_mfma_f32_16x16x32_bf16 v[104:107], v[40:43], v[240:243], v[104:107]
    v_rcp_f32 v14, v14
    v_add_f32_e64 v15, 1.0, v15
    v_rcp_f32 v15, v15
    s_waitcnt lgkmcnt(8)
    v_mfma_f32_16x16x32_bf16 v[108:111], v[44:47], v[240:243], v[108:111]
    ds_read_b64_tr_b16 v[40:41], v8 offset:63488
    ds_read_b64_tr_b16 v[42:43], v8 offset:63744
    v_mfma_f32_16x16x32_bf16 v[100:103], v[44:47], v[176:179], v[100:103]
    v_mul_f32 v78, v14, v78
    v_exp_f32 v12, v80
    v_mul_f32 v79, v15, v79
    s_waitcnt lgkmcnt(8)
    v_mfma_f32_16x16x32_bf16 v[96:99], v[48:51], v[180:183], v[96:99]
    ds_read_b64_tr_b16 v[44:45], v9 offset:63488
    ds_read_b64_tr_b16 v[46:47], v9 offset:63744
    v_mfma_f32_16x16x32_bf16 v[104:107], v[48:51], v[244:247], v[104:107]
    v_cvt_pk_bf16_f32 v31, v78, v79
    v_exp_f32_e64 v13, v81
    v_add_f32 v12, 1.0, v12
    s_waitcnt lgkmcnt(8)
    v_mfma_f32_16x16x32_bf16 v[108:111], v[52:55], v[244:247], v[108:111]
    v_mfma_f32_16x16x32_bf16 v[100:103], v[52:55], v[180:183], v[100:103]
    v_rcp_f32 v12, v12
    v_add_f32 v13, 1.0, v13
    v_rcp_f32 v13, v13
    s_waitcnt lgkmcnt(6)
    v_mfma_f32_16x16x32_bf16 v[96:99], v[56:59], v[184:187], v[96:99]
    v_mfma_f32_16x16x32_bf16 v[104:107], v[56:59], v[248:251], v[104:107]
    v_mul_f32 v80, v12, v80
    v_exp_f32 v14, v82
    v_mul_f32 v81, v13, v81
    s_waitcnt lgkmcnt(4)
    v_mfma_f32_16x16x32_bf16 v[108:111], v[60:63], v[248:251], v[108:111]
    v_mfma_f32_16x16x32_bf16 v[100:103], v[60:63], v[184:187], v[100:103]
    v_cvt_pk_bf16_f32 v32, v80, v81
    v_exp_f32_e64 v15, v83
    v_add_f32 v14, 1.0, v14
    s_waitcnt lgkmcnt(2)
    v_mfma_f32_16x16x32_bf16 v[96:99], v[40:43], v[188:191], v[96:99]
    v_mfma_f32_16x16x32_bf16 v[104:107], v[40:43], v[252:255], v[104:107]
    v_rcp_f32 v14, v14
    v_add_f32 v15, 1.0, v15
    v_rcp_f32 v15, v15
    s_waitcnt lgkmcnt(0)
    v_mfma_f32_16x16x32_bf16 v[108:111], v[44:47], v[252:255], v[108:111]
    v_mfma_f32_16x16x32_bf16 v[100:103], v[44:47], v[188:191], v[100:103]
    v_mul_f32 v82, v14, v82
    v_exp_f32 v12, v84
    v_mul_f32 v83, v15, v83
    s_setprio 3
    v_cvt_pk_bf16_f32 v33, v82, v83
    v_exp_f32 v13, v85
    v_add_f32 v12, 1.0, v12
    v_rcp_f32 v12, v12
    v_add_f32 v13, 1.0, v13
    v_rcp_f32 v13, v13
    v_mul_f32 v84, v12, v84
    v_exp_f32 v14, v86
    v_mul_f32 v85, v13, v85
    v_cvt_pk_bf16_f32 v34, v84, v85
    v_exp_f32 v15, v87
    v_add_f32 v14, 1.0, v14
    v_rcp_f32 v14, v14
    v_add_f32 v15, 1.0, v15
    v_rcp_f32 v15, v15
    v_mul_f32 v86, v14, v86
    v_exp_f32 v12, v88
    v_mul_f32 v87, v15, v87
    v_cvt_pk_bf16_f32 v35, v86, v87
    v_exp_f32 v13, v89
    v_add_f32 v12, 1.0, v12
    v_rcp_f32 v12, v12
    v_add_f32 v13, 1.0, v13
    v_rcp_f32 v13, v13
    v_mul_f32 v88, v12, v88
    v_exp_f32 v14, v90
    v_mul_f32 v89, v13, v89
    v_cvt_pk_bf16_f32 v36, v88, v89
    v_exp_f32 v15, v91
    v_add_f32 v14, 1.0, v14
    v_rcp_f32 v14, v14
    v_add_f32 v15, 1.0, v15
    v_rcp_f32 v15, v15
    v_mul_f32 v90, v14, v90
    v_exp_f32 v12, v92
    v_mul_f32 v91, v15, v91
    v_cvt_pk_bf16_f32 v37, v90, v91
    v_exp_f32 v13, v93
    v_add_f32 v12, 1.0, v12
    v_rcp_f32 v12, v12
    v_add_f32 v13, 1.0, v13
    v_rcp_f32 v13, v13
    v_mul_f32 v92, v12, v92
    v_exp_f32 v14, v94
    v_mul_f32 v93, v13, v93
    v_cvt_pk_bf16_f32 v38, v92, v93
    v_exp_f32 v15, v95
    v_add_f32 v14, 1.0, v14
    v_rcp_f32 v14, v14
    v_add_f32 v15, 1.0, v15
    v_rcp_f32 v15, v15
    v_mul_f32 v94, v14, v94
    v_mul_f32_e64 v95, v15, v95
    v_cvt_pk_bf16_f32 v39, v94, v95
    buffer_store_dwordx4 v[24:27], v1, s[32:35], s66 offen offset:0 sc1
    buffer_store_dwordx4 v[28:31], v1, s[32:35], s66 offen offset:2048 sc1
    buffer_store_dwordx4 v[32:35], v6, s[32:35], s66 offen offset:0 sc1
    buffer_store_dwordx4 v[36:39], v6, s[32:35], s66 offen offset:2048 sc1
    s_add_u32 s66, s59, s63
    v_exp_f32 v12, v96
    v_exp_f32 v13, v97
    v_add_f32 v12, 1.0, v12
    v_rcp_f32 v12, v12
    v_add_f32 v13, 1.0, v13
    v_rcp_f32 v13, v13
    v_mul_f32 v96, v12, v96
    v_exp_f32 v14, v98
    v_mul_f32 v97, v13, v97
    v_cvt_pk_bf16_f32 v40, v96, v97
    v_exp_f32 v15, v99
    v_add_f32 v14, 1.0, v14
    v_rcp_f32 v14, v14
    v_add_f32 v15, 1.0, v15
    v_rcp_f32 v15, v15
    v_mul_f32 v98, v14, v98
    v_exp_f32 v12, v100
    v_mul_f32 v99, v15, v99
    v_cvt_pk_bf16_f32 v41, v98, v99
    v_exp_f32 v13, v101
    v_add_f32 v12, 1.0, v12
    v_rcp_f32 v12, v12
    v_add_f32 v13, 1.0, v13
    v_rcp_f32 v13, v13
    v_mul_f32 v100, v12, v100
    v_exp_f32 v14, v102
    v_mul_f32 v101, v13, v101
    v_cvt_pk_bf16_f32 v42, v100, v101
    v_exp_f32 v15, v103
    v_add_f32 v14, 1.0, v14
    v_rcp_f32 v14, v14
    v_add_f32 v15, 1.0, v15
    v_rcp_f32 v15, v15
    v_mul_f32 v102, v14, v102
    v_exp_f32 v12, v104
    v_mul_f32 v103, v15, v103
    v_cvt_pk_bf16_f32 v43, v102, v103
    v_exp_f32 v13, v105
    v_add_f32 v12, 1.0, v12
    v_rcp_f32 v12, v12
    v_add_f32 v13, 1.0, v13
    v_rcp_f32 v13, v13
    v_mul_f32 v104, v12, v104
    v_exp_f32 v14, v106
    v_mul_f32 v105, v13, v105
    v_cvt_pk_bf16_f32 v44, v104, v105
    v_exp_f32 v15, v107
    v_add_f32 v14, 1.0, v14
    v_rcp_f32 v14, v14
    v_add_f32 v15, 1.0, v15
    v_rcp_f32 v15, v15
    v_mul_f32 v106, v14, v106
    v_exp_f32 v12, v108
    v_mul_f32 v107, v15, v107
    v_cvt_pk_bf16_f32 v45, v106, v107
    v_exp_f32 v13, v109
    v_add_f32 v12, 1.0, v12
    v_rcp_f32 v12, v12
    v_add_f32 v13, 1.0, v13
    v_rcp_f32 v13, v13
    v_mul_f32 v108, v12, v108
    v_exp_f32 v14, v110
    v_mul_f32 v109, v13, v109
    v_cvt_pk_bf16_f32 v46, v108, v109
    v_exp_f32 v15, v111
    v_add_f32 v14, 1.0, v14
    v_rcp_f32 v14, v14
    v_add_f32 v15, 1.0, v15
    v_rcp_f32 v15, v15
    v_mul_f32 v110, v14, v110
    v_mul_f32_e64 v111, v15, v111
    v_cvt_pk_bf16_f32 v47, v110, v111
    buffer_store_dwordx4 v[40:43], v1, s[32:35], s66 offen offset:0 sc1
    buffer_store_dwordx4 v[44:47], v6, s[32:35], s66 offen offset:0 sc1
    s_waitcnt vmcnt(2)
    s_atomic_swap s52, s[70:71], 32
    s_waitcnt vmcnt(0)
    s_atomic_swap s52, s[70:71], 48
    s_endpgm
G1_A:
    s_barrier
    ds_read_b64_tr_b16 v[40:41], v2 offset:0
    ds_read_b64_tr_b16 v[42:43], v2 offset:512
    ds_read_b64_tr_b16 v[44:45], v3 offset:0
    ds_read_b64_tr_b16 v[46:47], v3 offset:512
    ds_read_b64_tr_b16 v[48:49], v4 offset:0
    ds_read_b64_tr_b16 v[50:51], v4 offset:512
    ds_read_b64_tr_b16 v[52:53], v5 offset:0
    ds_read_b64_tr_b16 v[54:55], v5 offset:512
    ds_read_b64_tr_b16 v[56:57], v2 offset:4096
    ds_read_b64_tr_b16 v[58:59], v2 offset:4608
    s_waitcnt lgkmcnt(8)
    v_mfma_f32_16x16x32_bf16 v[64:67], v[128:131], v[40:43], 0
    ds_read_b64_tr_b16 v[60:61], v3 offset:4096
    ds_read_b64_tr_b16 v[62:63], v3 offset:4608
    v_mfma_f32_16x16x32_bf16 v[68:71], v[192:195], v[40:43], 0
    s_waitcnt lgkmcnt(8)
    v_mfma_f32_16x16x32_bf16 v[76:79], v[192:195], v[44:47], 0
    ds_read_b64_tr_b16 v[40:41], v4 offset:4096
    ds_read_b64_tr_b16 v[42:43], v4 offset:4608
    v_mfma_f32_16x16x32_bf16 v[72:75], v[128:131], v[44:47], 0
    s_waitcnt lgkmcnt(8)
    v_mfma_f32_16x16x32_bf16 v[80:83], v[128:131], v[48:51], 0
    ds_read_b64_tr_b16 v[44:45], v5 offset:4096
    ds_read_b64_tr_b16 v[46:47], v5 offset:4608
    v_mfma_f32_16x16x32_bf16 v[84:87], v[192:195], v[48:51], 0
    s_waitcnt lgkmcnt(8)
    v_mfma_f32_16x16x32_bf16 v[92:95], v[192:195], v[52:55], 0
    ds_read_b64_tr_b16 v[48:49], v2 offset:8192
    ds_read_b64_tr_b16 v[50:51], v2 offset:8704
    v_mfma_f32_16x16x32_bf16 v[88:91], v[128:131], v[52:55], 0
    s_waitcnt lgkmcnt(8)
    v_mfma_f32_16x16x32_bf16 v[64:67], v[132:135], v[56:59], v[64:67]
    ds_read_b64_tr_b16 v[52:53], v3 offset:8192
    ds_read_b64_tr_b16 v[54:55], v3 offset:8704
    v_mfma_f32_16x16x32_bf16 v[68:71], v[196:199], v[56:59], v[68:71]
    s_waitcnt lgkmcnt(8)
    v_mfma_f32_16x16x32_bf16 v[76:79], v[196:199], v[60:63], v[76:79]
    ds_read_b64_tr_b16 v[56:57], v4 offset:8192
    ds_read_b64_tr_b16 v[58:59], v4 offset:8704
    v_mfma_f32_16x16x32_bf16 v[72:75], v[132:135], v[60:63], v[72:75]
    s_waitcnt lgkmcnt(8)
    v_mfma_f32_16x16x32_bf16 v[80:83], v[132:135], v[40:43], v[80:83]
    ds_read_b64_tr_b16 v[60:61], v5 offset:8192
    ds_read_b64_tr_b16 v[62:63], v5 offset:8704
    v_mfma_f32_16x16x32_bf16 v[84:87], v[196:199], v[40:43], v[84:87]
    s_waitcnt lgkmcnt(8)
    v_mfma_f32_16x16x32_bf16 v[92:95], v[196:199], v[44:47], v[92:95]
    ds_read_b64_tr_b16 v[40:41], v2 offset:12288
    ds_read_b64_tr_b16 v[42:43], v2 offset:12800
    v_mfma_f32_16x16x32_bf16 v[88:91], v[132:135], v[44:47], v[88:91]
    s_waitcnt lgkmcnt(8)
    v_mfma_f32_16x16x32_bf16 v[64:67], v[136:139], v[48:51], v[64:67]
    ds_read_b64_tr_b16 v[44:45], v3 offset:12288
    ds_read_b64_tr_b16 v[46:47], v3 offset:12800
    v_mfma_f32_16x16x32_bf16 v[68:71], v[200:203], v[48:51], v[68:71]
    s_waitcnt lgkmcnt(8)
    v_mfma_f32_16x16x32_bf16 v[76:79], v[200:203], v[52:55], v[76:79]
    ds_read_b64_tr_b16 v[48:49], v4 offset:12288
    ds_read_b64_tr_b16 v[50:51], v4 offset:12800
    v_mfma_f32_16x16x32_bf16 v[72:75], v[136:139], v[52:55], v[72:75]
    s_waitcnt lgkmcnt(8)
    v_mfma_f32_16x16x32_bf16 v[80:83], v[136:139], v[56:59], v[80:83]
    ds_read_b64_tr_b16 v[52:53], v5 offset:12288
    ds_read_b64_tr_b16 v[54:55], v5 offset:12800
    v_mfma_f32_16x16x32_bf16 v[84:87], v[200:203], v[56:59], v[84:87]
    s_waitcnt lgkmcnt(8)
    v_mfma_f32_16x16x32_bf16 v[92:95], v[200:203], v[60:63], v[92:95]
    s_barrier
    ds_read_b64_tr_b16 v[56:57], v2 offset:16384
    ds_read_b64_tr_b16 v[58:59], v2 offset:16896
    v_mfma_f32_16x16x32_bf16 v[88:91], v[136:139], v[60:63], v[88:91]
    s_waitcnt lgkmcnt(8)
    v_mfma_f32_16x16x32_bf16 v[64:67], v[140:143], v[40:43], v[64:67]
    ds_read_b64_tr_b16 v[60:61], v3 offset:16384
    ds_read_b64_tr_b16 v[62:63], v3 offset:16896
    v_mfma_f32_16x16x32_bf16 v[68:71], v[204:207], v[40:43], v[68:71]
    s_waitcnt lgkmcnt(8)
    v_mfma_f32_16x16x32_bf16 v[76:79], v[204:207], v[44:47], v[76:79]
    ds_read_b64_tr_b16 v[40:41], v4 offset:16384
    ds_read_b64_tr_b16 v[42:43], v4 offset:16896
    v_mfma_f32_16x16x32_bf16 v[72:75], v[140:143], v[44:47], v[72:75]
    s_waitcnt lgkmcnt(8)
    v_mfma_f32_16x16x32_bf16 v[80:83], v[140:143], v[48:51], v[80:83]
    ds_read_b64_tr_b16 v[44:45], v5 offset:16384
    ds_read_b64_tr_b16 v[46:47], v5 offset:16896
    v_mfma_f32_16x16x32_bf16 v[84:87], v[204:207], v[48:51], v[84:87]
    s_waitcnt lgkmcnt(8)
    v_mfma_f32_16x16x32_bf16 v[92:95], v[204:207], v[52:55], v[92:95]
    ds_read_b64_tr_b16 v[48:49], v2 offset:20480
    ds_read_b64_tr_b16 v[50:51], v2 offset:20992
    v_mfma_f32_16x16x32_bf16 v[88:91], v[140:143], v[52:55], v[88:91]
    s_mov_b32 s60, 0x35c1a2a0
    s_mov_b32 s61, 0x3f317218
    s_waitcnt lgkmcnt(8)
    v_mfma_f32_16x16x32_bf16 v[64:67], v[144:147], v[56:59], v[64:67]
    ds_read_b64_tr_b16 v[52:53], v3 offset:20480
    ds_read_b64_tr_b16 v[54:55], v3 offset:20992
    v_mfma_f32_16x16x32_bf16 v[68:71], v[208:211], v[56:59], v[68:71]
    s_waitcnt lgkmcnt(8)
    v_mfma_f32_16x16x32_bf16 v[76:79], v[208:211], v[60:63], v[76:79]
    ds_read_b64_tr_b16 v[56:57], v4 offset:20480
    ds_read_b64_tr_b16 v[58:59], v4 offset:20992
    v_mfma_f32_16x16x32_bf16 v[72:75], v[144:147], v[60:63], v[72:75]
    s_waitcnt lgkmcnt(8)
    v_mfma_f32_16x16x32_bf16 v[80:83], v[144:147], v[40:43], v[80:83]
    ds_read_b64_tr_b16 v[60:61], v5 offset:20480
    ds_read_b64_tr_b16 v[62:63], v5 offset:20992
    v_mfma_f32_16x16x32_bf16 v[84:87], v[208:211], v[40:43], v[84:87]
    s_mul_i32 s62, s23, 69632
    s_add_u32 s62, s62, 9437184
    s_waitcnt lgkmcnt(8)
    v_mfma_f32_16x16x32_bf16 v[92:95], v[208:211], v[44:47], v[92:95]
    ds_read_b64_tr_b16 v[40:41], v2 offset:24576
    ds_read_b64_tr_b16 v[42:43], v2 offset:25088
    v_mfma_f32_16x16x32_bf16 v[88:91], v[144:147], v[44:47], v[88:91]
    s_waitcnt lgkmcnt(8)
    v_mfma_f32_16x16x32_bf16 v[64:67], v[148:151], v[48:51], v[64:67]
    ds_read_b64_tr_b16 v[44:45], v3 offset:24576
    ds_read_b64_tr_b16 v[46:47], v3 offset:25088
    v_mfma_f32_16x16x32_bf16 v[68:71], v[212:215], v[48:51], v[68:71]
    s_waitcnt lgkmcnt(8)
    v_mfma_f32_16x16x32_bf16 v[76:79], v[212:215], v[52:55], v[76:79]
    ds_read_b64_tr_b16 v[48:49], v4 offset:24576
    ds_read_b64_tr_b16 v[50:51], v4 offset:25088
    v_mfma_f32_16x16x32_bf16 v[72:75], v[148:151], v[52:55], v[72:75]
    s_lshl2_add_u32 s54, s23, s3
    s_lshl_b32 s54, s54, 7
    s_waitcnt lgkmcnt(8)
    v_mfma_f32_16x16x32_bf16 v[80:83], v[148:151], v[56:59], v[80:83]
    ds_read_b64_tr_b16 v[52:53], v5 offset:24576
    ds_read_b64_tr_b16 v[54:55], v5 offset:25088
    v_mfma_f32_16x16x32_bf16 v[84:87], v[212:215], v[56:59], v[84:87]
    s_waitcnt lgkmcnt(8)
    v_mfma_f32_16x16x32_bf16 v[92:95], v[212:215], v[60:63], v[92:95]
    ds_read_b64_tr_b16 v[56:57], v2 offset:28672
    ds_read_b64_tr_b16 v[58:59], v2 offset:29184
    v_mfma_f32_16x16x32_bf16 v[88:91], v[148:151], v[60:63], v[88:91]
    s_waitcnt lgkmcnt(8)
    v_mfma_f32_16x16x32_bf16 v[64:67], v[152:155], v[40:43], v[64:67]
    ds_read_b64_tr_b16 v[60:61], v3 offset:28672
    ds_read_b64_tr_b16 v[62:63], v3 offset:29184
    v_mfma_f32_16x16x32_bf16 v[68:71], v[216:219], v[40:43], v[68:71]
    s_add_u32 s54, s54, 10059904
    s_lshl2_add_u32 s55, s22, s54
    s_waitcnt lgkmcnt(8)
    v_mfma_f32_16x16x32_bf16 v[76:79], v[216:219], v[44:47], v[76:79]
    ds_read_b64_tr_b16 v[40:41], v4 offset:28672
    ds_read_b64_tr_b16 v[42:43], v4 offset:29184
    v_mfma_f32_16x16x32_bf16 v[72:75], v[152:155], v[44:47], v[72:75]
    s_waitcnt lgkmcnt(8)
    v_mfma_f32_16x16x32_bf16 v[80:83], v[152:155], v[48:51], v[80:83]
    ds_read_b64_tr_b16 v[44:45], v5 offset:28672
    ds_read_b64_tr_b16 v[46:47], v5 offset:29184
    v_mfma_f32_16x16x32_bf16 v[84:87], v[216:219], v[48:51], v[84:87]
    s_waitcnt lgkmcnt(8)
    v_mfma_f32_16x16x32_bf16 v[92:95], v[216:219], v[52:55], v[92:95]
    s_barrier
    ds_read_b64_tr_b16 v[48:49], v2 offset:32768
    ds_read_b64_tr_b16 v[50:51], v2 offset:33280
    v_mfma_f32_16x16x32_bf16 v[88:91], v[152:155], v[52:55], v[88:91]
    s_add_u32 s72, s20, s54
    s_addc_u32 s73, s21, 0
    s_waitcnt lgkmcnt(8)
    v_mfma_f32_16x16x32_bf16 v[64:67], v[156:159], v[56:59], v[64:67]
    ds_read_b64_tr_b16 v[52:53], v3 offset:32768
    ds_read_b64_tr_b16 v[54:55], v3 offset:33280
    v_mfma_f32_16x16x32_bf16 v[68:71], v[220:223], v[56:59], v[68:71]
    s_waitcnt lgkmcnt(8)
    v_mfma_f32_16x16x32_bf16 v[76:79], v[220:223], v[60:63], v[76:79]
    ds_read_b64_tr_b16 v[56:57], v4 offset:32768
    ds_read_b64_tr_b16 v[58:59], v4 offset:33280
    v_mfma_f32_16x16x32_bf16 v[72:75], v[156:159], v[60:63], v[72:75]
    s_waitcnt lgkmcnt(8)
    v_mfma_f32_16x16x32_bf16 v[80:83], v[156:159], v[40:43], v[80:83]
    ds_read_b64_tr_b16 v[60:61], v5 offset:32768
    ds_read_b64_tr_b16 v[62:63], v5 offset:33280
    v_mfma_f32_16x16x32_bf16 v[84:87], v[220:223], v[40:43], v[84:87]
    s_add_u32 s44, s20, s55
    s_addc_u32 s45, s21, 0
    s_waitcnt lgkmcnt(8)
    v_mfma_f32_16x16x32_bf16 v[92:95], v[220:223], v[44:47], v[92:95]
    ds_read_b64_tr_b16 v[40:41], v2 offset:36864
    ds_read_b64_tr_b16 v[42:43], v2 offset:37376
    v_mfma_f32_16x16x32_bf16 v[88:91], v[156:159], v[44:47], v[88:91]
    s_waitcnt lgkmcnt(8)
    v_mfma_f32_16x16x32_bf16 v[64:67], v[160:163], v[48:51], v[64:67]
    ds_read_b64_tr_b16 v[44:45], v3 offset:36864
    ds_read_b64_tr_b16 v[46:47], v3 offset:37376
    v_mfma_f32_16x16x32_bf16 v[68:71], v[224:227], v[48:51], v[68:71]
    s_waitcnt lgkmcnt(8)
    v_mfma_f32_16x16x32_bf16 v[76:79], v[224:227], v[52:55], v[76:79]
    ds_read_b64_tr_b16 v[48:49], v4 offset:36864
    ds_read_b64_tr_b16 v[50:51], v4 offset:37376
    v_mfma_f32_16x16x32_bf16 v[72:75], v[160:163], v[52:55], v[72:75]
    v_lshlrev_b32_e64 v20, 4, v0
    s_waitcnt lgkmcnt(8)
    v_mfma_f32_16x16x32_bf16 v[80:83], v[160:163], v[56:59], v[80:83]
    ds_read_b64_tr_b16 v[52:53], v5 offset:36864
    ds_read_b64_tr_b16 v[54:55], v5 offset:37376
    v_mfma_f32_16x16x32_bf16 v[84:87], v[224:227], v[56:59], v[84:87]
    s_waitcnt lgkmcnt(8)
    v_mfma_f32_16x16x32_bf16 v[92:95], v[224:227], v[60:63], v[92:95]
    ds_read_b64_tr_b16 v[56:57], v2 offset:40960
    ds_read_b64_tr_b16 v[58:59], v2 offset:41472
    v_mfma_f32_16x16x32_bf16 v[88:91], v[160:163], v[60:63], v[88:91]
    s_waitcnt lgkmcnt(8)
    v_mfma_f32_16x16x32_bf16 v[64:67], v[164:167], v[40:43], v[64:67]
    ds_read_b64_tr_b16 v[60:61], v3 offset:40960
    ds_read_b64_tr_b16 v[62:63], v3 offset:41472
    v_mfma_f32_16x16x32_bf16 v[68:71], v[228:231], v[40:43], v[68:71]
    s_lshl_b32 s54, s3, 12
    s_add_u32 s54, s54, 147456
    v_add_u32_e64 v8, s54, v20
    s_waitcnt lgkmcnt(8)
    v_mfma_f32_16x16x32_bf16 v[76:79], v[228:231], v[44:47], v[76:79]
    ds_read_b64_tr_b16 v[40:41], v4 offset:40960
    ds_read_b64_tr_b16 v[42:43], v4 offset:41472
    v_mfma_f32_16x16x32_bf16 v[72:75], v[164:167], v[44:47], v[72:75]
    s_waitcnt lgkmcnt(8)
    v_mfma_f32_16x16x32_bf16 v[80:83], v[164:167], v[48:51], v[80:83]
    ds_read_b64_tr_b16 v[44:45], v5 offset:40960
    ds_read_b64_tr_b16 v[46:47], v5 offset:41472
    v_mfma_f32_16x16x32_bf16 v[84:87], v[228:231], v[48:51], v[84:87]
    s_waitcnt lgkmcnt(8)
    v_mfma_f32_16x16x32_bf16 v[92:95], v[228:231], v[52:55], v[92:95]
    ds_read_b64_tr_b16 v[48:49], v2 offset:45056
    ds_read_b64_tr_b16 v[50:51], v2 offset:45568
    v_mfma_f32_16x16x32_bf16 v[88:91], v[164:167], v[52:55], v[88:91]
    v_lshlrev_b32 v11, 2, v0
    s_waitcnt lgkmcnt(8)
    v_mfma_f32_16x16x32_bf16 v[64:67], v[168:171], v[56:59], v[64:67]
    ds_read_b64_tr_b16 v[52:53], v3 offset:45056
    ds_read_b64_tr_b16 v[54:55], v3 offset:45568
    v_mfma_f32_16x16x32_bf16 v[68:71], v[232:235], v[56:59], v[68:71]
    v_add_u32 v11, 147456, v11
    s_waitcnt lgkmcnt(8)
    v_mfma_f32_16x16x32_bf16 v[76:79], v[232:235], v[60:63], v[76:79]
    ds_read_b64_tr_b16 v[56:57], v4 offset:45056
    ds_read_b64_tr_b16 v[58:59], v4 offset:45568
    v_mfma_f32_16x16x32_bf16 v[72:75], v[168:171], v[60:63], v[72:75]
    s_waitcnt lgkmcnt(8)
    v_mfma_f32_16x16x32_bf16 v[80:83], v[168:171], v[40:43], v[80:83]
    ds_read_b64_tr_b16 v[60:61], v5 offset:45056
    ds_read_b64_tr_b16 v[62:63], v5 offset:45568
    v_mfma_f32_16x16x32_bf16 v[84:87], v[232:235], v[40:43], v[84:87]
    s_waitcnt lgkmcnt(8)
    v_mfma_f32_16x16x32_bf16 v[92:95], v[232:235], v[44:47], v[92:95]
    s_barrier
    ds_read_b64_tr_b16 v[40:41], v2 offset:49152
    ds_read_b64_tr_b16 v[42:43], v2 offset:49664
    v_mfma_f32_16x16x32_bf16 v[88:91], v[168:171], v[44:47], v[88:91]
    s_lshl_b32 s54, s3, 8
    v_add_u32_e64 v9, s54, v11
    s_waitcnt lgkmcnt(8)
    v_mfma_f32_16x16x32_bf16 v[64:67], v[172:175], v[48:51], v[64:67]
    ds_read_b64_tr_b16 v[44:45], v3 offset:49152
    ds_read_b64_tr_b16 v[46:47], v3 offset:49664
    v_mfma_f32_16x16x32_bf16 v[68:71], v[236:239], v[48:51], v[68:71]
    s_waitcnt lgkmcnt(8)
    v_mfma_f32_16x16x32_bf16 v[76:79], v[236:239], v[52:55], v[76:79]
    ds_read_b64_tr_b16 v[48:49], v4 offset:49152
    ds_read_b64_tr_b16 v[50:51], v4 offset:49664
    v_mfma_f32_16x16x32_bf16 v[72:75], v[172:175], v[52:55], v[72:75]
    s_waitcnt lgkmcnt(8)
    v_mfma_f32_16x16x32_bf16 v[80:83], v[172:175], v[56:59], v[80:83]
    ds_read_b64_tr_b16 v[52:53], v5 offset:49152
    ds_read_b64_tr_b16 v[54:55], v5 offset:49664
    v_mfma_f32_16x16x32_bf16 v[84:87], v[236:239], v[56:59], v[84:87]
    s_waitcnt lgkmcnt(8)
    v_mfma_f32_16x16x32_bf16 v[92:95], v[236:239], v[60:63], v[92:95]
    ds_read_b64_tr_b16 v[56:57], v2 offset:53248
    ds_read_b64_tr_b16 v[58:59], v2 offset:53760
    v_mfma_f32_16x16x32_bf16 v[88:91], v[172:175], v[60:63], v[88:91]
    s_lshl_b32 s54, s3, 10
    s_add_u32 s55, s54, 147456
    v_add_u32 v10, s55, v20
    s_waitcnt lgkmcnt(8)
    v_mfma_f32_16x16x32_bf16 v[64:67], v[176:179], v[40:43], v[64:67]
    ds_read_b64_tr_b16 v[60:61], v3 offset:53248
    ds_read_b64_tr_b16 v[62:63], v3 offset:53760
    v_mfma_f32_16x16x32_bf16 v[68:71], v[240:243], v[40:43], v[68:71]
    s_waitcnt lgkmcnt(8)
    v_mfma_f32_16x16x32_bf16 v[76:79], v[240:243], v[44:47], v[76:79]
    ds_read_b64_tr_b16 v[40:41], v4 offset:53248
    ds_read_b64_tr_b16 v[42:43], v4 offset:53760
    v_mfma_f32_16x16x32_bf16 v[72:75], v[176:179], v[44:47], v[72:75]
    s_waitcnt lgkmcnt(8)
    v_mfma_f32_16x16x32_bf16 v[80:83], v[176:179], v[48:51], v[80:83]
    ds_read_b64_tr_b16 v[44:45], v5 offset:53248
    ds_read_b64_tr_b16 v[46:47], v5 offset:53760
    v_mfma_f32_16x16x32_bf16 v[84:87], v[240:243], v[48:51], v[84:87]
    s_mul_i32 s55, s22, 4352
    s_add_u32 s66, s55, s62
    s_waitcnt lgkmcnt(8)
    v_mfma_f32_16x16x32_bf16 v[92:95], v[240:243], v[52:55], v[92:95]
    ds_read_b64_tr_b16 v[48:49], v2 offset:57344
    ds_read_b64_tr_b16 v[50:51], v2 offset:57856
    v_mfma_f32_16x16x32_bf16 v[88:91], v[176:179], v[52:55], v[88:91]
    s_waitcnt lgkmcnt(8)
    v_mfma_f32_16x16x32_bf16 v[64:67], v[180:183], v[56:59], v[64:67]
    ds_read_b64_tr_b16 v[52:53], v3 offset:57344
    ds_read_b64_tr_b16 v[54:55], v3 offset:57856
    v_mfma_f32_16x16x32_bf16 v[68:71], v[244:247], v[56:59], v[68:71]
    s_waitcnt lgkmcnt(8)
    v_mfma_f32_16x16x32_bf16 v[76:79], v[244:247], v[60:63], v[76:79]
    ds_read_b64_tr_b16 v[56:57], v4 offset:57344
    ds_read_b64_tr_b16 v[58:59], v4 offset:57856
    v_mfma_f32_16x16x32_bf16 v[72:75], v[180:183], v[60:63], v[72:75]
    s_add_u32 s63, s54, s66
    s_waitcnt lgkmcnt(8)
    v_mfma_f32_16x16x32_bf16 v[80:83], v[180:183], v[40:43], v[80:83]
    ds_read_b64_tr_b16 v[60:61], v5 offset:57344
    ds_read_b64_tr_b16 v[62:63], v5 offset:57856
    v_mfma_f32_16x16x32_bf16 v[84:87], v[244:247], v[40:43], v[84:87]
    s_waitcnt lgkmcnt(8)
    v_mfma_f32_16x16x32_bf16 v[92:95], v[244:247], v[44:47], v[92:95]
    ds_read_b64_tr_b16 v[40:41], v2 offset:61440
    ds_read_b64_tr_b16 v[42:43], v2 offset:61952
    v_mfma_f32_16x16x32_bf16 v[88:91], v[180:183], v[44:47], v[88:91]
    v_add_u32 v2, 0x10000, v2
    s_waitcnt lgkmcnt(8)
    v_mfma_f32_16x16x32_bf16 v[64:67], v[184:187], v[48:51], v[64:67]
    ds_read_b64_tr_b16 v[44:45], v3 offset:61440
    ds_read_b64_tr_b16 v[46:47], v3 offset:61952
    v_mfma_f32_16x16x32_bf16 v[68:71], v[248:251], v[48:51], v[68:71]
    v_add_u32 v3, 0x10000, v3
    s_waitcnt lgkmcnt(8)
    v_mfma_f32_16x16x32_bf16 v[76:79], v[248:251], v[52:55], v[76:79]
    ds_read_b64_tr_b16 v[48:49], v4 offset:61440
    ds_read_b64_tr_b16 v[50:51], v4 offset:61952
    v_mfma_f32_16x16x32_bf16 v[72:75], v[184:187], v[52:55], v[72:75]
    v_add_u32 v4, 0x10000, v4
    s_waitcnt lgkmcnt(8)
    v_mfma_f32_16x16x32_bf16 v[80:83], v[184:187], v[56:59], v[80:83]
    ds_read_b64_tr_b16 v[52:53], v5 offset:61440
    ds_read_b64_tr_b16 v[54:55], v5 offset:61952
    v_mfma_f32_16x16x32_bf16 v[84:87], v[248:251], v[56:59], v[84:87]
    v_add_u32 v5, 0x10000, v5
    s_waitcnt lgkmcnt(8)
    v_mfma_f32_16x16x32_bf16 v[92:95], v[248:251], v[60:63], v[92:95]
    s_barrier
    ds_read_b64_tr_b16 v[56:57], v2 offset:0
    ds_read_b64_tr_b16 v[58:59], v2 offset:512
    v_mfma_f32_16x16x32_bf16 v[88:91], v[184:187], v[60:63], v[88:91]
    s_waitcnt lgkmcnt(8)
    v_mfma_f32_16x16x32_bf16 v[64:67], v[188:191], v[40:43], v[64:67]
    ds_read_b64_tr_b16 v[60:61], v3 offset:0
    ds_read_b64_tr_b16 v[62:63], v3 offset:512
    v_mfma_f32_16x16x32_bf16 v[68:71], v[252:255], v[40:43], v[68:71]
    s_waitcnt lgkmcnt(8)
    v_mfma_f32_16x16x32_bf16 v[76:79], v[252:255], v[44:47], v[76:79]
    ds_read_b64_tr_b16 v[40:41], v4 offset:0
    ds_read_b64_tr_b16 v[42:43], v4 offset:512
    v_mfma_f32_16x16x32_bf16 v[72:75], v[188:191], v[44:47], v[72:75]
    s_waitcnt lgkmcnt(8)
    v_mfma_f32_16x16x32_bf16 v[80:83], v[188:191], v[48:51], v[80:83]
    ds_read_b64_tr_b16 v[44:45], v5 offset:0
    ds_read_b64_tr_b16 v[46:47], v5 offset:512
    v_mfma_f32_16x16x32_bf16 v[84:87], v[252:255], v[48:51], v[84:87]
    s_waitcnt lgkmcnt(8)
    v_mfma_f32_16x16x32_bf16 v[92:95], v[252:255], v[52:55], v[92:95]
    ds_read_b64_tr_b16 v[48:49], v2 offset:4096
    ds_read_b64_tr_b16 v[50:51], v2 offset:4608
    v_mfma_f32_16x16x32_bf16 v[88:91], v[188:191], v[52:55], v[88:91]
    s_waitcnt lgkmcnt(8)
    v_mfma_f32_16x16x32_bf16 v[96:99], v[128:131], v[56:59], 0
    ds_read_b64_tr_b16 v[52:53], v3 offset:4096
    ds_read_b64_tr_b16 v[54:55], v3 offset:4608
    v_mfma_f32_16x16x32_bf16 v[100:103], v[192:195], v[56:59], 0
    s_waitcnt lgkmcnt(8)
    v_mfma_f32_16x16x32_bf16 v[108:111], v[192:195], v[60:63], 0
    ds_read_b64_tr_b16 v[56:57], v4 offset:4096
    ds_read_b64_tr_b16 v[58:59], v4 offset:4608
    v_mfma_f32_16x16x32_bf16 v[104:107], v[128:131], v[60:63], 0
    v_exp_f32 v12, v64 clamp
    v_max_f32 v64, s60, v64
    s_waitcnt lgkmcnt(8)
    v_mfma_f32_16x16x32_bf16 v[112:115], v[128:131], v[40:43], 0
    ds_read_b64_tr_b16 v[60:61], v5 offset:4096
    ds_read_b64_tr_b16 v[62:63], v5 offset:4608
    v_mfma_f32_16x16x32_bf16 v[116:119], v[192:195], v[40:43], 0
    v_exp_f32 v13, v65 clamp
    v_max_f32 v65, s60, v65
    v_fmac_f32 v12, s61, v64
    v_fmac_f32 v13, s61, v65
    s_waitcnt lgkmcnt(8)
    v_mfma_f32_16x16x32_bf16 v[124:127], v[192:195], v[44:47], 0
    ds_read_b64_tr_b16 v[40:41], v2 offset:8192
    ds_read_b64_tr_b16 v[42:43], v2 offset:8704
    v_mfma_f32_16x16x32_bf16 v[120:123], v[128:131], v[44:47], 0
    v_exp_f32 v14, v66 clamp
    v_max_f32_e64 v66, s60, v66
    v_cvt_pk_bf16_f32 v24, v12, v13
    s_waitcnt lgkmcnt(8)
    v_mfma_f32_16x16x32_bf16 v[96:99], v[132:135], v[48:51], v[96:99]
    ds_read_b64_tr_b16 v[44:45], v3 offset:8192
    ds_read_b64_tr_b16 v[46:47], v3 offset:8704
    v_mfma_f32_16x16x32_bf16 v[100:103], v[196:199], v[48:51], v[100:103]
    v_exp_f32 v15, v67 clamp
    v_max_f32 v67, s60, v67
    v_fmac_f32 v14, s61, v66
    s_waitcnt lgkmcnt(8)
    v_mfma_f32_16x16x32_bf16 v[108:111], v[196:199], v[52:55], v[108:111]
    ds_read_b64_tr_b16 v[48:49], v4 offset:8192
    ds_read_b64_tr_b16 v[50:51], v4 offset:8704
    v_mfma_f32_16x16x32_bf16 v[104:107], v[132:135], v[52:55], v[104:107]
    v_fmac_f32_e64 v15, s61, v67
    v_exp_f32 v12, v68 clamp
    v_max_f32 v68, s60, v68
    s_waitcnt lgkmcnt(8)
    v_mfma_f32_16x16x32_bf16 v[112:115], v[132:135], v[56:59], v[112:115]
    ds_read_b64_tr_b16 v[52:53], v5 offset:8192
    ds_read_b64_tr_b16 v[54:55], v5 offset:8704
    v_mfma_f32_16x16x32_bf16 v[116:119], v[196:199], v[56:59], v[116:119]
    v_cvt_pk_bf16_f32 v25, v14, v15
    v_dot2_f32_bf16 v16, v24, s64, 0
    v_exp_f32 v13, v69 clamp
    s_waitcnt lgkmcnt(8)
    v_mfma_f32_16x16x32_bf16 v[124:127], v[196:199], v[60:63], v[124:127]
    ds_read_b64_tr_b16 v[56:57], v2 offset:12288
    ds_read_b64_tr_b16 v[58:59], v2 offset:12800
    v_mfma_f32_16x16x32_bf16 v[120:123], v[132:135], v[60:63], v[120:123]
    v_subrev_u32 v2, 0x10000, v2
    v_max_f32 v69, s60, v69
    v_fmac_f32_e64 v12, s61, v68
    v_fmac_f32 v13, s61, v69
    s_waitcnt lgkmcnt(8)
    v_mfma_f32_16x16x32_bf16 v[96:99], v[136:139], v[40:43], v[96:99]
    ds_read_b64_tr_b16 v[60:61], v3 offset:12288
    ds_read_b64_tr_b16 v[62:63], v3 offset:12800
    v_mfma_f32_16x16x32_bf16 v[100:103], v[200:203], v[40:43], v[100:103]
    v_subrev_u32 v3, 0x10000, v3
    v_exp_f32 v14, v70 clamp
    v_max_f32_e64 v70, s60, v70
    v_cvt_pk_bf16_f32 v26, v12, v13
    v_dot2_f32_bf16 v16, v25, s64, v16
    s_waitcnt lgkmcnt(8)
    v_mfma_f32_16x16x32_bf16 v[108:111], v[200:203], v[44:47], v[108:111]
    ds_read_b64_tr_b16 v[40:41], v4 offset:12288
    ds_read_b64_tr_b16 v[42:43], v4 offset:12800
    v_mfma_f32_16x16x32_bf16 v[104:107], v[136:139], v[44:47], v[104:107]
    v_subrev_u32 v4, 0x10000, v4
    v_exp_f32 v15, v71 clamp
    v_max_f32 v71, s60, v71
    v_fmac_f32 v14, s61, v70
    s_waitcnt lgkmcnt(8)
    v_mfma_f32_16x16x32_bf16 v[112:115], v[136:139], v[48:51], v[112:115]
    ds_read_b64_tr_b16 v[44:45], v5 offset:12288
    ds_read_b64_tr_b16 v[46:47], v5 offset:12800
    v_mfma_f32_16x16x32_bf16 v[116:119], v[200:203], v[48:51], v[116:119]
    v_subrev_u32 v5, 0x10000, v5
    v_fmac_f32_e64 v15, s61, v71
    v_exp_f32 v12, v72 clamp
    v_max_f32 v72, s60, v72
    s_waitcnt lgkmcnt(8)
    v_mfma_f32_16x16x32_bf16 v[124:127], v[200:203], v[52:55], v[124:127]
    s_barrier
    ds_read_b64_tr_b16 v[48:49], v2 offset:0
    ds_read_b64_tr_b16 v[50:51], v2 offset:512
    v_mfma_f32_16x16x32_bf16 v[120:123], v[136:139], v[52:55], v[120:123]
    v_cvt_pk_bf16_f32 v27, v14, v15
    v_dot2_f32_bf16 v16, v26, s64, v16
    v_exp_f32 v13, v73 clamp
    s_waitcnt lgkmcnt(8)
    v_mfma_f32_16x16x32_bf16 v[96:99], v[140:143], v[56:59], v[96:99]
    ds_read_b64_tr_b16 v[52:53], v3 offset:0
    ds_read_b64_tr_b16 v[54:55], v3 offset:512
    v_mfma_f32_16x16x32_bf16 v[100:103], v[204:207], v[56:59], v[100:103]
    v_max_f32 v73, s60, v73
    v_fmac_f32 v12, s61, v72
    v_fmac_f32 v13, s61, v73
    s_waitcnt lgkmcnt(8)
    v_mfma_f32_16x16x32_bf16 v[108:111], v[204:207], v[60:63], v[108:111]
    ds_read_b64_tr_b16 v[56:57], v4 offset:0
    ds_read_b64_tr_b16 v[58:59], v4 offset:512
    v_mfma_f32_16x16x32_bf16 v[104:107], v[140:143], v[60:63], v[104:107]
    v_exp_f32 v14, v74 clamp
    v_max_f32_e64 v74, s60, v74
    v_cvt_pk_bf16_f32 v28, v12, v13
    v_dot2_f32_bf16 v16, v27, s64, v16
    s_waitcnt lgkmcnt(8)
    v_mfma_f32_16x16x32_bf16 v[112:115], v[140:143], v[40:43], v[112:115]
    ds_read_b64_tr_b16 v[60:61], v5 offset:0
    ds_read_b64_tr_b16 v[62:63], v5 offset:512
    v_mfma_f32_16x16x32_bf16 v[116:119], v[204:207], v[40:43], v[116:119]
    v_exp_f32 v15, v75 clamp
    v_max_f32 v75, s60, v75
    v_fmac_f32 v14, s61, v74
    s_waitcnt lgkmcnt(8)
    v_mfma_f32_16x16x32_bf16 v[124:127], v[204:207], v[44:47], v[124:127]
    ds_read_b64_tr_b16 v[40:41], v2 offset:4096
    ds_read_b64_tr_b16 v[42:43], v2 offset:4608
    v_mfma_f32_16x16x32_bf16 v[120:123], v[140:143], v[44:47], v[120:123]
    v_fmac_f32_e64 v15, s61, v75
    v_exp_f32 v12, v76 clamp
    v_max_f32 v76, s60, v76
    s_waitcnt lgkmcnt(8)
    v_mfma_f32_16x16x32_bf16 v[96:99], v[144:147], v[48:51], v[96:99]
    ds_read_b64_tr_b16 v[44:45], v3 offset:4096
    ds_read_b64_tr_b16 v[46:47], v3 offset:4608
    v_mfma_f32_16x16x32_bf16 v[100:103], v[208:211], v[48:51], v[100:103]
    v_cvt_pk_bf16_f32 v29, v14, v15
    v_dot2_f32_bf16 v17, v28, s64, 0
    v_exp_f32 v13, v77 clamp
    s_waitcnt lgkmcnt(8)
    v_mfma_f32_16x16x32_bf16 v[108:111], v[208:211], v[52:55], v[108:111]
    ds_read_b64_tr_b16 v[48:49], v4 offset:4096
    ds_read_b64_tr_b16 v[50:51], v4 offset:4608
    v_mfma_f32_16x16x32_bf16 v[104:107], v[144:147], v[52:55], v[104:107]
    v_max_f32 v77, s60, v77
    v_fmac_f32_e64 v12, s61, v76
    v_fmac_f32 v13, s61, v77
    s_waitcnt lgkmcnt(8)
    v_mfma_f32_16x16x32_bf16 v[112:115], v[144:147], v[56:59], v[112:115]
    ds_read_b64_tr_b16 v[52:53], v5 offset:4096
    ds_read_b64_tr_b16 v[54:55], v5 offset:4608
    v_mfma_f32_16x16x32_bf16 v[116:119], v[208:211], v[56:59], v[116:119]
    v_exp_f32 v14, v78 clamp
    v_max_f32_e64 v78, s60, v78
    v_cvt_pk_bf16_f32 v30, v12, v13
    v_dot2_f32_bf16 v17, v29, s64, v17
    s_waitcnt lgkmcnt(8)
    v_mfma_f32_16x16x32_bf16 v[124:127], v[208:211], v[60:63], v[124:127]
    ds_read_b64_tr_b16 v[56:57], v2 offset:8192
    ds_read_b64_tr_b16 v[58:59], v2 offset:8704
    v_mfma_f32_16x16x32_bf16 v[120:123], v[144:147], v[60:63], v[120:123]
    v_exp_f32 v15, v79 clamp
    v_max_f32 v79, s60, v79
    v_fmac_f32 v14, s61, v78
    s_waitcnt lgkmcnt(8)
    v_mfma_f32_16x16x32_bf16 v[96:99], v[148:151], v[40:43], v[96:99]
    ds_read_b64_tr_b16 v[60:61], v3 offset:8192
    ds_read_b64_tr_b16 v[62:63], v3 offset:8704
    v_mfma_f32_16x16x32_bf16 v[100:103], v[212:215], v[40:43], v[100:103]
    v_fmac_f32_e64 v15, s61, v79
    v_exp_f32 v12, v80 clamp
    v_max_f32 v80, s60, v80
    s_waitcnt lgkmcnt(8)
    v_mfma_f32_16x16x32_bf16 v[108:111], v[212:215], v[44:47], v[108:111]
    ds_read_b64_tr_b16 v[40:41], v4 offset:8192
    ds_read_b64_tr_b16 v[42:43], v4 offset:8704
    v_mfma_f32_16x16x32_bf16 v[104:107], v[148:151], v[44:47], v[104:107]
    v_cvt_pk_bf16_f32 v31, v14, v15
    v_dot2_f32_bf16 v17, v30, s64, v17
    v_exp_f32 v13, v81 clamp
    s_waitcnt lgkmcnt(8)
    v_mfma_f32_16x16x32_bf16 v[112:115], v[148:151], v[48:51], v[112:115]
    ds_read_b64_tr_b16 v[44:45], v5 offset:8192
    ds_read_b64_tr_b16 v[46:47], v5 offset:8704
    v_mfma_f32_16x16x32_bf16 v[116:119], v[212:215], v[48:51], v[116:119]
    v_max_f32 v81, s60, v81
    v_fmac_f32_e64 v12, s61, v80
    v_fmac_f32 v13, s61, v81
    s_waitcnt lgkmcnt(8)
    v_mfma_f32_16x16x32_bf16 v[124:127], v[212:215], v[52:55], v[124:127]
    ds_read_b64_tr_b16 v[48:49], v2 offset:12288
    ds_read_b64_tr_b16 v[50:51], v2 offset:12800
    v_mfma_f32_16x16x32_bf16 v[120:123], v[148:151], v[52:55], v[120:123]
    v_exp_f32 v14, v82 clamp
    v_max_f32_e64 v82, s60, v82
    v_cvt_pk_bf16_f32 v32, v12, v13
    v_dot2_f32_bf16 v17, v31, s64, v17
    s_waitcnt lgkmcnt(8)
    v_mfma_f32_16x16x32_bf16 v[96:99], v[152:155], v[56:59], v[96:99]
    ds_read_b64_tr_b16 v[52:53], v3 offset:12288
    ds_read_b64_tr_b16 v[54:55], v3 offset:12800
    v_mfma_f32_16x16x32_bf16 v[100:103], v[216:219], v[56:59], v[100:103]
    v_exp_f32 v15, v83 clamp
    v_max_f32 v83, s60, v83
    v_fmac_f32 v14, s61, v82
    s_waitcnt lgkmcnt(8)
    v_mfma_f32_16x16x32_bf16 v[108:111], v[216:219], v[60:63], v[108:111]
    ds_read_b64_tr_b16 v[56:57], v4 offset:12288
    ds_read_b64_tr_b16 v[58:59], v4 offset:12800
    v_mfma_f32_16x16x32_bf16 v[104:107], v[152:155], v[60:63], v[104:107]
    v_fmac_f32_e64 v15, s61, v83
    v_exp_f32 v12, v84 clamp
    v_max_f32 v84, s60, v84
    s_waitcnt lgkmcnt(8)
    v_mfma_f32_16x16x32_bf16 v[112:115], v[152:155], v[40:43], v[112:115]
    ds_read_b64_tr_b16 v[60:61], v5 offset:12288
    ds_read_b64_tr_b16 v[62:63], v5 offset:12800
    v_mfma_f32_16x16x32_bf16 v[116:119], v[216:219], v[40:43], v[116:119]
    v_cvt_pk_bf16_f32 v33, v14, v15
    v_dot2_f32_bf16 v18, v32, s64, 0
    v_exp_f32 v13, v85 clamp
    s_waitcnt lgkmcnt(8)
    v_mfma_f32_16x16x32_bf16 v[124:127], v[216:219], v[44:47], v[124:127]
    s_barrier
    ds_read_b64_tr_b16 v[40:41], v2 offset:16384
    ds_read_b64_tr_b16 v[42:43], v2 offset:16896
    v_mfma_f32_16x16x32_bf16 v[120:123], v[152:155], v[44:47], v[120:123]
    v_max_f32 v85, s60, v85
    v_fmac_f32 v12, s61, v84
    v_fmac_f32 v13, s61, v85
    s_waitcnt lgkmcnt(8)
    v_mfma_f32_16x16x32_bf16 v[96:99], v[156:159], v[48:51], v[96:99]
    ds_read_b64_tr_b16 v[44:45], v3 offset:16384
    ds_read_b64_tr_b16 v[46:47], v3 offset:16896
    v_mfma_f32_16x16x32_bf16 v[100:103], v[220:223], v[48:51], v[100:103]
    v_exp_f32 v14, v86 clamp
    v_max_f32_e64 v86, s60, v86
    v_cvt_pk_bf16_f32 v34, v12, v13
    v_dot2_f32_bf16 v18, v33, s64, v18
    s_waitcnt lgkmcnt(8)
    v_mfma_f32_16x16x32_bf16 v[108:111], v[220:223], v[52:55], v[108:111]
    ds_read_b64_tr_b16 v[48:49], v4 offset:16384
    ds_read_b64_tr_b16 v[50:51], v4 offset:16896
    v_mfma_f32_16x16x32_bf16 v[104:107], v[156:159], v[52:55], v[104:107]
    v_exp_f32 v15, v87 clamp
    v_max_f32 v87, s60, v87
    v_fmac_f32 v14, s61, v86
    s_waitcnt lgkmcnt(8)
    v_mfma_f32_16x16x32_bf16 v[112:115], v[156:159], v[56:59], v[112:115]
    ds_read_b64_tr_b16 v[52:53], v5 offset:16384
    ds_read_b64_tr_b16 v[54:55], v5 offset:16896
    v_mfma_f32_16x16x32_bf16 v[116:119], v[220:223], v[56:59], v[116:119]
    v_fmac_f32_e64 v15, s61, v87
    v_exp_f32 v12, v88 clamp
    v_max_f32 v88, s60, v88
    s_waitcnt lgkmcnt(8)
    v_mfma_f32_16x16x32_bf16 v[124:127], v[220:223], v[60:63], v[124:127]
    ds_read_b64_tr_b16 v[56:57], v2 offset:20480
    ds_read_b64_tr_b16 v[58:59], v2 offset:20992
    v_mfma_f32_16x16x32_bf16 v[120:123], v[156:159], v[60:63], v[120:123]
    v_cvt_pk_bf16_f32 v35, v14, v15
    v_dot2_f32_bf16 v18, v34, s64, v18
    v_exp_f32 v13, v89 clamp
    s_waitcnt lgkmcnt(8)
    v_mfma_f32_16x16x32_bf16 v[96:99], v[160:163], v[40:43], v[96:99]
    ds_read_b64_tr_b16 v[60:61], v3 offset:20480
    ds_read_b64_tr_b16 v[62:63], v3 offset:20992
    v_mfma_f32_16x16x32_bf16 v[100:103], v[224:227], v[40:43], v[100:103]
    v_max_f32 v89, s60, v89
    v_fmac_f32_e64 v12, s61, v88
    v_fmac_f32 v13, s61, v89
    s_waitcnt lgkmcnt(8)
    v_mfma_f32_16x16x32_bf16 v[108:111], v[224:227], v[44:47], v[108:111]
    ds_read_b64_tr_b16 v[40:41], v4 offset:20480
    ds_read_b64_tr_b16 v[42:43], v4 offset:20992
    v_mfma_f32_16x16x32_bf16 v[104:107], v[160:163], v[44:47], v[104:107]
    v_exp_f32 v14, v90 clamp
    v_max_f32_e64 v90, s60, v90
    v_cvt_pk_bf16_f32 v36, v12, v13
    v_dot2_f32_bf16 v18, v35, s64, v18
    s_waitcnt lgkmcnt(8)
    v_mfma_f32_16x16x32_bf16 v[112:115], v[160:163], v[48:51], v[112:115]
    ds_read_b64_tr_b16 v[44:45], v5 offset:20480
    ds_read_b64_tr_b16 v[46:47], v5 offset:20992
    v_mfma_f32_16x16x32_bf16 v[116:119], v[224:227], v[48:51], v[116:119]
    v_exp_f32 v15, v91 clamp
    v_max_f32 v91, s60, v91
    v_fmac_f32 v14, s61, v90
    s_waitcnt lgkmcnt(8)
    v_mfma_f32_16x16x32_bf16 v[124:127], v[224:227], v[52:55], v[124:127]
    ds_read_b64_tr_b16 v[48:49], v2 offset:24576
    ds_read_b64_tr_b16 v[50:51], v2 offset:25088
    v_mfma_f32_16x16x32_bf16 v[120:123], v[160:163], v[52:55], v[120:123]
    v_fmac_f32_e64 v15, s61, v91
    v_exp_f32 v12, v92 clamp
    v_max_f32 v92, s60, v92
    s_waitcnt lgkmcnt(8)
    v_mfma_f32_16x16x32_bf16 v[96:99], v[164:167], v[56:59], v[96:99]
    ds_read_b64_tr_b16 v[52:53], v3 offset:24576
    ds_read_b64_tr_b16 v[54:55], v3 offset:25088
    v_mfma_f32_16x16x32_bf16 v[100:103], v[228:231], v[56:59], v[100:103]
    v_cvt_pk_bf16_f32 v37, v14, v15
    v_dot2_f32_bf16 v19, v36, s64, 0
    v_exp_f32 v13, v93 clamp
    s_waitcnt lgkmcnt(8)
    v_mfma_f32_16x16x32_bf16 v[108:111], v[228:231], v[60:63], v[108:111]
    ds_read_b64_tr_b16 v[56:57], v4 offset:24576
    ds_read_b64_tr_b16 v[58:59], v4 offset:25088
    v_mfma_f32_16x16x32_bf16 v[104:107], v[164:167], v[60:63], v[104:107]
    v_max_f32 v93, s60, v93
    v_fmac_f32_e64 v12, s61, v92
    v_fmac_f32 v13, s61, v93
    s_waitcnt lgkmcnt(8)
    v_mfma_f32_16x16x32_bf16 v[112:115], v[164:167], v[40:43], v[112:115]
    ds_read_b64_tr_b16 v[60:61], v5 offset:24576
    ds_read_b64_tr_b16 v[62:63], v5 offset:25088
    v_mfma_f32_16x16x32_bf16 v[116:119], v[228:231], v[40:43], v[116:119]
    v_exp_f32 v14, v94 clamp
    v_max_f32_e64 v94, s60, v94
    v_cvt_pk_bf16_f32 v38, v12, v13
    v_dot2_f32_bf16 v19, v37, s64, v19
    s_waitcnt lgkmcnt(8)
    v_mfma_f32_16x16x32_bf16 v[124:127], v[228:231], v[44:47], v[124:127]
    ds_read_b64_tr_b16 v[40:41], v2 offset:28672
    ds_read_b64_tr_b16 v[42:43], v2 offset:29184
    v_mfma_f32_16x16x32_bf16 v[120:123], v[164:167], v[44:47], v[120:123]
    v_exp_f32 v15, v95 clamp
    v_max_f32 v95, s60, v95
    v_fmac_f32 v14, s61, v94
    s_waitcnt lgkmcnt(8)
    v_mfma_f32_16x16x32_bf16 v[96:99], v[168:171], v[48:51], v[96:99]
    ds_read_b64_tr_b16 v[44:45], v3 offset:28672
    ds_read_b64_tr_b16 v[46:47], v3 offset:29184
    v_mfma_f32_16x16x32_bf16 v[100:103], v[232:235], v[48:51], v[100:103]
    v_fmac_f32_e64 v15, s61, v95
    v_cvt_pk_bf16_f32 v39, v14, v15
    v_dot2_f32_bf16 v19, v38, s64, v19
    v_dot2_f32_bf16 v19, v39, s64, v19
    s_waitcnt lgkmcnt(8)
    v_mfma_f32_16x16x32_bf16 v[108:111], v[232:235], v[52:55], v[108:111]
    ds_read_b64_tr_b16 v[48:49], v4 offset:28672
    ds_read_b64_tr_b16 v[50:51], v4 offset:29184
    v_mfma_f32_16x16x32_bf16 v[104:107], v[168:171], v[52:55], v[104:107]
    v_permlane32_swap_b32 v16, v18
    v_permlane32_swap_b32 v17, v19
    v_add_f32 v16, v16, v18
    v_add_f32 v17, v17, v19
    s_waitcnt lgkmcnt(8)
    v_mfma_f32_16x16x32_bf16 v[112:115], v[168:171], v[56:59], v[112:115]
    ds_read_b64_tr_b16 v[52:53], v5 offset:28672
    ds_read_b64_tr_b16 v[54:55], v5 offset:29184
    v_mfma_f32_16x16x32_bf16 v[116:119], v[232:235], v[56:59], v[116:119]
    v_permlane16_swap_b32 v16, v17
    v_add_f32 v16, v16, v17
    ds_write_b32 v9, v16
    s_waitcnt lgkmcnt(9)
    v_mfma_f32_16x16x32_bf16 v[124:127], v[232:235], v[60:63], v[124:127]
    s_waitcnt lgkmcnt(0)
    s_barrier
    ds_read_b64_tr_b16 v[56:57], v2 offset:32768
    ds_read_b64_tr_b16 v[58:59], v2 offset:33280
    v_mfma_f32_16x16x32_bf16 v[120:123], v[168:171], v[60:63], v[120:123]
    ds_read_b32 v12, v11 offset:0
    ds_read_b32 v13, v11 offset:256
    ds_read_b32 v14, v11 offset:512
    ds_read_b32 v15, v11 offset:768
    v_mfma_f32_16x16x32_bf16 v[96:99], v[172:175], v[40:43], v[96:99]
    ds_read_b64_tr_b16 v[60:61], v3 offset:32768
    ds_read_b64_tr_b16 v[62:63], v3 offset:33280
    v_mfma_f32_16x16x32_bf16 v[100:103], v[236:239], v[40:43], v[100:103]
    v_mfma_f32_16x16x32_bf16 v[108:111], v[236:239], v[44:47], v[108:111]
    ds_read_b64_tr_b16 v[40:41], v4 offset:32768
    ds_read_b64_tr_b16 v[42:43], v4 offset:33280
    v_mfma_f32_16x16x32_bf16 v[104:107], v[172:175], v[44:47], v[104:107]
    v_mfma_f32_16x16x32_bf16 v[112:115], v[172:175], v[48:51], v[112:115]
    ds_read_b64_tr_b16 v[44:45], v5 offset:32768
    ds_read_b64_tr_b16 v[46:47], v5 offset:33280
    v_mfma_f32_16x16x32_bf16 v[116:119], v[236:239], v[48:51], v[116:119]
    v_mfma_f32_16x16x32_bf16 v[124:127], v[236:239], v[52:55], v[124:127]
    ds_read_b64_tr_b16 v[48:49], v2 offset:36864
    ds_read_b64_tr_b16 v[50:51], v2 offset:37376
    v_mfma_f32_16x16x32_bf16 v[120:123], v[172:175], v[52:55], v[120:123]
    s_waitcnt lgkmcnt(10)
    v_add_f32_e64 v12, v12, v13
    v_mfma_f32_16x16x32_bf16 v[96:99], v[176:179], v[56:59], v[96:99]
    ds_read_b64_tr_b16 v[52:53], v3 offset:36864
    ds_read_b64_tr_b16 v[54:55], v3 offset:37376
    v_mfma_f32_16x16x32_bf16 v[100:103], v[240:243], v[56:59], v[100:103]
    s_waitcnt lgkmcnt(10)
    v_add_f32_e64 v14, v14, v15
    s_waitcnt lgkmcnt(8)
    v_mfma_f32_16x16x32_bf16 v[108:111], v[240:243], v[60:63], v[108:111]
    ds_read_b64_tr_b16 v[56:57], v4 offset:36864
    ds_read_b64_tr_b16 v[58:59], v4 offset:37376
    v_mfma_f32_16x16x32_bf16 v[104:107], v[176:179], v[60:63], v[104:107]
    v_subrev_u32 v11, 143360, v11
    s_waitcnt lgkmcnt(8)
    v_mfma_f32_16x16x32_bf16 v[112:115], v[176:179], v[40:43], v[112:115]
    ds_read_b64_tr_b16 v[60:61], v5 offset:36864
    ds_read_b64_tr_b16 v[62:63], v5 offset:37376
    v_mfma_f32_16x16x32_bf16 v[116:119], v[240:243], v[40:43], v[116:119]
    v_add_f32_e64 v22, v12, v14
    s_waitcnt lgkmcnt(8)
    v_mfma_f32_16x16x32_bf16 v[124:127], v[240:243], v[44:47], v[124:127]
    ds_read_b64_tr_b16 v[40:41], v2 offset:40960
    ds_read_b64_tr_b16 v[42:43], v2 offset:41472
    v_mfma_f32_16x16x32_bf16 v[120:123], v[176:179], v[44:47], v[120:123]
    s_waitcnt lgkmcnt(8)
    v_mfma_f32_16x16x32_bf16 v[96:99], v[180:183], v[48:51], v[96:99]
    ds_read_b64_tr_b16 v[44:45], v3 offset:40960
    ds_read_b64_tr_b16 v[46:47], v3 offset:41472
    v_mfma_f32_16x16x32_bf16 v[100:103], v[244:247], v[48:51], v[100:103]
    s_waitcnt lgkmcnt(8)
    v_mfma_f32_16x16x32_bf16 v[108:111], v[244:247], v[52:55], v[108:111]
    ds_read_b64_tr_b16 v[48:49], v4 offset:40960
    ds_read_b64_tr_b16 v[50:51], v4 offset:41472
    v_mfma_f32_16x16x32_bf16 v[104:107], v[180:183], v[52:55], v[104:107]
    s_waitcnt lgkmcnt(8)
    v_mfma_f32_16x16x32_bf16 v[112:115], v[180:183], v[56:59], v[112:115]
    ds_read_b64_tr_b16 v[52:53], v5 offset:40960
    ds_read_b64_tr_b16 v[54:55], v5 offset:41472
    v_mfma_f32_16x16x32_bf16 v[116:119], v[244:247], v[56:59], v[116:119]
    s_waitcnt lgkmcnt(8)
    v_mfma_f32_16x16x32_bf16 v[124:127], v[244:247], v[60:63], v[124:127]
    ds_read_b64_tr_b16 v[56:57], v2 offset:45056
    ds_read_b64_tr_b16 v[58:59], v2 offset:45568
    v_mfma_f32_16x16x32_bf16 v[120:123], v[180:183], v[60:63], v[120:123]
    s_waitcnt lgkmcnt(8)
    v_mfma_f32_16x16x32_bf16 v[96:99], v[184:187], v[40:43], v[96:99]
    ds_read_b64_tr_b16 v[60:61], v3 offset:45056
    ds_read_b64_tr_b16 v[62:63], v3 offset:45568
    v_mfma_f32_16x16x32_bf16 v[100:103], v[248:251], v[40:43], v[100:103]
    s_waitcnt lgkmcnt(8)
    v_mfma_f32_16x16x32_bf16 v[108:111], v[248:251], v[44:47], v[108:111]
    ds_read_b64_tr_b16 v[40:41], v4 offset:45056
    ds_read_b64_tr_b16 v[42:43], v4 offset:45568
    v_mfma_f32_16x16x32_bf16 v[104:107], v[184:187], v[44:47], v[104:107]
    s_waitcnt lgkmcnt(8)
    v_mfma_f32_16x16x32_bf16 v[112:115], v[184:187], v[48:51], v[112:115]
    ds_read_b64_tr_b16 v[44:45], v5 offset:45056
    ds_read_b64_tr_b16 v[46:47], v5 offset:45568
    v_mfma_f32_16x16x32_bf16 v[116:119], v[248:251], v[48:51], v[116:119]
    s_waitcnt lgkmcnt(8)
    v_mfma_f32_16x16x32_bf16 v[124:127], v[248:251], v[52:55], v[124:127]
    s_barrier
    ds_read_b64_tr_b16 v[48:49], v2 offset:49152
    ds_read_b64_tr_b16 v[50:51], v2 offset:49664
    v_mfma_f32_16x16x32_bf16 v[120:123], v[184:187], v[52:55], v[120:123]
    s_waitcnt lgkmcnt(8)
    v_mfma_f32_16x16x32_bf16 v[96:99], v[188:191], v[56:59], v[96:99]
    ds_read_b64_tr_b16 v[52:53], v3 offset:49152
    ds_read_b64_tr_b16 v[54:55], v3 offset:49664
    v_mfma_f32_16x16x32_bf16 v[100:103], v[252:255], v[56:59], v[100:103]
    s_waitcnt lgkmcnt(8)
    v_mfma_f32_16x16x32_bf16 v[108:111], v[252:255], v[60:63], v[108:111]
    ds_read_b64_tr_b16 v[56:57], v4 offset:49152
    ds_read_b64_tr_b16 v[58:59], v4 offset:49664
    v_mfma_f32_16x16x32_bf16 v[104:107], v[188:191], v[60:63], v[104:107]
    s_waitcnt lgkmcnt(8)
    v_mfma_f32_16x16x32_bf16 v[112:115], v[188:191], v[40:43], v[112:115]
    ds_read_b64_tr_b16 v[60:61], v5 offset:49152
    ds_read_b64_tr_b16 v[62:63], v5 offset:49664
    v_mfma_f32_16x16x32_bf16 v[116:119], v[252:255], v[40:43], v[116:119]
    s_waitcnt lgkmcnt(8)
    v_mfma_f32_16x16x32_bf16 v[124:127], v[252:255], v[44:47], v[124:127]
    ds_read_b64_tr_b16 v[40:41], v2 offset:53248
    ds_read_b64_tr_b16 v[42:43], v2 offset:53760
    v_mfma_f32_16x16x32_bf16 v[120:123], v[188:191], v[44:47], v[120:123]
    s_waitcnt lgkmcnt(8)
    v_mfma_f32_16x16x32_bf16 v[64:67], v[48:51], v[128:131], 0
    ds_read_b64_tr_b16 v[44:45], v3 offset:53248
    ds_read_b64_tr_b16 v[46:47], v3 offset:53760
    v_mfma_f32_16x16x32_bf16 v[80:83], v[48:51], v[192:195], 0
    v_cvt_pk_bf16_f32 v96, v96, v97
    v_cvt_pk_bf16_f32 v97, v98, v99
    v_cvt_pk_bf16_f32 v98, v100, v101
    v_cvt_pk_bf16_f32 v99, v102, v103
    s_waitcnt lgkmcnt(8)
    v_mfma_f32_16x16x32_bf16 v[84:87], v[52:55], v[192:195], 0
    ds_read_b64_tr_b16 v[48:49], v4 offset:53248
    ds_read_b64_tr_b16 v[50:51], v4 offset:53760
    v_mfma_f32_16x16x32_bf16 v[68:71], v[52:55], v[128:131], 0
    v_cvt_pk_bf16_f32 v100, v104, v105
    v_cvt_pk_bf16_f32 v101, v106, v107
    v_cvt_pk_bf16_f32 v102, v108, v109
    v_cvt_pk_bf16_f32 v103, v110, v111
    s_waitcnt lgkmcnt(8)
    v_mfma_f32_16x16x32_bf16 v[72:75], v[56:59], v[128:131], 0
    ds_read_b64_tr_b16 v[52:53], v5 offset:53248
    ds_read_b64_tr_b16 v[54:55], v5 offset:53760
    v_mfma_f32_16x16x32_bf16 v[88:91], v[56:59], v[192:195], 0
    v_cvt_pk_bf16_f32 v104, v112, v113
    v_cvt_pk_bf16_f32 v105, v114, v115
    v_cvt_pk_bf16_f32 v106, v116, v117
    v_cvt_pk_bf16_f32 v107, v118, v119
    s_waitcnt lgkmcnt(8)
    v_mfma_f32_16x16x32_bf16 v[92:95], v[60:63], v[192:195], 0
    ds_read_b64_tr_b16 v[56:57], v2 offset:57344
    ds_read_b64_tr_b16 v[58:59], v2 offset:57856
    v_mfma_f32_16x16x32_bf16 v[76:79], v[60:63], v[128:131], 0
    v_cvt_pk_bf16_f32 v108, v120, v121
    v_cvt_pk_bf16_f32 v109, v122, v123
    v_cvt_pk_bf16_f32 v110, v124, v125
    v_cvt_pk_bf16_f32 v111, v126, v127
    s_waitcnt lgkmcnt(8)
    v_mfma_f32_16x16x32_bf16 v[64:67], v[40:43], v[132:135], v[64:67]
    ds_read_b64_tr_b16 v[60:61], v3 offset:57344
    ds_read_b64_tr_b16 v[62:63], v3 offset:57856
    v_mfma_f32_16x16x32_bf16 v[80:83], v[40:43], v[196:199], v[80:83]
    v_mfma_f32_16x16x32_bf16 v[112:115], v[24:27], v[96:99], 0
    v_mfma_f32_16x16x32_bf16 v[116:119], v[28:31], v[100:103], 0
    v_mfma_f32_16x16x32_bf16 v[120:123], v[32:35], v[104:107], 0
    v_mfma_f32_16x16x32_bf16 v[124:127], v[36:39], v[108:111], 0
    s_waitcnt lgkmcnt(8)
    v_mfma_f32_16x16x32_bf16 v[84:87], v[44:47], v[196:199], v[84:87]
    ds_read_b64_tr_b16 v[40:41], v4 offset:57344
    ds_read_b64_tr_b16 v[42:43], v4 offset:57856
    v_mfma_f32_16x16x32_bf16 v[68:71], v[44:47], v[132:135], v[68:71]
    s_waitcnt lgkmcnt(8)
    v_mfma_f32_16x16x32_bf16 v[72:75], v[48:51], v[132:135], v[72:75]
    ds_read_b64_tr_b16 v[44:45], v5 offset:57344
    ds_read_b64_tr_b16 v[46:47], v5 offset:57856
    v_mfma_f32_16x16x32_bf16 v[88:91], v[48:51], v[196:199], v[88:91]
    ds_write_b128 v8, v[112:115] offset:0
    ds_write_b128 v8, v[116:119] offset:1024
    s_waitcnt lgkmcnt(10)
    v_mfma_f32_16x16x32_bf16 v[92:95], v[52:55], v[196:199], v[92:95]
    ds_read_b64_tr_b16 v[48:49], v2 offset:61440
    ds_read_b64_tr_b16 v[50:51], v2 offset:61952
    v_mfma_f32_16x16x32_bf16 v[76:79], v[52:55], v[132:135], v[76:79]
    v_add_u32 v2, 0x10000, v2
    ds_write_b128 v8, v[120:123] offset:2048
    ds_write_b128 v8, v[124:127] offset:3072
    s_waitcnt lgkmcnt(12)
    v_mfma_f32_16x16x32_bf16 v[64:67], v[56:59], v[136:139], v[64:67]
    ds_read_b64_tr_b16 v[52:53], v3 offset:61440
    ds_read_b64_tr_b16 v[54:55], v3 offset:61952
    v_mfma_f32_16x16x32_bf16 v[80:83], v[56:59], v[200:203], v[80:83]
    v_add_u32 v3, 0x10000, v3
    s_waitcnt lgkmcnt(12)
    v_mfma_f32_16x16x32_bf16 v[84:87], v[60:63], v[200:203], v[84:87]
    ds_read_b64_tr_b16 v[56:57], v4 offset:61440
    ds_read_b64_tr_b16 v[58:59], v4 offset:61952
    v_mfma_f32_16x16x32_bf16 v[68:71], v[60:63], v[136:139], v[68:71]
    v_add_u32 v4, 0x10000, v4
    s_waitcnt lgkmcnt(12)
    v_mfma_f32_16x16x32_bf16 v[72:75], v[40:43], v[136:139], v[72:75]
    ds_read_b64_tr_b16 v[60:61], v5 offset:61440
    ds_read_b64_tr_b16 v[62:63], v5 offset:61952
    v_mfma_f32_16x16x32_bf16 v[88:91], v[40:43], v[200:203], v[88:91]
    v_add_u32 v5, 0x10000, v5
    s_waitcnt lgkmcnt(12)
    v_mfma_f32_16x16x32_bf16 v[92:95], v[44:47], v[200:203], v[92:95]
    s_waitcnt lgkmcnt(6)
    s_barrier
    ds_read_b64_tr_b16 v[40:41], v2 offset:0
    ds_read_b64_tr_b16 v[42:43], v2 offset:512
    v_mfma_f32_16x16x32_bf16 v[76:79], v[44:47], v[136:139], v[76:79]
    ds_read_b128 v[96:99], v10 offset:0
    ds_read_b128 v[100:103], v10 offset:4096
    ds_read_b128 v[104:107], v10 offset:8192
    ds_read_b128 v[108:111], v10 offset:12288
    v_mfma_f32_16x16x32_bf16 v[64:67], v[48:51], v[140:143], v[64:67]
    ds_read_b64_tr_b16 v[44:45], v3 offset:0
    ds_read_b64_tr_b16 v[46:47], v3 offset:512
    v_mfma_f32_16x16x32_bf16 v[80:83], v[48:51], v[204:207], v[80:83]
    s_waitcnt lgkmcnt(12)
    v_mfma_f32_16x16x32_bf16 v[84:87], v[52:55], v[204:207], v[84:87]
    ds_read_b64_tr_b16 v[48:49], v4 offset:0
    ds_read_b64_tr_b16 v[50:51], v4 offset:512
    v_mfma_f32_16x16x32_bf16 v[68:71], v[52:55], v[140:143], v[68:71]
    s_waitcnt lgkmcnt(12)
    v_mfma_f32_16x16x32_bf16 v[72:75], v[56:59], v[140:143], v[72:75]
    ds_read_b64_tr_b16 v[52:53], v5 offset:0
    ds_read_b64_tr_b16 v[54:55], v5 offset:512
    v_mfma_f32_16x16x32_bf16 v[88:91], v[56:59], v[204:207], v[88:91]
    s_waitcnt lgkmcnt(8)
    v_add_f32 v96, v96, v100
    v_add_f32 v97, v97, v101
    v_add_f32 v98, v98, v102
    v_add_f32 v99, v99, v103
    s_waitcnt lgkmcnt(6)
    v_add_f32 v104, v104, v108
    v_add_f32 v105, v105, v109
    v_add_f32 v106, v106, v110
    v_add_f32 v107, v107, v111
    v_add_f32 v96, v96, v104
    v_add_f32 v97, v97, v105
    v_add_f32 v98, v98, v106
    v_add_f32_e64 v99, v99, v107
    buffer_store_dwordx4 v[96:99], v20, s[32:35], s63 offen sc1
    buffer_store_dword v22, v11, s[32:35], s66 offen sc1
    v_mfma_f32_16x16x32_bf16 v[92:95], v[60:63], v[204:207], v[92:95]
    ds_read_b64_tr_b16 v[56:57], v2 offset:4096
    ds_read_b64_tr_b16 v[58:59], v2 offset:4608
    v_mfma_f32_16x16x32_bf16 v[76:79], v[60:63], v[140:143], v[76:79]
    v_mfma_f32_16x16x32_bf16 v[64:67], v[40:43], v[144:147], v[64:67]
    ds_read_b64_tr_b16 v[60:61], v3 offset:4096
    ds_read_b64_tr_b16 v[62:63], v3 offset:4608
    v_mfma_f32_16x16x32_bf16 v[80:83], v[40:43], v[208:211], v[80:83]
    s_lshl2_add_u32 s54, s3, 102400
    v_mov_b32 v18, s54
    s_waitcnt vmcnt(2)
    v_mov_b32_e64 v23, 0
    ds_write_b32 v18, v23
    s_waitcnt lgkmcnt(9)
    v_mfma_f32_16x16x32_bf16 v[84:87], v[44:47], v[208:211], v[84:87]
    ds_read_b64_tr_b16 v[40:41], v4 offset:4096
    ds_read_b64_tr_b16 v[42:43], v4 offset:4608
    v_mfma_f32_16x16x32_bf16 v[68:71], v[44:47], v[144:147], v[68:71]
    v_and_b32 v19, 3, v0
    v_lshlrev_b32_e64 v19, 2, v19
    v_add_u32 v19, 102400, v19
    s_waitcnt lgkmcnt(9)
    v_mfma_f32_16x16x32_bf16 v[72:75], v[48:51], v[144:147], v[72:75]
    ds_read_b64_tr_b16 v[44:45], v5 offset:4096
    ds_read_b64_tr_b16 v[46:47], v5 offset:4608
    v_mfma_f32_16x16x32_bf16 v[88:91], v[48:51], v[208:211], v[88:91]
    v_and_b32_e64 v11, 15, v0
    s_waitcnt lgkmcnt(9)
    v_mfma_f32_16x16x32_bf16 v[92:95], v[52:55], v[208:211], v[92:95]
    ds_read_b64_tr_b16 v[48:49], v2 offset:8192
    ds_read_b64_tr_b16 v[50:51], v2 offset:8704
    v_mfma_f32_16x16x32_bf16 v[76:79], v[52:55], v[144:147], v[76:79]
    v_mul_u32_u24 v11, 4352, v11
    v_lshl_add_u32 v11, v7, 4, v11
    s_waitcnt lgkmcnt(9)
    v_mfma_f32_16x16x32_bf16 v[64:67], v[56:59], v[148:151], v[64:67]
    ds_read_b64_tr_b16 v[52:53], v3 offset:8192
    ds_read_b64_tr_b16 v[54:55], v3 offset:8704
    v_mfma_f32_16x16x32_bf16 v[80:83], v[56:59], v[212:215], v[80:83]
    v_subrev_u32 v8, 49152, v10
    s_waitcnt lgkmcnt(9)
    v_mfma_f32_16x16x32_bf16 v[84:87], v[60:63], v[212:215], v[84:87]
    ds_read_b64_tr_b16 v[56:57], v4 offset:8192
    ds_read_b64_tr_b16 v[58:59], v4 offset:8704
    v_mfma_f32_16x16x32_bf16 v[68:71], v[60:63], v[148:151], v[68:71]
    v_add_u32 v10, 98304, v20
    s_waitcnt lgkmcnt(8)
    v_mfma_f32_16x16x32_bf16 v[72:75], v[40:43], v[148:151], v[72:75]
    ds_read_b64_tr_b16 v[60:61], v5 offset:8192
    ds_read_b64_tr_b16 v[62:63], v5 offset:8704
    v_mfma_f32_16x16x32_bf16 v[88:91], v[40:43], v[212:215], v[88:91]
    v_mov_b32_e64 v23, 1
    s_waitcnt lgkmcnt(8)
    v_mfma_f32_16x16x32_bf16 v[92:95], v[44:47], v[212:215], v[92:95]
    ds_read_b64_tr_b16 v[40:41], v2 offset:12288
    ds_read_b64_tr_b16 v[42:43], v2 offset:12800
    v_mfma_f32_16x16x32_bf16 v[76:79], v[44:47], v[148:151], v[76:79]
    v_subrev_u32 v2, 0x10000, v2
    s_lshl2_add_u32 s54, s23, 112
    s_lshl_b32 s54, s54, 10
    s_add_u32 s66, s54, s59
    s_waitcnt lgkmcnt(8)
    v_mfma_f32_16x16x32_bf16 v[64:67], v[48:51], v[152:155], v[64:67]
    ds_read_b64_tr_b16 v[44:45], v3 offset:12288
    ds_read_b64_tr_b16 v[46:47], v3 offset:12800
    v_mfma_f32_16x16x32_bf16 v[80:83], v[48:51], v[216:219], v[80:83]
    v_subrev_u32 v3, 0x10000, v3
    s_waitcnt lgkmcnt(8)
    v_mfma_f32_16x16x32_bf16 v[84:87], v[52:55], v[216:219], v[84:87]
    ds_read_b64_tr_b16 v[48:49], v4 offset:12288
    ds_read_b64_tr_b16 v[50:51], v4 offset:12800
    v_mfma_f32_16x16x32_bf16 v[68:71], v[52:55], v[152:155], v[68:71]
    v_subrev_u32 v4, 0x10000, v4
    s_waitcnt lgkmcnt(8)
    v_mfma_f32_16x16x32_bf16 v[72:75], v[56:59], v[152:155], v[72:75]
    ds_read_b64_tr_b16 v[52:53], v5 offset:12288
    ds_read_b64_tr_b16 v[54:55], v5 offset:12800
    v_mfma_f32_16x16x32_bf16 v[88:91], v[56:59], v[216:219], v[88:91]
    v_subrev_u32 v5, 0x10000, v5
    s_lshl_b32 s54, s3, 6
    s_add_u32 s54, s54, s62
    s_add_u32 s63, s54, 4096
    s_waitcnt lgkmcnt(8)
    v_mfma_f32_16x16x32_bf16 v[92:95], v[60:63], v[216:219], v[92:95]
    s_barrier
    ds_read_b64_tr_b16 v[56:57], v2 offset:0
    ds_read_b64_tr_b16 v[58:59], v2 offset:512
    v_mfma_f32_16x16x32_bf16 v[76:79], v[60:63], v[152:155], v[76:79]
    s_waitcnt lgkmcnt(8)
    v_mfma_f32_16x16x32_bf16 v[64:67], v[40:43], v[156:159], v[64:67]
    ds_read_b64_tr_b16 v[60:61], v3 offset:0
    ds_read_b64_tr_b16 v[62:63], v3 offset:512
    v_mfma_f32_16x16x32_bf16 v[80:83], v[40:43], v[220:223], v[80:83]
    s_lshl_b32 s54, s3, 10
    s_add_u32 s62, s54, s62
    s_waitcnt lgkmcnt(8)
    v_mfma_f32_16x16x32_bf16 v[84:87], v[44:47], v[220:223], v[84:87]
    ds_read_b64_tr_b16 v[40:41], v4 offset:0
    ds_read_b64_tr_b16 v[42:43], v4 offset:512
    v_mfma_f32_16x16x32_bf16 v[68:71], v[44:47], v[156:159], v[68:71]
    s_waitcnt lgkmcnt(8)
    v_mfma_f32_16x16x32_bf16 v[72:75], v[48:51], v[156:159], v[72:75]
    ds_read_b64_tr_b16 v[44:45], v5 offset:0
    ds_read_b64_tr_b16 v[46:47], v5 offset:512
    v_mfma_f32_16x16x32_bf16 v[88:91], v[48:51], v[220:223], v[88:91]
    s_waitcnt lgkmcnt(8)
    v_mfma_f32_16x16x32_bf16 v[92:95], v[52:55], v[220:223], v[92:95]
    ds_read_b64_tr_b16 v[48:49], v2 offset:4096
    ds_read_b64_tr_b16 v[50:51], v2 offset:4608
    v_mfma_f32_16x16x32_bf16 v[76:79], v[52:55], v[156:159], v[76:79]
    s_waitcnt lgkmcnt(8)
    v_mfma_f32_16x16x32_bf16 v[64:67], v[56:59], v[160:163], v[64:67]
    ds_read_b64_tr_b16 v[52:53], v3 offset:4096
    ds_read_b64_tr_b16 v[54:55], v3 offset:4608
    v_mfma_f32_16x16x32_bf16 v[80:83], v[56:59], v[224:227], v[80:83]
    s_waitcnt lgkmcnt(8)
    v_mfma_f32_16x16x32_bf16 v[84:87], v[60:63], v[224:227], v[84:87]
    ds_read_b64_tr_b16 v[56:57], v4 offset:4096
    ds_read_b64_tr_b16 v[58:59], v4 offset:4608
    v_mfma_f32_16x16x32_bf16 v[68:71], v[60:63], v[160:163], v[68:71]
    s_waitcnt lgkmcnt(8)
    v_mfma_f32_16x16x32_bf16 v[72:75], v[40:43], v[160:163], v[72:75]
    ds_read_b64_tr_b16 v[60:61], v5 offset:4096
    ds_read_b64_tr_b16 v[62:63], v5 offset:4608
    v_mfma_f32_16x16x32_bf16 v[88:91], v[40:43], v[224:227], v[88:91]
    s_waitcnt lgkmcnt(8)
    v_mfma_f32_16x16x32_bf16 v[92:95], v[44:47], v[224:227], v[92:95]
    ds_read_b64_tr_b16 v[40:41], v2 offset:8192
    ds_read_b64_tr_b16 v[42:43], v2 offset:8704
    v_mfma_f32_16x16x32_bf16 v[76:79], v[44:47], v[160:163], v[76:79]
    s_waitcnt vmcnt(0)
    s_atomic_swap s52, s[44:45], 0
    s_waitcnt lgkmcnt(8)
    v_mfma_f32_16x16x32_bf16 v[64:67], v[48:51], v[164:167], v[64:67]
    ds_read_b64_tr_b16 v[44:45], v3 offset:8192
    ds_read_b64_tr_b16 v[46:47], v3 offset:8704
    v_mfma_f32_16x16x32_bf16 v[80:83], v[48:51], v[228:231], v[80:83]
    s_waitcnt lgkmcnt(8)
    v_mfma_f32_16x16x32_bf16 v[84:87], v[52:55], v[228:231], v[84:87]
    ds_read_b64_tr_b16 v[48:49], v4 offset:8192
    ds_read_b64_tr_b16 v[50:51], v4 offset:8704
    v_mfma_f32_16x16x32_bf16 v[68:71], v[52:55], v[164:167], v[68:71]
    s_waitcnt lgkmcnt(8)
    v_mfma_f32_16x16x32_bf16 v[72:75], v[56:59], v[164:167], v[72:75]
    ds_read_b64_tr_b16 v[52:53], v5 offset:8192
    ds_read_b64_tr_b16 v[54:55], v5 offset:8704
    v_mfma_f32_16x16x32_bf16 v[88:91], v[56:59], v[228:231], v[88:91]
    s_waitcnt lgkmcnt(8)
    v_mfma_f32_16x16x32_bf16 v[92:95], v[60:63], v[228:231], v[92:95]
    ds_read_b64_tr_b16 v[56:57], v2 offset:12288
    ds_read_b64_tr_b16 v[58:59], v2 offset:12800
    v_mfma_f32_16x16x32_bf16 v[76:79], v[60:63], v[164:167], v[76:79]
    s_waitcnt lgkmcnt(8)
    v_mfma_f32_16x16x32_bf16 v[64:67], v[40:43], v[168:171], v[64:67]
    ds_read_b64_tr_b16 v[60:61], v3 offset:12288
    ds_read_b64_tr_b16 v[62:63], v3 offset:12800
    v_mfma_f32_16x16x32_bf16 v[80:83], v[40:43], v[232:235], v[80:83]
    s_waitcnt lgkmcnt(8)
    v_mfma_f32_16x16x32_bf16 v[84:87], v[44:47], v[232:235], v[84:87]
    ds_read_b64_tr_b16 v[40:41], v4 offset:12288
    ds_read_b64_tr_b16 v[42:43], v4 offset:12800
    v_mfma_f32_16x16x32_bf16 v[68:71], v[44:47], v[168:171], v[68:71]
    s_waitcnt lgkmcnt(8)
    v_mfma_f32_16x16x32_bf16 v[72:75], v[48:51], v[168:171], v[72:75]
    ds_read_b64_tr_b16 v[44:45], v5 offset:12288
    ds_read_b64_tr_b16 v[46:47], v5 offset:12800
    v_mfma_f32_16x16x32_bf16 v[88:91], v[48:51], v[232:235], v[88:91]
    s_waitcnt lgkmcnt(8)
    v_mfma_f32_16x16x32_bf16 v[92:95], v[52:55], v[232:235], v[92:95]
    ds_read_b64_tr_b16 v[48:49], v2 offset:16384
    ds_read_b64_tr_b16 v[50:51], v2 offset:16896
    v_mfma_f32_16x16x32_bf16 v[76:79], v[52:55], v[168:171], v[76:79]
    s_waitcnt lgkmcnt(8)
    v_mfma_f32_16x16x32_bf16 v[64:67], v[56:59], v[172:175], v[64:67]
    ds_read_b64_tr_b16 v[52:53], v3 offset:16384
    ds_read_b64_tr_b16 v[54:55], v3 offset:16896
    v_mfma_f32_16x16x32_bf16 v[80:83], v[56:59], v[236:239], v[80:83]
    s_waitcnt lgkmcnt(8)
    v_mfma_f32_16x16x32_bf16 v[84:87], v[60:63], v[236:239], v[84:87]
    ds_read_b64_tr_b16 v[56:57], v4 offset:16384
    ds_read_b64_tr_b16 v[58:59], v4 offset:16896
    v_mfma_f32_16x16x32_bf16 v[68:71], v[60:63], v[172:175], v[68:71]
    s_waitcnt lgkmcnt(8)
    v_mfma_f32_16x16x32_bf16 v[72:75], v[40:43], v[172:175], v[72:75]
    ds_read_b64_tr_b16 v[60:61], v5 offset:16384
    ds_read_b64_tr_b16 v[62:63], v5 offset:16896
    v_mfma_f32_16x16x32_bf16 v[88:91], v[40:43], v[236:239], v[88:91]
    s_waitcnt lgkmcnt(8)
    v_mfma_f32_16x16x32_bf16 v[92:95], v[44:47], v[236:239], v[92:95]
    ds_read_b64_tr_b16 v[40:41], v2 offset:20480
    ds_read_b64_tr_b16 v[42:43], v2 offset:20992
    v_mfma_f32_16x16x32_bf16 v[76:79], v[44:47], v[172:175], v[76:79]
    s_waitcnt lgkmcnt(8)
    v_mfma_f32_16x16x32_bf16 v[64:67], v[48:51], v[176:179], v[64:67]
    ds_read_b64_tr_b16 v[44:45], v3 offset:20480
    ds_read_b64_tr_b16 v[46:47], v3 offset:20992
    v_mfma_f32_16x16x32_bf16 v[80:83], v[48:51], v[240:243], v[80:83]
    s_waitcnt lgkmcnt(8)
    v_mfma_f32_16x16x32_bf16 v[84:87], v[52:55], v[240:243], v[84:87]
    ds_read_b64_tr_b16 v[48:49], v4 offset:20480
    ds_read_b64_tr_b16 v[50:51], v4 offset:20992
    v_mfma_f32_16x16x32_bf16 v[68:71], v[52:55], v[176:179], v[68:71]
    s_waitcnt lgkmcnt(8)
    v_mfma_f32_16x16x32_bf16 v[72:75], v[56:59], v[176:179], v[72:75]
    ds_read_b64_tr_b16 v[52:53], v5 offset:20480
    ds_read_b64_tr_b16 v[54:55], v5 offset:20992
    v_mfma_f32_16x16x32_bf16 v[88:91], v[56:59], v[240:243], v[88:91]
    s_waitcnt lgkmcnt(8)
    v_mfma_f32_16x16x32_bf16 v[92:95], v[60:63], v[240:243], v[92:95]
    ds_read_b64_tr_b16 v[56:57], v2 offset:24576
    ds_read_b64_tr_b16 v[58:59], v2 offset:25088
    v_mfma_f32_16x16x32_bf16 v[76:79], v[60:63], v[176:179], v[76:79]
    s_waitcnt lgkmcnt(8)
    v_mfma_f32_16x16x32_bf16 v[64:67], v[40:43], v[180:183], v[64:67]
    ds_read_b64_tr_b16 v[60:61], v3 offset:24576
    ds_read_b64_tr_b16 v[62:63], v3 offset:25088
    v_mfma_f32_16x16x32_bf16 v[80:83], v[40:43], v[244:247], v[80:83]
    s_waitcnt lgkmcnt(8)
    v_mfma_f32_16x16x32_bf16 v[84:87], v[44:47], v[244:247], v[84:87]
    ds_read_b64_tr_b16 v[40:41], v4 offset:24576
    ds_read_b64_tr_b16 v[42:43], v4 offset:25088
    v_mfma_f32_16x16x32_bf16 v[68:71], v[44:47], v[180:183], v[68:71]
    s_waitcnt lgkmcnt(8)
    v_mfma_f32_16x16x32_bf16 v[72:75], v[48:51], v[180:183], v[72:75]
    ds_read_b64_tr_b16 v[44:45], v5 offset:24576
    ds_read_b64_tr_b16 v[46:47], v5 offset:25088
    v_mfma_f32_16x16x32_bf16 v[88:91], v[48:51], v[244:247], v[88:91]
    s_waitcnt lgkmcnt(8)
    v_mfma_f32_16x16x32_bf16 v[92:95], v[52:55], v[244:247], v[92:95]
    ds_read_b64_tr_b16 v[48:49], v2 offset:28672
    ds_read_b64_tr_b16 v[50:51], v2 offset:29184
    v_mfma_f32_16x16x32_bf16 v[76:79], v[52:55], v[180:183], v[76:79]
    s_load_dwordx16 s[4:19], s[72:73], 0 glc
    s_waitcnt lgkmcnt(8)
    v_mfma_f32_16x16x32_bf16 v[64:67], v[56:59], v[184:187], v[64:67]
    ds_read_b64_tr_b16 v[52:53], v3 offset:28672
    ds_read_b64_tr_b16 v[54:55], v3 offset:29184
    v_mfma_f32_16x16x32_bf16 v[80:83], v[56:59], v[248:251], v[80:83]
    s_waitcnt lgkmcnt(8)
    v_mfma_f32_16x16x32_bf16 v[84:87], v[60:63], v[248:251], v[84:87]
    ds_read_b64_tr_b16 v[56:57], v4 offset:28672
    ds_read_b64_tr_b16 v[58:59], v4 offset:29184
    v_mfma_f32_16x16x32_bf16 v[68:71], v[60:63], v[184:187], v[68:71]
    s_waitcnt lgkmcnt(8)
    v_mfma_f32_16x16x32_bf16 v[72:75], v[40:43], v[184:187], v[72:75]
    ds_read_b64_tr_b16 v[60:61], v5 offset:28672
    ds_read_b64_tr_b16 v[62:63], v5 offset:29184
    v_mfma_f32_16x16x32_bf16 v[88:91], v[40:43], v[248:251], v[88:91]
    s_waitcnt lgkmcnt(8)
    v_mfma_f32_16x16x32_bf16 v[92:95], v[44:47], v[248:251], v[92:95]
    v_mfma_f32_16x16x32_bf16 v[76:79], v[44:47], v[184:187], v[76:79]
    s_waitcnt lgkmcnt(6)
    v_mfma_f32_16x16x32_bf16 v[64:67], v[48:51], v[188:191], v[64:67]
    v_mfma_f32_16x16x32_bf16 v[80:83], v[48:51], v[252:255], v[80:83]
    s_waitcnt lgkmcnt(4)
    v_mfma_f32_16x16x32_bf16 v[84:87], v[52:55], v[252:255], v[84:87]
    v_mfma_f32_16x16x32_bf16 v[68:71], v[52:55], v[188:191], v[68:71]
    s_waitcnt lgkmcnt(2)
    v_mfma_f32_16x16x32_bf16 v[72:75], v[56:59], v[188:191], v[72:75]
    v_mfma_f32_16x16x32_bf16 v[88:91], v[56:59], v[252:255], v[88:91]
    s_waitcnt lgkmcnt(0)
    v_mfma_f32_16x16x32_bf16 v[92:95], v[60:63], v[252:255], v[92:95]
    v_mfma_f32_16x16x32_bf16 v[76:79], v[60:63], v[188:191], v[76:79]
    s_setprio 3
    v_exp_f32 v12, v64 clamp
    v_max_f32 v64, s60, v64
    v_exp_f32 v13, v65 clamp
    v_max_f32 v65, s60, v65
    v_fmac_f32 v12, s61, v64
    v_fmac_f32_e64 v13, s61, v65
    v_exp_f32 v14, v66 clamp
    v_max_f32_e64 v66, s60, v66
    v_cvt_pk_bf16_f32 v24, v12, v13
    v_exp_f32 v15, v67 clamp
    v_max_f32 v67, s60, v67
    v_fmac_f32 v14, s61, v66
    v_fmac_f32_e64 v15, s61, v67
    v_exp_f32 v12, v68 clamp
    v_max_f32_e64 v68, s60, v68
    v_cvt_pk_bf16_f32 v25, v14, v15
    v_exp_f32 v13, v69 clamp
    v_max_f32 v69, s60, v69
    v_fmac_f32 v12, s61, v68
    v_fmac_f32_e64 v13, s61, v69
    v_exp_f32 v14, v70 clamp
    v_max_f32_e64 v70, s60, v70
    v_cvt_pk_bf16_f32 v26, v12, v13
    v_exp_f32 v15, v71 clamp
    v_max_f32 v71, s60, v71
    v_fmac_f32 v14, s61, v70
    v_fmac_f32_e64 v15, s61, v71
    v_exp_f32 v12, v72 clamp
    v_max_f32_e64 v72, s60, v72
    v_cvt_pk_bf16_f32 v27, v14, v15
    v_exp_f32 v13, v73 clamp
    v_max_f32 v73, s60, v73
    v_fmac_f32 v12, s61, v72
    v_fmac_f32_e64 v13, s61, v73
    v_exp_f32 v14, v74 clamp
    v_max_f32_e64 v74, s60, v74
    v_cvt_pk_bf16_f32 v28, v12, v13
    v_exp_f32 v15, v75 clamp
    v_max_f32 v75, s60, v75
    v_fmac_f32 v14, s61, v74
    v_fmac_f32_e64 v15, s61, v75
    v_exp_f32 v12, v76 clamp
RE2:
    s_waitcnt lgkmcnt(0)
    s_xor_b64 s[4:5], s[4:5], s[52:53]
    s_xor_b64 s[6:7], s[6:7], s[52:53]
    s_xor_b64 s[8:9], s[8:9], s[52:53]
    s_xor_b64 s[10:11], s[10:11], s[52:53]
    s_xor_b64 s[12:13], s[12:13], s[52:53]
    s_xor_b64 s[14:15], s[14:15], s[52:53]
    s_xor_b64 s[16:17], s[16:17], s[52:53]
    s_xor_b64 s[18:19], s[18:19], s[52:53]
    s_or_b64 s[4:5], s[4:5], s[6:7]
    s_or_b64 s[4:5], s[4:5], s[8:9]
    s_or_b64 s[4:5], s[4:5], s[10:11]
    s_or_b64 s[4:5], s[4:5], s[12:13]
    s_or_b64 s[4:5], s[4:5], s[14:15]
    s_or_b64 s[4:5], s[4:5], s[16:17]
    s_or_b64 s[4:5], s[4:5], s[18:19]
    s_cbranch_scc0 OK2
    s_sleep 1
    s_load_dwordx16 s[4:19], s[72:73], 0 glc
    s_sub_u32 s0, s0, 16
    s_cmp_lt_i32 s0, 0
    s_cbranch_scc0 RE2
    s_waitcnt lgkmcnt(0)
OK2:
    buffer_load_dwordx4 v[192:195], v11, s[32:35], s63 offen sc1
    buffer_load_dwordx4 v[128:131], v20, s[32:35], s62 offen sc1
    s_add_u32 s62, s62, 4352
    buffer_load_dwordx4 v[132:135], v20, s[32:35], s62 offen sc1
    s_add_u32 s62, s62, 4352
    buffer_load_dwordx4 v[136:139], v20, s[32:35], s62 offen sc1
    s_add_u32 s62, s62, 4352
    buffer_load_dwordx4 v[140:143], v20, s[32:35], s62 offen sc1
    s_add_u32 s62, s62, 4352
    buffer_load_dwordx4 v[144:147], v20, s[32:35], s62 offen sc1
    s_add_u32 s62, s62, 4352
    buffer_load_dwordx4 v[148:151], v20, s[32:35], s62 offen sc1
    s_add_u32 s62, s62, 4352
    buffer_load_dwordx4 v[152:155], v20, s[32:35], s62 offen sc1
    s_add_u32 s62, s62, 4352
    buffer_load_dwordx4 v[156:159], v20, s[32:35], s62 offen sc1
    s_add_u32 s62, s62, 4352
    buffer_load_dwordx4 v[160:163], v20, s[32:35], s62 offen sc1
    s_add_u32 s62, s62, 4352
    buffer_load_dwordx4 v[164:167], v20, s[32:35], s62 offen sc1
    s_add_u32 s62, s62, 4352
    buffer_load_dwordx4 v[168:171], v20, s[32:35], s62 offen sc1
    s_add_u32 s62, s62, 4352
    buffer_load_dwordx4 v[172:175], v20, s[32:35], s62 offen sc1
    s_add_u32 s62, s62, 4352
    buffer_load_dwordx4 v[176:179], v20, s[32:35], s62 offen sc1
    s_add_u32 s62, s62, 4352
    buffer_load_dwordx4 v[180:183], v20, s[32:35], s62 offen sc1
    s_add_u32 s62, s62, 4352
    buffer_load_dwordx4 v[184:187], v20, s[32:35], s62 offen sc1
    s_add_u32 s62, s62, 4352
    buffer_load_dwordx4 v[188:191], v20, s[32:35], s62 offen sc1
    v_max_f32_e64 v76, s60, v76
    v_cvt_pk_bf16_f32 v29, v14, v15
    v_exp_f32 v13, v77 clamp
    v_max_f32 v77, s60, v77
    v_fmac_f32 v12, s61, v76
    v_fmac_f32_e64 v13, s61, v77
    v_exp_f32 v14, v78 clamp
    v_max_f32_e64 v78, s60, v78
    v_cvt_pk_bf16_f32 v30, v12, v13
    v_exp_f32 v15, v79 clamp
    v_max_f32 v79, s60, v79
    v_fmac_f32 v14, s61, v78
    v_fmac_f32_e64 v15, s61, v79
    v_exp_f32 v12, v80 clamp
    v_max_f32_e64 v80, s60, v80
    v_cvt_pk_bf16_f32 v31, v14, v15
    v_exp_f32 v13, v81 clamp
    v_max_f32 v81, s60, v81
    v_fmac_f32 v12, s61, v80
    v_fmac_f32_e64 v13, s61, v81
    v_exp_f32 v14, v82 clamp
    v_max_f32_e64 v82, s60, v82
    v_cvt_pk_bf16_f32 v32, v12, v13
    v_exp_f32 v15, v83 clamp
    v_max_f32 v83, s60, v83
    v_fmac_f32 v14, s61, v82
    v_fmac_f32_e64 v15, s61, v83
    v_exp_f32 v12, v84 clamp
    v_max_f32_e64 v84, s60, v84
    v_cvt_pk_bf16_f32 v33, v14, v15
    v_exp_f32 v13, v85 clamp
    v_max_f32 v85, s60, v85
    v_fmac_f32 v12, s61, v84
    v_fmac_f32_e64 v13, s61, v85
    v_exp_f32 v14, v86 clamp
    v_max_f32_e64 v86, s60, v86
    v_cvt_pk_bf16_f32 v34, v12, v13
    v_exp_f32 v15, v87 clamp
    v_max_f32 v87, s60, v87
    v_fmac_f32 v14, s61, v86
    v_fmac_f32_e64 v15, s61, v87
    v_exp_f32 v12, v88 clamp
    v_max_f32_e64 v88, s60, v88
    v_cvt_pk_bf16_f32 v35, v14, v15
    v_exp_f32 v13, v89 clamp
    v_max_f32 v89, s60, v89
    v_fmac_f32 v12, s61, v88
    v_fmac_f32_e64 v13, s61, v89
    v_exp_f32 v14, v90 clamp
    v_max_f32_e64 v90, s60, v90
    v_cvt_pk_bf16_f32 v36, v12, v13
    v_exp_f32 v15, v91 clamp
    v_max_f32 v91, s60, v91
    v_fmac_f32 v14, s61, v90
    v_fmac_f32_e64 v15, s61, v91
    v_exp_f32 v12, v92 clamp
    v_max_f32_e64 v92, s60, v92
    v_cvt_pk_bf16_f32 v37, v14, v15
    v_exp_f32 v13, v93 clamp
    v_max_f32 v93, s60, v93
    v_fmac_f32 v12, s61, v92
    v_fmac_f32_e64 v13, s61, v93
    v_exp_f32 v14, v94 clamp
    v_max_f32_e64 v94, s60, v94
    v_cvt_pk_bf16_f32 v38, v12, v13
    v_exp_f32 v15, v95 clamp
    v_max_f32 v95, s60, v95
    v_fmac_f32 v14, s61, v94
    v_fmac_f32_e64 v15, s61, v95
    v_cvt_pk_bf16_f32 v39, v14, v15
    s_waitcnt vmcnt(16)
    v_add_f32 v192, v192, v192 row_ror:1 row_mask:0xf bank_mask:0xf
    v_add_f32 v193, v193, v193 row_ror:1 row_mask:0xf bank_mask:0xf
    v_add_f32 v194, v194, v194 row_ror:1 row_mask:0xf bank_mask:0xf
    v_add_f32 v195, v195, v195 row_ror:1 row_mask:0xf bank_mask:0xf
    v_add_f32 v192, v192, v192 row_ror:2 row_mask:0xf bank_mask:0xf
    v_add_f32 v193, v193, v193 row_ror:2 row_mask:0xf bank_mask:0xf
    v_add_f32 v194, v194, v194 row_ror:2 row_mask:0xf bank_mask:0xf
    v_add_f32 v195, v195, v195 row_ror:2 row_mask:0xf bank_mask:0xf
    v_add_f32 v192, v192, v192 row_ror:4 row_mask:0xf bank_mask:0xf
    v_add_f32 v193, v193, v193 row_ror:4 row_mask:0xf bank_mask:0xf
    v_add_f32 v194, v194, v194 row_ror:4 row_mask:0xf bank_mask:0xf
    v_add_f32 v195, v195, v195 row_ror:4 row_mask:0xf bank_mask:0xf
    v_add_f32 v192, v192, v192 row_ror:8 row_mask:0xf bank_mask:0xf
    v_add_f32 v193, v193, v193 row_ror:8 row_mask:0xf bank_mask:0xf
    v_add_f32 v194, v194, v194 row_ror:8 row_mask:0xf bank_mask:0xf
    v_add_f32 v195, v195, v195 row_ror:8 row_mask:0xf bank_mask:0xf
    v_cvt_pk_bf16_f32 v195, v194, v195
    v_cvt_pk_bf16_f32 v194, v192, v193
    s_waitcnt vmcnt(14)
    v_add_f32 v128, v128, v132
    v_add_f32 v129, v129, v133
    v_add_f32 v130, v130, v134
    v_add_f32 v131, v131, v135
    s_waitcnt vmcnt(13)
    v_add_f32 v128, v128, v136
    v_add_f32 v129, v129, v137
    v_add_f32 v130, v130, v138
    v_add_f32 v131, v131, v139
    s_waitcnt vmcnt(12)
    v_add_f32 v128, v128, v140
    v_add_f32 v129, v129, v141
    v_add_f32 v130, v130, v142
    v_add_f32 v131, v131, v143
    s_waitcnt vmcnt(11)
    v_add_f32 v128, v128, v144
    v_add_f32 v129, v129, v145
    v_add_f32 v130, v130, v146
    v_add_f32 v131, v131, v147
    s_waitcnt vmcnt(10)
    v_add_f32 v128, v128, v148
    v_add_f32 v129, v129, v149
    v_add_f32 v130, v130, v150
    v_add_f32 v131, v131, v151
    s_waitcnt vmcnt(9)
    v_add_f32 v128, v128, v152
    v_add_f32 v129, v129, v153
    v_add_f32 v130, v130, v154
    v_add_f32 v131, v131, v155
    s_waitcnt vmcnt(8)
    v_add_f32 v128, v128, v156
    v_add_f32 v129, v129, v157
    v_add_f32 v130, v130, v158
    v_add_f32 v131, v131, v159
    s_waitcnt vmcnt(7)
    v_add_f32 v128, v128, v160
    v_add_f32 v129, v129, v161
    v_add_f32 v130, v130, v162
    v_add_f32 v131, v131, v163
    s_waitcnt vmcnt(6)
    v_add_f32 v128, v128, v164
    v_add_f32 v129, v129, v165
    v_add_f32 v130, v130, v166
    v_add_f32 v131, v131, v167
    s_waitcnt vmcnt(5)
    v_add_f32 v128, v128, v168
    v_add_f32 v129, v129, v169
    v_add_f32 v130, v130, v170
    v_add_f32 v131, v131, v171
    s_waitcnt vmcnt(4)
    v_add_f32 v128, v128, v172
    v_add_f32 v129, v129, v173
    v_add_f32 v130, v130, v174
    v_add_f32 v131, v131, v175
    s_waitcnt vmcnt(3)
    v_add_f32 v128, v128, v176
    v_add_f32 v129, v129, v177
    v_add_f32 v130, v130, v178
    v_add_f32 v131, v131, v179
    s_waitcnt vmcnt(2)
    v_add_f32 v128, v128, v180
    v_add_f32 v129, v129, v181
    v_add_f32 v130, v130, v182
    v_add_f32 v131, v131, v183
    s_waitcnt vmcnt(1)
    v_add_f32 v128, v128, v184
    v_add_f32 v129, v129, v185
    v_add_f32 v130, v130, v186
    v_add_f32 v131, v131, v187
    s_waitcnt vmcnt(0)
    v_add_f32 v128, v128, v188
    v_add_f32 v129, v129, v189
    v_add_f32 v130, v130, v190
    v_add_f32 v131, v131, v191
    v_cvt_pk_bf16_f32 v192, v128, v129
    v_cvt_pk_bf16_f32 v193, v130, v131
    ds_write_b128 v8, v[192:195]
    ds_write_b32 v18, v23
RE3:
    ds_read_b32 v21, v19
    s_sub_u32 s0, s0, 1
    s_cmp_lt_i32 s0, 0
    s_cbranch_scc1 OK3
    s_waitcnt lgkmcnt(0)
    v_cmp_gt_u32 vcc, 1, v21
    s_cbranch_vccnz RE3
OK3:
    ds_read_b128 v[40:43], v10 offset:0
    ds_read_b128 v[44:47], v10 offset:1024
    ds_read_b128 v[48:51], v10 offset:2048
    ds_read_b128 v[52:55], v10 offset:3072
    s_waitcnt lgkmcnt(3)
    v_mfma_f32_16x16x16_bf16 v[96:99], v[42:43], v[24:25], 0
    v_mfma_f32_16x16x16_bf16 v[64:67], v[40:41], v[24:25], 0
    s_waitcnt lgkmcnt(2)
    v_mfma_f32_16x16x16_bf16 v[100:103], v[46:47], v[26:27], 0
    v_mfma_f32_16x16x16_bf16 v[68:71], v[44:45], v[26:27], 0
    v_mfma_f32_16x16x16_bf16 v[112:115], v[42:43], v[32:33], 0
    v_mfma_f32_16x16x16_bf16 v[80:83], v[40:41], v[32:33], 0
    v_mfma_f32_16x16x16_bf16 v[116:119], v[46:47], v[34:35], 0
    v_mfma_f32_16x16x16_bf16 v[84:87], v[44:45], v[34:35], 0
    s_waitcnt lgkmcnt(1)
    v_mfma_f32_16x16x16_bf16 v[104:107], v[50:51], v[28:29], 0
    v_mfma_f32_16x16x16_bf16 v[72:75], v[48:49], v[28:29], 0
    s_waitcnt lgkmcnt(0)
    v_mfma_f32_16x16x16_bf16 v[108:111], v[54:55], v[30:31], 0
    v_mfma_f32_16x16x16_bf16 v[76:79], v[52:53], v[30:31], 0
    v_mfma_f32_16x16x16_bf16 v[120:123], v[50:51], v[36:37], 0
    v_mfma_f32_16x16x16_bf16 v[88:91], v[48:49], v[36:37], 0
    v_mfma_f32_16x16x16_bf16 v[124:127], v[54:55], v[38:39], 0
    v_mfma_f32_16x16x16_bf16 v[92:95], v[52:53], v[38:39], 0
    v_add_f32 v16, 0x358637bd, v96
    v_add_f32 v17, 0x358637bd, v100
    v_rcp_f32 v16, v16
    v_rcp_f32 v17, v17
    v_mul_f32 v64, -v64, v16
    v_mul_f32 v65, -v65, v16
    v_mul_f32 v66, -v66, v16
    v_mul_f32 v67, -v67, v16
    v_mul_f32 v68, -v68, v17
    v_mul_f32 v69, -v69, v17
    v_mul_f32 v70, -v70, v17
    v_mul_f32 v71, -v71, v17
    v_cvt_pk_bf16_f32 v64, v64, v65
    v_cvt_pk_bf16_f32 v65, v66, v67
    v_cvt_pk_bf16_f32 v66, v68, v69
    v_cvt_pk_bf16_f32 v67, v70, v71
    buffer_store_dwordx4 v[64:67], v1, s[32:35], s66 offen offset:0 sc1
    v_add_f32 v16, 0x358637bd, v112
    v_add_f32 v17, 0x358637bd, v116
    v_rcp_f32 v16, v16
    v_rcp_f32 v17, v17
    v_mul_f32 v80, -v80, v16
    v_mul_f32 v81, -v81, v16
    v_mul_f32 v82, -v82, v16
    v_mul_f32 v83, -v83, v16
    v_mul_f32 v84, -v84, v17
    v_mul_f32 v85, -v85, v17
    v_mul_f32 v86, -v86, v17
    v_mul_f32 v87, -v87, v17
    v_cvt_pk_bf16_f32 v80, v80, v81
    v_cvt_pk_bf16_f32 v81, v82, v83
    v_cvt_pk_bf16_f32 v82, v84, v85
    v_cvt_pk_bf16_f32 v83, v86, v87
    buffer_store_dwordx4 v[80:83], v6, s[32:35], s66 offen offset:0 sc1
    v_add_f32 v16, 0x358637bd, v104
    v_add_f32 v17, 0x358637bd, v108
    v_rcp_f32 v16, v16
    v_rcp_f32 v17, v17
    v_mul_f32 v72, -v72, v16
    v_mul_f32 v73, -v73, v16
    v_mul_f32 v74, -v74, v16
    v_mul_f32 v75, -v75, v16
    v_mul_f32 v76, -v76, v17
    v_mul_f32 v77, -v77, v17
    v_mul_f32 v78, -v78, v17
    v_mul_f32 v79, -v79, v17
    v_cvt_pk_bf16_f32 v72, v72, v73
    v_cvt_pk_bf16_f32 v73, v74, v75
    v_cvt_pk_bf16_f32 v74, v76, v77
    v_cvt_pk_bf16_f32 v75, v78, v79
    buffer_store_dwordx4 v[72:75], v1, s[32:35], s66 offen offset:2048 sc1
    v_add_f32 v16, 0x358637bd, v120
    v_add_f32 v17, 0x358637bd, v124
    v_rcp_f32 v16, v16
    v_rcp_f32 v17, v17
    v_mul_f32 v88, -v88, v16
    v_mul_f32 v89, -v89, v16
    v_mul_f32 v90, -v90, v16
    v_mul_f32 v91, -v91, v16
    v_mul_f32 v92, -v92, v17
    v_mul_f32 v93, -v93, v17
    v_mul_f32 v94, -v94, v17
    v_mul_f32 v95, -v95, v17
    v_cvt_pk_bf16_f32 v88, v88, v89
    v_cvt_pk_bf16_f32 v89, v90, v91
    v_cvt_pk_bf16_f32 v90, v92, v93
    v_cvt_pk_bf16_f32 v91, v94, v95
    buffer_store_dwordx4 v[88:91], v6, s[32:35], s66 offen offset:2048 sc1
    s_waitcnt vmcnt(0)
    s_atomic_swap s52, s[70:71], 64
    s_endpgm
G2_START:
    s_waitcnt lgkmcnt(0)
    s_lshr_b32 s23, s51, 2
    s_lshr_b32 s48, s23, 2
    s_and_b32 s23, s23, 3
    s_bfe_u32 s55, s2, 65538
    s_lshl2_add_u32 s23, s55, s23
    s_and_b32 s55, s51, 3
    s_mov_b32 s75, 12801
    s_cmp_eq_u32 s55, 1
    s_cselect_b32 s75, 12576, s75
    s_cmp_eq_u32 s55, 2
    s_cselect_b32 s75, 8976, s75
    s_cmp_eq_u32 s55, 3
    s_cselect_b32 s75, 12816, s75
    s_cmp_eq_u32 s48, 0
    s_movk_i32 s54, 3072
    s_cselect_b32 s50, s54, 3584
    v_and_b32 v4, 1, v4
    v_lshlrev_b32 v5, 1, v4
    v_xor_b32 v5, v5, v2
    v_lshlrev_b32_e64 v5, 4, v5
    v_mad_u32_u24 v192, v1, s50, v5
    s_lshl_b32 s54, s50, 3
    s_sub_u32 s54, s54, 1024
    v_xor_b32 v193, 64, v192
    v_add_u32 v193, s54, v193
    s_lshl_b32 s54, s54, 1
    v_add_u32 v194, s54, v192
    v_add_u32 v195, s54, v193
    v_lshrrev_b32 v8, 2, v0
    v_and_b32 v9, 3, v0
    v_lshlrev_b32 v10, 4, v9
    v_and_b32 v11, 32, v0
    v_xor_b32_e64 v10, v10, v11
    v_mad_u32_u24 v196, v8, s50, v10
    s_lshl_b32 s54, s50, 4
    s_sub_u32 s54, s54, 1024
    v_add_u32 v197, s54, v196
    v_add_u32 v198, s54, v197
    v_add_u32 v199, s54, v198
    s_mov_b32 s0, 4194304
    s_cmp_eq_u32 s48, 0
    s_cselect_b64 s[28:29], s[6:7], s[12:13]
    s_lshl_b32 s30, s50, 9
    s_mov_b32 s31, 0x20000
    s_mov_b64 s[24:25], s[4:5]
    s_mov_b32 s26, 2097152
    s_mov_b32 s27, 0x20000
    s_mov_b64 s[32:33], s[20:21]
    s_mov_b32 s34, 10125568
    s_mov_b32 s35, 0x20000
    s_mov_b64 s[36:37], s[14:15]
    s_mov_b32 s38, 1835008
    s_mov_b32 s39, 0x20000
    s_mov_b64 s[40:41], s[8:9]
    s_mov_b32 s42, 524288
    s_mov_b32 s43, 0x20000
    s_mov_b64 s[44:45], s[16:17]
    s_mov_b32 s46, 2097152
    s_mov_b32 s47, 0x20000
    s_lshr_b32 s54, s75, 0
    s_add_u32 s54, s54, s49
    s_and_b32 s54, s54, 3
    s_lshl2_add_u32 s54, s54, s3
    s_lshl_b32 s54, s54, 5
    s_mul_i32 s4, s54, s50
    s_lshr_b32 s54, s75, 4
    s_add_u32 s54, s54, s49
    s_and_b32 s54, s54, 3
    s_lshl2_add_u32 s54, s54, s3
    s_lshl_b32 s54, s54, 5
    s_mul_i32 s5, s54, s50
    s_lshr_b32 s54, s75, 8
    s_add_u32 s54, s54, s49
    s_and_b32 s54, s54, 3
    s_lshl2_add_u32 s54, s54, s3
    s_lshl_b32 s54, s54, 5
    s_mul_i32 s6, s54, s50
    s_lshr_b32 s54, s75, 12
    s_add_u32 s54, s54, s49
    s_and_b32 s54, s54, 3
    s_lshl2_add_u32 s54, s54, s3
    s_lshl_b32 s54, s54, 5
    s_mul_i32 s7, s54, s50
    s_lshr_b32 s1, s3, 1
    s_lshl_b32 s1, s1, 2
    s_and_b32 s55, s3, 1
    s_lshr_b32 s54, s75, s1
    s_add_u32 s54, s54, s49
    s_and_b32 s54, s54, 3
    s_lshl1_add_u32 s54, s54, s55
    s_lshl_b32 s54, s54, 6
    s_mul_i32 s8, s54, s50
    s_add_u32 s1, s1, 8
    s_lshr_b32 s54, s75, s1
    s_add_u32 s54, s54, s49
    s_and_b32 s54, s54, 3
    s_lshl1_add_u32 s54, s54, s55
    s_lshl_b32 s54, s54, 6
    s_mul_i32 s9, s54, s50
    s_add_u32 s1, s1, 8
    s_lshl_b32 s58, s23, 7
    s_mul_i32 s59, s23, 448
    s_and_b32 s60, s23, 1
    s_lshl_b32 s54, s60, 6
    s_add_u32 s61, s54, s59
    s_add_u32 s62, s58, 1024
    s_add_u32 s54, s58, 2048
    s_add_u32 s55, s61, 128
    s_add_u32 s1, s61, 256
    s_cmp_eq_u32 s48, 0
    s_cselect_b32 s10, s62, s61
    s_cselect_b32 s11, s54, s55
    s_cselect_b32 s12, s58, s1
    s_cmp_eq_u32 s60, 0
    s_cselect_b32 s54, 384, 0
    s_add_u32 s13, s59, s54
    s_lshl_b32 s14, s3, 12
    s_add_u32 s14, s14, 65536
    s_lshl_b32 s15, s3, 14
    s_lshr_b32 s54, s23, 2
    s_lshl1_add_u32 s54, s22, s54
    s_lshr_b32 s1, s51, 2
    s_xor_b32 s1, s1, 6
    s_lshl_b32 s1, s1, 7
    v_lshrrev_b32 v4, 4, v0
    v_lshlrev_b32 v5, 1, v4
    v_xor_b32 v5, v5, v2
    v_lshlrev_b32 v5, 4, v5
    v_lshl_add_u32 v1, v1, 10, v5
    v_add_u32_e64 v1, s1, v1
    v_add_u32 v2, 7168, v1
    s_lshl2_add_u32 s55, s54, s3
    s_lshl_b32 s55, s55, 7
    s_add_u32 s55, s55, 9994240
    s_add_u32 s16, s20, s55
    s_addc_u32 s17, s21, 0
    s_lshl_b32 s55, s48, 1
    s_xor_b32 s55, s55, s3
    s_lshl2_add_u32 s54, s54, s55
    s_lshl_b32 s50, s54, 14
    s_add_u32 s50, s50, s1
    s_lshr_b32 s54, s54, 1
    s_mul_i32 s68, s54, 147456
    s_xor_b32 s54, s54, 1
    s_mul_i32 s69, s54, 147456
    s_and_b32 s55, s55, 1
    s_lshl_b32 s55, s55, 10
    v_lshl_add_u32 v5, v0, 4, s55
    v_xor_b32 v6, 0x400, v5
    v_bfe_u32 v11, v0, 3, 2
    v_lshlrev_b32 v11, 5, v11
    v_lshl_add_u32 v11, v9, 3, v11
    v_lshl_add_u32 v11, v8, 7, v11
    v_add_u32 v0, s15, v11
    v_xor_b32 v3, 32, v0
    v_xor_b32_e64 v4, 64, v0
    v_xor_b32 v7, 0x60, v0
    s_lshr_b32 s1, s51, 2
    s_mul_i32 s1, s1, 1
    s_mul_i32 s54, s51, 2
    s_add_u32 s1, s1, s54
    s_mul_i32 s22, s3, 28
    s_lshl_b32 s23, s3, 3
    s_add_u32 s54, s1, 0
    s_and_b32 s54, s54, 3
    s_lshl1_add_u32 s55, s54, s23
    s_lshl_b32 s64, s55, 10
    s_and_b32 s55, s54, 1
    s_lshl1_add_u32 s55, s55, s22
    s_add_u32 s60, s55, 12
    s_lshl_b32 s60, s60, 10
    s_lshr_b32 s54, s54, 1
    s_lshl4_add_u32 s55, s54, s55
    s_lshl_b32 s56, s55, 10
    s_add_u32 s54, s1, 1
    s_and_b32 s54, s54, 3
    s_lshl1_add_u32 s55, s54, s23
    s_lshl_b32 s65, s55, 10
    s_and_b32 s55, s54, 1
    s_lshl1_add_u32 s55, s55, s22
    s_add_u32 s61, s55, 12
    s_lshl_b32 s61, s61, 10
    s_lshr_b32 s54, s54, 1
    s_lshl4_add_u32 s55, s54, s55
    s_lshl_b32 s57, s55, 10
    s_add_u32 s54, s1, 2
    s_and_b32 s54, s54, 3
    s_lshl1_add_u32 s55, s54, s23
    s_lshl_b32 s66, s55, 10
    s_and_b32 s55, s54, 1
    s_lshl1_add_u32 s55, s55, s22
    s_lshr_b32 s54, s54, 1
    s_lshl4_add_u32 s55, s54, s55
    s_lshl_b32 s58, s55, 10
    s_add_u32 s54, s1, 3
    s_and_b32 s54, s54, 3
    s_lshl1_add_u32 s55, s54, s23
    s_lshl_b32 s67, s55, 10
    s_and_b32 s55, s54, 1
    s_lshl1_add_u32 s55, s55, s22
    s_lshr_b32 s54, s54, 1
    s_lshl4_add_u32 s55, s54, s55
    s_lshl_b32 s59, s55, 10
    s_cmp_eq_u32 s48, 0
    s_cbranch_scc1 G2_A
    s_barrier
    s_load_dwordx2 s[52:53], s[18:19], 0
    s_add_u32 m0, s14, 0
    s_add_u32 s55, s10, s4
    buffer_load_dwordx4 v192, s[28:31], s55 offen offset:0 lds
    buffer_load_dwordx4 v193, s[28:31], s55 offen offset:1024 lds
    buffer_load_dwordx4 v194, s[28:31], s55 offen offset:2048 lds
    buffer_load_dwordx4 v195, s[28:31], s55 offen offset:3072 lds
    s_add_u32 m0, s14, 16384
    s_add_u32 s55, s10, s5
    buffer_load_dwordx4 v192, s[28:31], s55 offen offset:0 lds
    buffer_load_dwordx4 v193, s[28:31], s55 offen offset:1024 lds
    buffer_load_dwordx4 v194, s[28:31], s55 offen offset:2048 lds
    buffer_load_dwordx4 v195, s[28:31], s55 offen offset:3072 lds
    s_add_u32 m0, s14, 32768
    s_add_u32 s55, s10, s6
    s_waitcnt vmcnt(8)
    buffer_load_dwordx4 v192, s[28:31], s55 offen offset:0 lds
    s_waitcnt vmcnt(8)
    buffer_load_dwordx4 v193, s[28:31], s55 offen offset:1024 lds
    s_waitcnt vmcnt(8)
    buffer_load_dwordx4 v194, s[28:31], s55 offen offset:2048 lds
    s_waitcnt vmcnt(8)
    buffer_load_dwordx4 v195, s[28:31], s55 offen offset:3072 lds
    s_add_u32 m0, s14, 49152
    s_add_u32 s55, s10, s7
    s_waitcnt vmcnt(8)
    buffer_load_dwordx4 v192, s[28:31], s55 offen offset:0 lds
    s_waitcnt vmcnt(8)
    buffer_load_dwordx4 v193, s[28:31], s55 offen offset:1024 lds
    s_waitcnt vmcnt(8)
    buffer_load_dwordx4 v194, s[28:31], s55 offen offset:2048 lds
    s_waitcnt vmcnt(8)
    buffer_load_dwordx4 v195, s[28:31], s55 offen offset:3072 lds
    s_add_u32 m0, s14, 65536
    s_add_u32 s55, s11, s4
    s_waitcnt vmcnt(8)
    buffer_load_dwordx4 v192, s[28:31], s55 offen offset:0 lds
    s_waitcnt vmcnt(8)
    buffer_load_dwordx4 v193, s[28:31], s55 offen offset:1024 lds
    s_waitcnt vmcnt(8)
    buffer_load_dwordx4 v194, s[28:31], s55 offen offset:2048 lds
    s_waitcnt vmcnt(8)
    buffer_load_dwordx4 v195, s[28:31], s55 offen offset:3072 lds
RE4:
    s_waitcnt lgkmcnt(0)
    s_cmp_lg_u32 s53, 0
    s_cbranch_scc1 OK4
    s_sleep 4
    s_load_dwordx2 s[52:53], s[18:19], 0 glc
    s_sub_u32 s0, s0, 16
    s_cmp_lt_i32 s0, 0
    s_cbranch_scc0 RE4
    s_waitcnt lgkmcnt(0)
OK4:
    s_mov_b32 s53, s52
    s_barrier
    s_add_u32 m0, s15, 0
    s_lshl4_add_u32 s55, s56, 0
    s_waitcnt vmcnt(8)
    buffer_load_dwordx4 v1, s[36:39], s55 offen offset:0 lds
    s_waitcnt vmcnt(8)
    buffer_load_dwordx4 v2, s[36:39], s55 offen offset:1024 lds
    s_add_u32 m0, s15, 2048
    s_lshl4_add_u32 s55, s56, 16384
    s_waitcnt vmcnt(8)
    buffer_load_dwordx4 v1, s[36:39], s55 offen offset:0 lds
    s_waitcnt vmcnt(8)
    buffer_load_dwordx4 v2, s[36:39], s55 offen offset:1024 lds
    s_add_u32 m0, s15, 4096
    s_lshl4_add_u32 s55, s57, 0
    s_waitcnt vmcnt(8)
    buffer_load_dwordx4 v1, s[36:39], s55 offen offset:0 lds
    s_waitcnt vmcnt(8)
    buffer_load_dwordx4 v2, s[36:39], s55 offen offset:1024 lds
    s_barrier
    s_add_u32 m0, s15, 6144
    s_lshl4_add_u32 s55, s57, 16384
    s_waitcnt vmcnt(8)
    buffer_load_dwordx4 v1, s[36:39], s55 offen offset:0 lds
    s_waitcnt vmcnt(8)
    buffer_load_dwordx4 v2, s[36:39], s55 offen offset:1024 lds
    s_add_u32 m0, s15, 8192
    s_lshl4_add_u32 s55, s58, 65536
    s_waitcnt vmcnt(8)
    buffer_load_dwordx4 v1, s[36:39], s55 offen offset:0 lds
    s_waitcnt vmcnt(8)
    buffer_load_dwordx4 v2, s[36:39], s55 offen offset:1024 lds
    s_add_u32 m0, s15, 10240
    s_lshl4_add_u32 s55, s58, 81920
    s_waitcnt vmcnt(8)
    buffer_load_dwordx4 v1, s[36:39], s55 offen offset:0 lds
    s_waitcnt vmcnt(8)
    buffer_load_dwordx4 v2, s[36:39], s55 offen offset:1024 lds
    s_barrier
    s_add_u32 m0, s14, 0
    s_add_u32 s55, s11, s5
    s_waitcnt vmcnt(8)
    ds_read_b64_tr_b16 v[48:49], v0 offset:0
    ds_read_b64_tr_b16 v[50:51], v0 offset:2048
    ds_read_b64_tr_b16 v[52:53], v3 offset:0
    ds_read_b64_tr_b16 v[54:55], v3 offset:2048
    ds_read_b64_tr_b16 v[56:57], v4 offset:0
    ds_read_b64_tr_b16 v[58:59], v4 offset:2048
    ds_read_b64_tr_b16 v[60:61], v7 offset:0
    ds_read_b64_tr_b16 v[62:63], v7 offset:2048
    buffer_load_dwordx4 v192, s[28:31], s55 offen offset:0 lds
    s_waitcnt vmcnt(8)
    buffer_load_dwordx4 v193, s[28:31], s55 offen offset:1024 lds
    s_waitcnt vmcnt(8)
    buffer_load_dwordx4 v194, s[28:31], s55 offen offset:2048 lds
    s_waitcnt vmcnt(8)
    buffer_load_dwordx4 v195, s[28:31], s55 offen offset:3072 lds
    s_add_u32 m0, s15, 12288
    s_lshl4_add_u32 s55, s59, 65536
    s_waitcnt vmcnt(8)
    ds_read_b64_tr_b16 v[64:65], v0 offset:4096
    ds_read_b64_tr_b16 v[66:67], v0 offset:6144
    ds_read_b64_tr_b16 v[68:69], v3 offset:4096
    ds_read_b64_tr_b16 v[70:71], v3 offset:6144
    ds_read_b64_tr_b16 v[72:73], v4 offset:4096
    ds_read_b64_tr_b16 v[74:75], v4 offset:6144
    ds_read_b64_tr_b16 v[76:77], v7 offset:4096
    ds_read_b64_tr_b16 v[78:79], v7 offset:6144
    buffer_load_dwordx4 v1, s[36:39], s55 offen offset:0 lds
    s_waitcnt vmcnt(8)
    buffer_load_dwordx4 v2, s[36:39], s55 offen offset:1024 lds
    s_barrier
    s_add_u32 m0, s14, 16384
    s_add_u32 s55, s11, s6
    s_waitcnt vmcnt(8)
    buffer_load_dwordx4 v192, s[28:31], s55 offen offset:0 lds
    s_waitcnt vmcnt(8)
    buffer_load_dwordx4 v193, s[28:31], s55 offen offset:1024 lds
    s_waitcnt vmcnt(8)
    ds_read_b64_tr_b16 v[80:81], v0 offset:8192
    ds_read_b64_tr_b16 v[82:83], v0 offset:10240
    ds_read_b64_tr_b16 v[84:85], v3 offset:8192
    ds_read_b64_tr_b16 v[86:87], v3 offset:10240
    ds_read_b64_tr_b16 v[88:89], v4 offset:8192
    ds_read_b64_tr_b16 v[90:91], v4 offset:10240
    ds_read_b64_tr_b16 v[92:93], v7 offset:8192
    ds_read_b64_tr_b16 v[94:95], v7 offset:10240
    buffer_load_dwordx4 v194, s[28:31], s55 offen offset:2048 lds
    s_waitcnt vmcnt(8)
    buffer_load_dwordx4 v195, s[28:31], s55 offen offset:3072 lds
    s_add_u32 m0, s15, 14336
    s_lshl4_add_u32 s55, s59, 81920
    s_waitcnt vmcnt(8)
    buffer_load_dwordx4 v1, s[36:39], s55 offen offset:0 lds
    s_waitcnt vmcnt(8)
    buffer_load_dwordx4 v2, s[36:39], s55 offen offset:1024 lds
    s_barrier
    s_add_u32 m0, s14, 32768
    s_add_u32 s55, s11, s7
    s_waitcnt vmcnt(8)
    buffer_load_dwordx4 v192, s[28:31], s55 offen offset:0 lds
    s_waitcnt vmcnt(8)
    buffer_load_dwordx4 v193, s[28:31], s55 offen offset:1024 lds
    s_waitcnt vmcnt(8)
    buffer_load_dwordx4 v194, s[28:31], s55 offen offset:2048 lds
    s_waitcnt vmcnt(8)
    buffer_load_dwordx4 v195, s[28:31], s55 offen offset:3072 lds
    s_waitcnt lgkmcnt(14)
    s_add_u32 m0, s15, 0
    s_lshl4_add_u32 s55, s56, 131072
    s_waitcnt vmcnt(8)
    buffer_load_dwordx4 v1, s[36:39], s55 offen offset:0 lds
    s_waitcnt vmcnt(8)
    buffer_load_dwordx4 v2, s[36:39], s55 offen offset:1024 lds
    s_add_u32 m0, s15, 2048
    s_lshl4_add_u32 s55, s56, 147456
    s_waitcnt vmcnt(8)
    buffer_load_dwordx4 v1, s[36:39], s55 offen offset:0 lds
    s_waitcnt vmcnt(8)
    buffer_load_dwordx4 v2, s[36:39], s55 offen offset:1024 lds
    s_barrier
    s_add_u32 m0, s14, 49152
    s_add_u32 s55, s12, s4
    s_waitcnt vmcnt(8)
    ds_read_b64_tr_b16 v[96:97], v0 offset:12288
    ds_read_b64_tr_b16 v[98:99], v0 offset:14336
    ds_read_b64_tr_b16 v[100:101], v3 offset:12288
    ds_read_b64_tr_b16 v[102:103], v3 offset:14336
    ds_read_b64_tr_b16 v[104:105], v4 offset:12288
    ds_read_b64_tr_b16 v[106:107], v4 offset:14336
    ds_read_b64_tr_b16 v[108:109], v7 offset:12288
    ds_read_b64_tr_b16 v[110:111], v7 offset:14336
    buffer_load_dwordx4 v192, s[28:31], s55 offen offset:0 lds
    s_waitcnt vmcnt(8)
    buffer_load_dwordx4 v193, s[28:31], s55 offen offset:1024 lds
    s_waitcnt vmcnt(8)
    buffer_load_dwordx4 v194, s[28:31], s55 offen offset:2048 lds
    s_waitcnt vmcnt(8)
    buffer_load_dwordx4 v195, s[28:31], s55 offen offset:3072 lds
    s_waitcnt lgkmcnt(14)
    s_add_u32 m0, s15, 4096
    s_lshl4_add_u32 s55, s57, 131072
    s_waitcnt vmcnt(8)
    buffer_load_dwordx4 v1, s[36:39], s55 offen offset:0 lds
    s_waitcnt vmcnt(8)
    buffer_load_dwordx4 v2, s[36:39], s55 offen offset:1024 lds
    s_add_u32 m0, s15, 6144
    s_lshl4_add_u32 s55, s57, 147456
    s_waitcnt vmcnt(8)
    buffer_load_dwordx4 v1, s[36:39], s55 offen offset:0 lds
    s_waitcnt vmcnt(8)
    buffer_load_dwordx4 v2, s[36:39], s55 offen offset:1024 lds
    s_barrier
    s_add_u32 m0, s14, 65536
    s_add_u32 s55, s12, s5
    s_waitcnt vmcnt(8)
    ds_read_b64_tr_b16 v[112:113], v0 offset:0
    ds_read_b64_tr_b16 v[114:115], v0 offset:2048
    ds_read_b64_tr_b16 v[116:117], v3 offset:0
    ds_read_b64_tr_b16 v[118:119], v3 offset:2048
    ds_read_b64_tr_b16 v[120:121], v4 offset:0
    ds_read_b64_tr_b16 v[122:123], v4 offset:2048
    ds_read_b64_tr_b16 v[124:125], v7 offset:0
    ds_read_b64_tr_b16 v[126:127], v7 offset:2048
    buffer_load_dwordx4 v192, s[28:31], s55 offen offset:0 lds
    s_waitcnt vmcnt(8)
    buffer_load_dwordx4 v193, s[28:31], s55 offen offset:1024 lds
    s_waitcnt vmcnt(8)
    buffer_load_dwordx4 v194, s[28:31], s55 offen offset:2048 lds
    s_waitcnt vmcnt(8)
    buffer_load_dwordx4 v195, s[28:31], s55 offen offset:3072 lds
    s_waitcnt lgkmcnt(14)
    s_add_u32 m0, s15, 8192
    s_lshl4_add_u32 s55, s58, 131072
    s_waitcnt vmcnt(8)
    buffer_load_dwordx4 v1, s[36:39], s55 offen offset:0 lds
    s_waitcnt vmcnt(8)
    buffer_load_dwordx4 v2, s[36:39], s55 offen offset:1024 lds
    s_add_u32 m0, s15, 10240
    s_lshl4_add_u32 s55, s58, 147456
    s_waitcnt vmcnt(8)
    buffer_load_dwordx4 v1, s[36:39], s55 offen offset:0 lds
    s_waitcnt vmcnt(8)
    buffer_load_dwordx4 v2, s[36:39], s55 offen offset:1024 lds
    s_barrier
    s_add_u32 m0, s14, 0
    s_add_u32 s55, s12, s6
    s_waitcnt vmcnt(8)
    ds_read_b64_tr_b16 v[128:129], v0 offset:4096
    ds_read_b64_tr_b16 v[130:131], v0 offset:6144
    ds_read_b64_tr_b16 v[132:133], v3 offset:4096
    ds_read_b64_tr_b16 v[134:135], v3 offset:6144
    ds_read_b64_tr_b16 v[136:137], v4 offset:4096
    ds_read_b64_tr_b16 v[138:139], v4 offset:6144
    ds_read_b64_tr_b16 v[140:141], v7 offset:4096
    ds_read_b64_tr_b16 v[142:143], v7 offset:6144
    buffer_load_dwordx4 v192, s[28:31], s55 offen offset:0 lds
    s_waitcnt vmcnt(8)
    buffer_load_dwordx4 v193, s[28:31], s55 offen offset:1024 lds
    s_waitcnt vmcnt(8)
    buffer_load_dwordx4 v194, s[28:31], s55 offen offset:2048 lds
    s_waitcnt vmcnt(8)
    buffer_load_dwordx4 v195, s[28:31], s55 offen offset:3072 lds
    s_waitcnt lgkmcnt(14)
    s_add_u32 m0, s15, 12288
    s_lshl4_add_u32 s55, s59, 131072
    s_waitcnt vmcnt(8)
    buffer_load_dwordx4 v1, s[36:39], s55 offen offset:0 lds
    s_waitcnt vmcnt(8)
    buffer_load_dwordx4 v2, s[36:39], s55 offen offset:1024 lds
    s_add_u32 m0, s15, 14336
    s_lshl4_add_u32 s55, s59, 147456
    s_waitcnt vmcnt(8)
    buffer_load_dwordx4 v1, s[36:39], s55 offen offset:0 lds
    s_waitcnt vmcnt(8)
    buffer_load_dwordx4 v2, s[36:39], s55 offen offset:1024 lds
    s_barrier
    s_add_u32 m0, s14, 16384
    s_add_u32 s55, s12, s7
    s_waitcnt vmcnt(8)
    ds_read_b64_tr_b16 v[144:145], v0 offset:8192
    ds_read_b64_tr_b16 v[146:147], v0 offset:10240
    ds_read_b64_tr_b16 v[148:149], v3 offset:8192
    ds_read_b64_tr_b16 v[150:151], v3 offset:10240
    ds_read_b64_tr_b16 v[152:153], v4 offset:8192
    ds_read_b64_tr_b16 v[154:155], v4 offset:10240
    ds_read_b64_tr_b16 v[156:157], v7 offset:8192
    ds_read_b64_tr_b16 v[158:159], v7 offset:10240
    buffer_load_dwordx4 v192, s[28:31], s55 offen offset:0 lds
    s_waitcnt vmcnt(8)
    buffer_load_dwordx4 v193, s[28:31], s55 offen offset:1024 lds
    s_waitcnt vmcnt(8)
    buffer_load_dwordx4 v194, s[28:31], s55 offen offset:2048 lds
    s_waitcnt vmcnt(8)
    buffer_load_dwordx4 v195, s[28:31], s55 offen offset:3072 lds
    s_waitcnt lgkmcnt(14)
    s_add_u32 m0, s15, 0
    s_lshl4_add_u32 s55, s60, 0
    s_waitcnt vmcnt(8)
    buffer_load_dwordx4 v1, s[36:39], s55 offen offset:0 lds
    s_waitcnt vmcnt(8)
    buffer_load_dwordx4 v2, s[36:39], s55 offen offset:1024 lds
    s_add_u32 m0, s15, 2048
    s_lshl4_add_u32 s55, s60, 16384
    s_waitcnt vmcnt(8)
    buffer_load_dwordx4 v1, s[36:39], s55 offen offset:0 lds
    s_waitcnt vmcnt(8)
    buffer_load_dwordx4 v2, s[36:39], s55 offen offset:1024 lds
    s_barrier
    s_add_u32 m0, s14, 32768
    s_add_u32 s55, s13, s8
    s_waitcnt vmcnt(8)
    ds_read_b64_tr_b16 v[160:161], v0 offset:12288
    ds_read_b64_tr_b16 v[162:163], v0 offset:14336
    ds_read_b64_tr_b16 v[164:165], v3 offset:12288
    ds_read_b64_tr_b16 v[166:167], v3 offset:14336
    ds_read_b64_tr_b16 v[168:169], v4 offset:12288
    ds_read_b64_tr_b16 v[170:171], v4 offset:14336
    ds_read_b64_tr_b16 v[172:173], v7 offset:12288
    ds_read_b64_tr_b16 v[174:175], v7 offset:14336
    buffer_load_dwordx4 v196, s[28:31], s55 offen offset:0 lds
    s_waitcnt vmcnt(8)
    buffer_load_dwordx4 v197, s[28:31], s55 offen offset:1024 lds
    s_waitcnt vmcnt(8)
    buffer_load_dwordx4 v198, s[28:31], s55 offen offset:2048 lds
    s_waitcnt vmcnt(8)
    buffer_load_dwordx4 v199, s[28:31], s55 offen offset:3072 lds
    s_waitcnt lgkmcnt(14)
    s_add_u32 m0, s15, 4096
    s_lshl4_add_u32 s55, s58, 0
    s_waitcnt vmcnt(8)
    buffer_load_dwordx4 v1, s[36:39], s55 offen offset:0 lds
    s_waitcnt vmcnt(8)
    buffer_load_dwordx4 v2, s[36:39], s55 offen offset:1024 lds
    s_add_u32 m0, s15, 6144
    s_lshl4_add_u32 s55, s58, 16384
    s_waitcnt vmcnt(8)
    buffer_load_dwordx4 v1, s[36:39], s55 offen offset:0 lds
    s_waitcnt vmcnt(8)
    buffer_load_dwordx4 v2, s[36:39], s55 offen offset:1024 lds
    s_barrier
    s_add_u32 m0, s14, 49152
    s_add_u32 s55, s13, s9
    s_waitcnt vmcnt(8)
    ds_read_b64_tr_b16 v[176:177], v0 offset:0
    ds_read_b64_tr_b16 v[178:179], v0 offset:2048
    ds_read_b64_tr_b16 v[180:181], v3 offset:0
    ds_read_b64_tr_b16 v[182:183], v3 offset:2048
    ds_read_b64_tr_b16 v[184:185], v4 offset:0
    ds_read_b64_tr_b16 v[186:187], v4 offset:2048
    ds_read_b64_tr_b16 v[188:189], v7 offset:0
    ds_read_b64_tr_b16 v[190:191], v7 offset:2048
    buffer_load_dwordx4 v196, s[28:31], s55 offen offset:0 lds
    s_waitcnt vmcnt(8)
    buffer_load_dwordx4 v197, s[28:31], s55 offen offset:1024 lds
    s_waitcnt vmcnt(8)
    buffer_load_dwordx4 v198, s[28:31], s55 offen offset:2048 lds
    s_waitcnt vmcnt(8)
    buffer_load_dwordx4 v199, s[28:31], s55 offen offset:3072 lds
    s_waitcnt lgkmcnt(14)
    s_add_u32 m0, s15, 8192
    s_lshl4_add_u32 s55, s59, 0
    s_waitcnt vmcnt(8)
    buffer_load_dwordx4 v1, s[36:39], s55 offen offset:0 lds
    s_waitcnt vmcnt(8)
    buffer_load_dwordx4 v2, s[36:39], s55 offen offset:1024 lds
    s_add_u32 m0, s15, 10240
    s_lshl4_add_u32 s55, s59, 16384
    s_waitcnt vmcnt(8)
    buffer_load_dwordx4 v1, s[36:39], s55 offen offset:0 lds
    s_waitcnt vmcnt(8)
    buffer_load_dwordx4 v2, s[36:39], s55 offen offset:1024 lds
    s_barrier
    s_waitcnt lgkmcnt(8)
    s_add_u32 m0, s15, 12288
    s_lshl4_add_u32 s55, s56, 65536
    s_waitcnt vmcnt(8)
    buffer_load_dwordx4 v1, s[36:39], s55 offen offset:0 lds
    s_waitcnt vmcnt(8)
    buffer_load_dwordx4 v2, s[36:39], s55 offen offset:1024 lds
    s_add_u32 m0, s15, 14336
    s_lshl4_add_u32 s55, s56, 81920
    s_waitcnt vmcnt(8)
    buffer_load_dwordx4 v1, s[36:39], s55 offen offset:0 lds
    s_waitcnt vmcnt(8)
    buffer_load_dwordx4 v2, s[36:39], s55 offen offset:1024 lds
    s_waitcnt lgkmcnt(0)
    s_add_u32 m0, s15, 0
    s_lshl4_add_u32 s55, s57, 65536
    s_waitcnt vmcnt(8)
    buffer_load_dwordx4 v1, s[36:39], s55 offen offset:0 lds
    s_waitcnt vmcnt(8)
    buffer_load_dwordx4 v2, s[36:39], s55 offen offset:1024 lds
    s_load_dwordx4 s[28:31], s[16:17], 0 glc
    s_barrier
    s_add_u32 m0, s15, 2048
    s_lshl4_add_u32 s55, s57, 81920
    s_waitcnt vmcnt(8)
    buffer_load_dwordx4 v1, s[36:39], s55 offen offset:0 lds
    s_waitcnt vmcnt(8)
    buffer_load_dwordx4 v2, s[36:39], s55 offen offset:1024 lds
    s_add_u32 m0, s14, 81920
    s_lshl4_add_u32 s55, s67, 0
    s_waitcnt vmcnt(8)
    buffer_load_dwordx4 v1, s[40:43], s55 offen offset:0 lds
    s_waitcnt vmcnt(8)
    buffer_load_dwordx4 v2, s[40:43], s55 offen offset:1024 lds
    s_add_u32 m0, s14, 83968
    s_lshl4_add_u32 s55, s67, 16384
    s_waitcnt vmcnt(8)
    buffer_load_dwordx4 v1, s[40:43], s55 offen offset:0 lds
    s_waitcnt vmcnt(8)
    buffer_load_dwordx4 v2, s[40:43], s55 offen offset:1024 lds
RE5:
    s_waitcnt lgkmcnt(0)
    s_xor_b64 s[28:29], s[28:29], s[52:53]
    s_xor_b64 s[30:31], s[30:31], s[52:53]
    s_or_b64 s[28:29], s[28:29], s[30:31]
    s_cbranch_scc0 OK5
    s_sleep 1
    s_load_dwordx4 s[28:31], s[16:17], 0 glc
    s_sub_u32 s0, s0, 16
    s_cmp_lt_i32 s0, 0
    s_cbranch_scc0 RE5
    s_waitcnt lgkmcnt(0)
OK5:
    s_add_u32 s70, s56, s68
    buffer_load_dwordx4 v[8:11], v5, s[32:35], s70 offen sc1
    buffer_load_dwordx4 v[12:15], v6, s[32:35], s70 offen sc1
    s_add_u32 s70, s56, s69
    buffer_load_dwordx4 v[16:19], v5, s[32:35], s70 offen sc1
    buffer_load_dwordx4 v[20:23], v6, s[32:35], s70 offen sc1
    s_add_u32 s70, s57, s68
    buffer_load_dwordx4 v[24:27], v5, s[32:35], s70 offen sc1
    buffer_load_dwordx4 v[28:31], v6, s[32:35], s70 offen sc1
    s_add_u32 s70, s57, s69
    buffer_load_dwordx4 v[32:35], v5, s[32:35], s70 offen sc1
    buffer_load_dwordx4 v[36:39], v6, s[32:35], s70 offen sc1
    s_add_u32 s70, s58, s68
    buffer_load_dwordx4 v[40:43], v5, s[32:35], s70 offen sc1
    buffer_load_dwordx4 v[44:47], v6, s[32:35], s70 offen sc1
    s_load_dwordx4 s[28:31], s[16:17], 16 glc
    s_waitcnt vmcnt(9)
    v_mfma_f32_16x16x32_bf16 v[192:195], v[48:51], v[8:11], 0
    v_mfma_f32_16x16x32_bf16 v[196:199], v[52:55], v[8:11], 0
    v_mfma_f32_16x16x32_bf16 v[200:203], v[56:59], v[8:11], 0
    v_mfma_f32_16x16x32_bf16 v[204:207], v[60:63], v[8:11], 0
    s_add_u32 s70, s58, s69
    s_waitcnt vmcnt(8)
    v_mfma_f32_16x16x32_bf16 v[220:223], v[60:63], v[12:15], 0
    buffer_load_dwordx4 v[8:11], v5, s[32:35], s70 offen sc1
    v_mfma_f32_16x16x32_bf16 v[216:219], v[56:59], v[12:15], 0
    v_mfma_f32_16x16x32_bf16 v[212:215], v[52:55], v[12:15], 0
    v_mfma_f32_16x16x32_bf16 v[208:211], v[48:51], v[12:15], 0
    s_waitcnt vmcnt(8)
    v_mfma_f32_16x16x32_bf16 v[224:227], v[48:51], v[16:19], 0
    buffer_load_dwordx4 v[12:15], v6, s[32:35], s70 offen sc1
    v_mfma_f32_16x16x32_bf16 v[228:231], v[52:55], v[16:19], 0
    v_mfma_f32_16x16x32_bf16 v[232:235], v[56:59], v[16:19], 0
    v_mfma_f32_16x16x32_bf16 v[236:239], v[60:63], v[16:19], 0
    s_add_u32 s70, s59, s68
    s_waitcnt vmcnt(8)
    v_mfma_f32_16x16x32_bf16 v[252:255], v[60:63], v[20:23], 0
    buffer_load_dwordx4 v[16:19], v5, s[32:35], s70 offen sc1
    v_mfma_f32_16x16x32_bf16 v[248:251], v[56:59], v[20:23], 0
    v_mfma_f32_16x16x32_bf16 v[244:247], v[52:55], v[20:23], 0
    v_mfma_f32_16x16x32_bf16 v[240:243], v[48:51], v[20:23], 0
    s_waitcnt vmcnt(8)
    v_mfma_f32_16x16x32_bf16 v[192:195], v[64:67], v[24:27], v[192:195]
    buffer_load_dwordx4 v[20:23], v6, s[32:35], s70 offen sc1
    v_mfma_f32_16x16x32_bf16 v[196:199], v[68:71], v[24:27], v[196:199]
    ds_read_b64_tr_b16 v[48:49], v0 offset:4096
    v_mfma_f32_16x16x32_bf16 v[200:203], v[72:75], v[24:27], v[200:203]
    ds_read_b64_tr_b16 v[50:51], v0 offset:6144
    v_mfma_f32_16x16x32_bf16 v[204:207], v[76:79], v[24:27], v[204:207]
    ds_read_b64_tr_b16 v[52:53], v3 offset:4096
    s_add_u32 s70, s59, s69
    s_waitcnt vmcnt(8)
    v_mfma_f32_16x16x32_bf16 v[220:223], v[76:79], v[28:31], v[220:223]
    buffer_load_dwordx4 v[24:27], v5, s[32:35], s70 offen sc1
    v_mfma_f32_16x16x32_bf16 v[216:219], v[72:75], v[28:31], v[216:219]
    ds_read_b64_tr_b16 v[54:55], v3 offset:6144
    v_mfma_f32_16x16x32_bf16 v[212:215], v[68:71], v[28:31], v[212:215]
    ds_read_b64_tr_b16 v[56:57], v4 offset:4096
    v_mfma_f32_16x16x32_bf16 v[208:211], v[64:67], v[28:31], v[208:211]
    ds_read_b64_tr_b16 v[58:59], v4 offset:6144
    s_waitcnt vmcnt(8)
    v_mfma_f32_16x16x32_bf16 v[224:227], v[64:67], v[32:35], v[224:227]
    buffer_load_dwordx4 v[28:31], v6, s[32:35], s70 offen sc1
    v_mfma_f32_16x16x32_bf16 v[228:231], v[68:71], v[32:35], v[228:231]
    ds_read_b64_tr_b16 v[60:61], v7 offset:4096
    v_mfma_f32_16x16x32_bf16 v[232:235], v[72:75], v[32:35], v[232:235]
    ds_read_b64_tr_b16 v[62:63], v7 offset:6144
    v_mfma_f32_16x16x32_bf16 v[236:239], v[76:79], v[32:35], v[236:239]
RE6:
    s_waitcnt lgkmcnt(0)
    s_xor_b64 s[28:29], s[28:29], s[52:53]
    s_xor_b64 s[30:31], s[30:31], s[52:53]
    s_or_b64 s[28:29], s[28:29], s[30:31]
    s_cbranch_scc0 OK6
    s_sleep 1
    s_load_dwordx4 s[28:31], s[16:17], 16 glc
    s_sub_u32 s0, s0, 16
    s_cmp_lt_i32 s0, 0
    s_cbranch_scc0 RE6
    s_waitcnt lgkmcnt(0)
OK6:
    s_add_i32 s68, s68, 4096
    s_add_i32 s69, s69, 4096
    s_add_u32 s70, s56, s68
    s_waitcnt vmcnt(8)
    v_mfma_f32_16x16x32_bf16 v[252:255], v[76:79], v[36:39], v[252:255]
    buffer_load_dwordx4 v[32:35], v5, s[32:35], s70 offen sc1
    v_mfma_f32_16x16x32_bf16 v[248:251], v[72:75], v[36:39], v[248:251]
    v_mfma_f32_16x16x32_bf16 v[244:247], v[68:71], v[36:39], v[244:247]
    v_mfma_f32_16x16x32_bf16 v[240:243], v[64:67], v[36:39], v[240:243]
    s_waitcnt vmcnt(8)
    v_mfma_f32_16x16x32_bf16 v[192:195], v[48:51], v[40:43], v[192:195]
    buffer_load_dwordx4 v[36:39], v6, s[32:35], s70 offen sc1
    v_mfma_f32_16x16x32_bf16 v[196:199], v[52:55], v[40:43], v[196:199]
    ds_read_b64_tr_b16 v[64:65], v0 offset:8192
    v_mfma_f32_16x16x32_bf16 v[200:203], v[56:59], v[40:43], v[200:203]
    ds_read_b64_tr_b16 v[66:67], v0 offset:10240
    v_mfma_f32_16x16x32_bf16 v[204:207], v[60:63], v[40:43], v[204:207]
    ds_read_b64_tr_b16 v[68:69], v3 offset:8192
    s_add_u32 s70, s56, s69
    s_waitcnt vmcnt(8)
    v_mfma_f32_16x16x32_bf16 v[220:223], v[60:63], v[44:47], v[220:223]
    buffer_load_dwordx4 v[40:43], v5, s[32:35], s70 offen sc1
    v_mfma_f32_16x16x32_bf16 v[216:219], v[56:59], v[44:47], v[216:219]
    ds_read_b64_tr_b16 v[70:71], v3 offset:10240
    v_mfma_f32_16x16x32_bf16 v[212:215], v[52:55], v[44:47], v[212:215]
    ds_read_b64_tr_b16 v[72:73], v4 offset:8192
    v_mfma_f32_16x16x32_bf16 v[208:211], v[48:51], v[44:47], v[208:211]
    ds_read_b64_tr_b16 v[74:75], v4 offset:10240
    s_waitcnt vmcnt(8)
    v_mfma_f32_16x16x32_bf16 v[224:227], v[48:51], v[8:11], v[224:227]
    buffer_load_dwordx4 v[44:47], v6, s[32:35], s70 offen sc1
    v_mfma_f32_16x16x32_bf16 v[228:231], v[52:55], v[8:11], v[228:231]
    ds_read_b64_tr_b16 v[76:77], v7 offset:8192
    v_mfma_f32_16x16x32_bf16 v[232:235], v[56:59], v[8:11], v[232:235]
    ds_read_b64_tr_b16 v[78:79], v7 offset:10240
    v_mfma_f32_16x16x32_bf16 v[236:239], v[60:63], v[8:11], v[236:239]
    s_add_u32 m0, s15, 4096
    s_lshl4_add_u32 s55, s61, 0
    buffer_load_dwordx4 v1, s[36:39], s55 offen offset:0 lds
    buffer_load_dwordx4 v2, s[36:39], s55 offen offset:1024 lds
    s_add_u32 s70, s57, s68
    s_waitcnt vmcnt(10)
    v_mfma_f32_16x16x32_bf16 v[252:255], v[60:63], v[12:15], v[252:255]
    buffer_load_dwordx4 v[8:11], v5, s[32:35], s70 offen sc1
    v_mfma_f32_16x16x32_bf16 v[248:251], v[56:59], v[12:15], v[248:251]
    v_mfma_f32_16x16x32_bf16 v[244:247], v[52:55], v[12:15], v[244:247]
    v_mfma_f32_16x16x32_bf16 v[240:243], v[48:51], v[12:15], v[240:243]
    s_add_u32 m0, s15, 6144
    s_lshl4_add_u32 s55, s61, 16384
    buffer_load_dwordx4 v1, s[36:39], s55 offen offset:0 lds
    buffer_load_dwordx4 v2, s[36:39], s55 offen offset:1024 lds
    s_waitcnt vmcnt(12) lgkmcnt(6)
    v_mfma_f32_16x16x32_bf16 v[192:195], v[64:67], v[16:19], v[192:195]
    buffer_load_dwordx4 v[12:15], v6, s[32:35], s70 offen sc1
    s_waitcnt lgkmcnt(4)
    v_mfma_f32_16x16x32_bf16 v[196:199], v[68:71], v[16:19], v[196:199]
    ds_read_b64_tr_b16 v[48:49], v0 offset:12288
    s_waitcnt lgkmcnt(3)
    v_mfma_f32_16x16x32_bf16 v[200:203], v[72:75], v[16:19], v[200:203]
    ds_read_b64_tr_b16 v[50:51], v0 offset:14336
    s_waitcnt lgkmcnt(2)
    v_mfma_f32_16x16x32_bf16 v[204:207], v[76:79], v[16:19], v[204:207]
    ds_read_b64_tr_b16 v[52:53], v3 offset:12288
    s_add_u32 s70, s57, s69
    s_waitcnt vmcnt(12)
    v_mfma_f32_16x16x32_bf16 v[220:223], v[76:79], v[20:23], v[220:223]
    buffer_load_dwordx4 v[16:19], v5, s[32:35], s70 offen sc1
    v_mfma_f32_16x16x32_bf16 v[216:219], v[72:75], v[20:23], v[216:219]
    ds_read_b64_tr_b16 v[54:55], v3 offset:14336
    v_mfma_f32_16x16x32_bf16 v[212:215], v[68:71], v[20:23], v[212:215]
    ds_read_b64_tr_b16 v[56:57], v4 offset:12288
    v_mfma_f32_16x16x32_bf16 v[208:211], v[64:67], v[20:23], v[208:211]
    ds_read_b64_tr_b16 v[58:59], v4 offset:14336
    s_waitcnt vmcnt(12)
    v_mfma_f32_16x16x32_bf16 v[224:227], v[64:67], v[24:27], v[224:227]
    buffer_load_dwordx4 v[20:23], v6, s[32:35], s70 offen sc1
    v_mfma_f32_16x16x32_bf16 v[228:231], v[68:71], v[24:27], v[228:231]
    ds_read_b64_tr_b16 v[60:61], v7 offset:12288
    v_mfma_f32_16x16x32_bf16 v[232:235], v[72:75], v[24:27], v[232:235]
    ds_read_b64_tr_b16 v[62:63], v7 offset:14336
    v_mfma_f32_16x16x32_bf16 v[236:239], v[76:79], v[24:27], v[236:239]
    s_add_u32 m0, s15, 8192
    s_lshl4_add_u32 s55, s64, 0
    buffer_load_dwordx4 v1, s[40:43], s55 offen offset:0 lds
    buffer_load_dwordx4 v2, s[40:43], s55 offen offset:1024 lds
    s_add_u32 s70, s58, s68
    s_waitcnt vmcnt(14)
    v_mfma_f32_16x16x32_bf16 v[252:255], v[76:79], v[28:31], v[252:255]
    buffer_load_dwordx4 v[24:27], v5, s[32:35], s70 offen sc1
    s_load_dwordx4 s[28:31], s[16:17], 32 glc
    v_mfma_f32_16x16x32_bf16 v[248:251], v[72:75], v[28:31], v[248:251]
    v_mfma_f32_16x16x32_bf16 v[244:247], v[68:71], v[28:31], v[244:247]
    v_mfma_f32_16x16x32_bf16 v[240:243], v[64:67], v[28:31], v[240:243]
    s_add_u32 m0, s15, 10240
    s_lshl4_add_u32 s55, s64, 16384
    buffer_load_dwordx4 v1, s[40:43], s55 offen offset:0 lds
    buffer_load_dwordx4 v2, s[40:43], s55 offen offset:1024 lds
    s_waitcnt vmcnt(16) lgkmcnt(6)
    v_mfma_f32_16x16x32_bf16 v[192:195], v[48:51], v[32:35], v[192:195]
    buffer_load_dwordx4 v[28:31], v6, s[32:35], s70 offen sc1
    s_waitcnt lgkmcnt(4)
    v_mfma_f32_16x16x32_bf16 v[196:199], v[52:55], v[32:35], v[196:199]
    ds_read_b64_tr_b16 v[64:65], v0 offset:0
    s_waitcnt lgkmcnt(3)
    v_mfma_f32_16x16x32_bf16 v[200:203], v[56:59], v[32:35], v[200:203]
    ds_read_b64_tr_b16 v[66:67], v0 offset:2048
    s_waitcnt lgkmcnt(2)
    v_mfma_f32_16x16x32_bf16 v[204:207], v[60:63], v[32:35], v[204:207]
    ds_read_b64_tr_b16 v[68:69], v3 offset:0
    s_add_u32 s70, s58, s69
    s_waitcnt vmcnt(16)
    v_mfma_f32_16x16x32_bf16 v[220:223], v[60:63], v[36:39], v[220:223]
    buffer_load_dwordx4 v[32:35], v5, s[32:35], s70 offen sc1
    v_mfma_f32_16x16x32_bf16 v[216:219], v[56:59], v[36:39], v[216:219]
    ds_read_b64_tr_b16 v[70:71], v3 offset:2048
    v_mfma_f32_16x16x32_bf16 v[212:215], v[52:55], v[36:39], v[212:215]
    ds_read_b64_tr_b16 v[72:73], v4 offset:0
    v_mfma_f32_16x16x32_bf16 v[208:211], v[48:51], v[36:39], v[208:211]
    ds_read_b64_tr_b16 v[74:75], v4 offset:2048
    s_waitcnt vmcnt(16)
    v_mfma_f32_16x16x32_bf16 v[224:227], v[48:51], v[40:43], v[224:227]
    buffer_load_dwordx4 v[36:39], v6, s[32:35], s70 offen sc1
    v_mfma_f32_16x16x32_bf16 v[228:231], v[52:55], v[40:43], v[228:231]
    ds_read_b64_tr_b16 v[76:77], v7 offset:0
    v_mfma_f32_16x16x32_bf16 v[232:235], v[56:59], v[40:43], v[232:235]
    ds_read_b64_tr_b16 v[78:79], v7 offset:2048
    v_mfma_f32_16x16x32_bf16 v[236:239], v[60:63], v[40:43], v[236:239]
    s_add_u32 m0, s15, 12288
    s_lshl4_add_u32 s55, s65, 0
    buffer_load_dwordx4 v1, s[40:43], s55 offen offset:0 lds
    buffer_load_dwordx4 v2, s[40:43], s55 offen offset:1024 lds
    s_add_u32 s70, s59, s68
    s_waitcnt vmcnt(18)
    v_mfma_f32_16x16x32_bf16 v[252:255], v[60:63], v[44:47], v[252:255]
    buffer_load_dwordx4 v[40:43], v5, s[32:35], s70 offen sc1
    v_mfma_f32_16x16x32_bf16 v[248:251], v[56:59], v[44:47], v[248:251]
    v_mfma_f32_16x16x32_bf16 v[244:247], v[52:55], v[44:47], v[244:247]
    v_mfma_f32_16x16x32_bf16 v[240:243], v[48:51], v[44:47], v[240:243]
    s_add_u32 m0, s15, 14336
    s_lshl4_add_u32 s55, s65, 16384
    buffer_load_dwordx4 v1, s[40:43], s55 offen offset:0 lds
    buffer_load_dwordx4 v2, s[40:43], s55 offen offset:1024 lds
    s_waitcnt vmcnt(18) lgkmcnt(6)
    v_mfma_f32_16x16x32_bf16 v[192:195], v[64:67], v[8:11], v[192:195]
    buffer_load_dwordx4 v[44:47], v6, s[32:35], s70 offen sc1
    s_waitcnt lgkmcnt(4)
    v_mfma_f32_16x16x32_bf16 v[196:199], v[68:71], v[8:11], v[196:199]
    s_waitcnt lgkmcnt(2)
    v_mfma_f32_16x16x32_bf16 v[200:203], v[72:75], v[8:11], v[200:203]
    s_waitcnt lgkmcnt(0)
    v_mfma_f32_16x16x32_bf16 v[204:207], v[76:79], v[8:11], v[204:207]
    s_add_u32 s70, s59, s69
    s_waitcnt vmcnt(16)
    v_mfma_f32_16x16x32_bf16 v[220:223], v[76:79], v[12:15], v[220:223]
    buffer_load_dwordx4 v[8:11], v5, s[32:35], s70 offen sc1
    v_mfma_f32_16x16x32_bf16 v[216:219], v[72:75], v[12:15], v[216:219]
    v_mfma_f32_16x16x32_bf16 v[212:215], v[68:71], v[12:15], v[212:215]
    v_mfma_f32_16x16x32_bf16 v[208:211], v[64:67], v[12:15], v[208:211]
    s_waitcnt vmcnt(16)
    v_mfma_f32_16x16x32_bf16 v[224:227], v[64:67], v[16:19], v[224:227]
    buffer_load_dwordx4 v[12:15], v6, s[32:35], s70 offen sc1
    v_mfma_f32_16x16x32_bf16 v[228:231], v[68:71], v[16:19], v[228:231]
    v_mfma_f32_16x16x32_bf16 v[232:235], v[72:75], v[16:19], v[232:235]
    v_mfma_f32_16x16x32_bf16 v[236:239], v[76:79], v[16:19], v[236:239]
    s_add_u32 m0, s15, 0
    s_lshl4_add_u32 s55, s66, 0
    buffer_load_dwordx4 v1, s[40:43], s55 offen offset:0 lds
    buffer_load_dwordx4 v2, s[40:43], s55 offen offset:1024 lds
RE7:
    s_waitcnt lgkmcnt(0)
    s_xor_b64 s[28:29], s[28:29], s[52:53]
    s_xor_b64 s[30:31], s[30:31], s[52:53]
    s_or_b64 s[28:29], s[28:29], s[30:31]
    s_cbranch_scc0 OK7
    s_sleep 1
    s_load_dwordx4 s[28:31], s[16:17], 32 glc
    s_sub_u32 s0, s0, 16
    s_cmp_lt_i32 s0, 0
    s_cbranch_scc0 RE7
    s_waitcnt lgkmcnt(0)
OK7:
    s_add_i32 s68, s68, 4096
    s_add_i32 s69, s69, 4096
    s_add_u32 s70, s56, s68
    s_waitcnt vmcnt(18)
    v_mfma_f32_16x16x32_bf16 v[252:255], v[76:79], v[20:23], v[252:255]
    buffer_load_dwordx4 v[16:19], v5, s[32:35], s70 offen sc1
    v_mfma_f32_16x16x32_bf16 v[248:251], v[72:75], v[20:23], v[248:251]
    v_mfma_f32_16x16x32_bf16 v[244:247], v[68:71], v[20:23], v[244:247]
    v_mfma_f32_16x16x32_bf16 v[240:243], v[64:67], v[20:23], v[240:243]
    s_add_u32 m0, s15, 2048
    s_lshl4_add_u32 s55, s66, 16384
    buffer_load_dwordx4 v1, s[40:43], s55 offen offset:0 lds
    buffer_load_dwordx4 v2, s[40:43], s55 offen offset:1024 lds
    s_waitcnt vmcnt(18)
    v_mfma_f32_16x16x32_bf16 v[192:195], v[80:83], v[24:27], v[192:195]
    buffer_load_dwordx4 v[20:23], v6, s[32:35], s70 offen sc1
    v_mfma_f32_16x16x32_bf16 v[196:199], v[84:87], v[24:27], v[196:199]
    ds_read_b64_tr_b16 v[48:49], v0 offset:4096
    v_mfma_f32_16x16x32_bf16 v[200:203], v[88:91], v[24:27], v[200:203]
    ds_read_b64_tr_b16 v[50:51], v0 offset:6144
    v_mfma_f32_16x16x32_bf16 v[204:207], v[92:95], v[24:27], v[204:207]
    s_add_u32 s70, s56, s69
    s_waitcnt vmcnt(16)
    v_mfma_f32_16x16x32_bf16 v[220:223], v[92:95], v[28:31], v[220:223]
    buffer_load_dwordx4 v[24:27], v5, s[32:35], s70 offen sc1
    v_mfma_f32_16x16x32_bf16 v[216:219], v[88:91], v[28:31], v[216:219]
    ds_read_b64_tr_b16 v[52:53], v3 offset:4096
    v_mfma_f32_16x16x32_bf16 v[212:215], v[84:87], v[28:31], v[212:215]
    v_mfma_f32_16x16x32_bf16 v[208:211], v[80:83], v[28:31], v[208:211]
    s_waitcnt vmcnt(16)
    v_mfma_f32_16x16x32_bf16 v[224:227], v[80:83], v[32:35], v[224:227]
    buffer_load_dwordx4 v[28:31], v6, s[32:35], s70 offen sc1
    v_mfma_f32_16x16x32_bf16 v[228:231], v[84:87], v[32:35], v[228:231]
    ds_read_b64_tr_b16 v[54:55], v3 offset:6144
    v_mfma_f32_16x16x32_bf16 v[232:235], v[88:91], v[32:35], v[232:235]
    v_mfma_f32_16x16x32_bf16 v[236:239], v[92:95], v[32:35], v[236:239]
    s_add_u32 s70, s57, s68
    s_waitcnt vmcnt(16)
    v_mfma_f32_16x16x32_bf16 v[252:255], v[92:95], v[36:39], v[252:255]
    buffer_load_dwordx4 v[32:35], v5, s[32:35], s70 offen sc1
    v_mfma_f32_16x16x32_bf16 v[248:251], v[88:91], v[36:39], v[248:251]
    ds_read_b64_tr_b16 v[56:57], v4 offset:4096
    v_mfma_f32_16x16x32_bf16 v[244:247], v[84:87], v[36:39], v[244:247]
    ds_read_b64_tr_b16 v[58:59], v4 offset:6144
    v_mfma_f32_16x16x32_bf16 v[240:243], v[80:83], v[36:39], v[240:243]
    s_waitcnt vmcnt(14)
    v_mfma_f32_16x16x32_bf16 v[192:195], v[96:99], v[40:43], v[192:195]
    buffer_load_dwordx4 v[36:39], v6, s[32:35], s70 offen sc1
    v_mfma_f32_16x16x32_bf16 v[196:199], v[100:103], v[40:43], v[196:199]
    ds_read_b64_tr_b16 v[60:61], v7 offset:4096
    v_mfma_f32_16x16x32_bf16 v[200:203], v[104:107], v[40:43], v[200:203]
    v_mbcnt_lo_u32_b32 v85, -1, 0
    v_mbcnt_hi_u32_b32 v85, -1, v85
    v_mfma_f32_16x16x32_bf16 v[204:207], v[108:111], v[40:43], v[204:207]
    s_add_u32 s70, s57, s69
    s_waitcnt vmcnt(12)
    v_mfma_f32_16x16x32_bf16 v[220:223], v[108:111], v[44:47], v[220:223]
    buffer_load_dwordx4 v[40:43], v5, s[32:35], s70 offen sc1
    v_mfma_f32_16x16x32_bf16 v[216:219], v[104:107], v[44:47], v[216:219]
    ds_read_b64_tr_b16 v[62:63], v7 offset:6144
    v_mfma_f32_16x16x32_bf16 v[212:215], v[100:103], v[44:47], v[212:215]
    v_and_b32 v84, 15, v85
    v_lshlrev_b32_e64 v84, 10, v84
    v_mfma_f32_16x16x32_bf16 v[208:211], v[96:99], v[44:47], v[208:211]
    s_waitcnt vmcnt(12)
    v_mfma_f32_16x16x32_bf16 v[224:227], v[96:99], v[8:11], v[224:227]
    buffer_load_dwordx4 v[44:47], v6, s[32:35], s70 offen sc1
    v_mfma_f32_16x16x32_bf16 v[228:231], v[100:103], v[8:11], v[228:231]
    ds_read_b64_tr_b16 v[64:65], v0 offset:8192
    v_mfma_f32_16x16x32_bf16 v[232:235], v[104:107], v[8:11], v[232:235]
    ds_read_b64_tr_b16 v[66:67], v0 offset:10240
    v_mfma_f32_16x16x32_bf16 v[236:239], v[108:111], v[8:11], v[236:239]
    s_add_u32 s70, s58, s68
    s_waitcnt vmcnt(12)
    v_mfma_f32_16x16x32_bf16 v[252:255], v[108:111], v[12:15], v[252:255]
    buffer_load_dwordx4 v[8:11], v5, s[32:35], s70 offen sc1
    s_load_dwordx4 s[28:31], s[16:17], 48 glc
    v_mfma_f32_16x16x32_bf16 v[248:251], v[104:107], v[12:15], v[248:251]
    ds_read_b64_tr_b16 v[68:69], v3 offset:8192
    v_mfma_f32_16x16x32_bf16 v[244:247], v[100:103], v[12:15], v[244:247]
    v_bfe_u32 v86, v85, 4, 1
    v_lshl_add_u32 v84, v86, 5, v84
    v_mfma_f32_16x16x32_bf16 v[240:243], v[96:99], v[12:15], v[240:243]
    s_waitcnt vmcnt(10)
    v_mfma_f32_16x16x32_bf16 v[192:195], v[112:115], v[16:19], v[192:195]
    buffer_load_dwordx4 v[12:15], v6, s[32:35], s70 offen sc1
    v_mfma_f32_16x16x32_bf16 v[196:199], v[116:119], v[16:19], v[196:199]
    ds_read_b64_tr_b16 v[70:71], v3 offset:10240
    v_mfma_f32_16x16x32_bf16 v[200:203], v[120:123], v[16:19], v[200:203]
    v_lshrrev_b32_e64 v86, 5, v85
    v_lshl_add_u32 v84, v86, 4, v84
    v_mfma_f32_16x16x32_bf16 v[204:207], v[124:127], v[16:19], v[204:207]
    s_add_u32 s70, s58, s69
    s_waitcnt vmcnt(8)
    v_mfma_f32_16x16x32_bf16 v[220:223], v[124:127], v[20:23], v[220:223]
    buffer_load_dwordx4 v[16:19], v5, s[32:35], s70 offen sc1
    v_mfma_f32_16x16x32_bf16 v[216:219], v[120:123], v[20:23], v[216:219]
    ds_read_b64_tr_b16 v[72:73], v4 offset:8192
    v_mfma_f32_16x16x32_bf16 v[212:215], v[116:119], v[20:23], v[212:215]
    ds_read_b64_tr_b16 v[74:75], v4 offset:10240
    v_mfma_f32_16x16x32_bf16 v[208:211], v[112:115], v[20:23], v[208:211]
    s_waitcnt vmcnt(8)
    v_mfma_f32_16x16x32_bf16 v[224:227], v[112:115], v[24:27], v[224:227]
    buffer_load_dwordx4 v[20:23], v6, s[32:35], s70 offen sc1
    v_mfma_f32_16x16x32_bf16 v[228:231], v[116:119], v[24:27], v[228:231]
    ds_read_b64_tr_b16 v[76:77], v7 offset:8192
    v_mfma_f32_16x16x32_bf16 v[232:235], v[120:123], v[24:27], v[232:235]
    v_lshlrev_b32 v85, 4, v85
    v_add_u32_e64 v86, s15, v85
    v_mfma_f32_16x16x32_bf16 v[236:239], v[124:127], v[24:27], v[236:239]
    s_add_u32 s70, s59, s68
    s_waitcnt vmcnt(8)
    v_mfma_f32_16x16x32_bf16 v[252:255], v[124:127], v[28:31], v[252:255]
    buffer_load_dwordx4 v[24:27], v5, s[32:35], s70 offen sc1
    v_mfma_f32_16x16x32_bf16 v[248:251], v[120:123], v[28:31], v[248:251]
    ds_read_b64_tr_b16 v[78:79], v7 offset:10240
    v_mfma_f32_16x16x32_bf16 v[244:247], v[116:119], v[28:31], v[244:247]
    s_sub_u32 s54, s14, s15
    s_add_u32 s54, s54, 81920
    v_mfma_f32_16x16x32_bf16 v[240:243], v[112:115], v[28:31], v[240:243]
    s_waitcnt vmcnt(8)
    v_mfma_f32_16x16x32_bf16 v[192:195], v[128:131], v[32:35], v[192:195]
    buffer_load_dwordx4 v[28:31], v6, s[32:35], s70 offen sc1
    v_mfma_f32_16x16x32_bf16 v[196:199], v[132:135], v[32:35], v[196:199]
    ds_read_b64_tr_b16 v[112:113], v0 offset:12288
    v_mfma_f32_16x16x32_bf16 v[200:203], v[136:139], v[32:35], v[200:203]
    ds_read_b64_tr_b16 v[114:115], v0 offset:14336
    v_mfma_f32_16x16x32_bf16 v[204:207], v[140:143], v[32:35], v[204:207]
    s_add_u32 s70, s59, s69
    s_waitcnt vmcnt(8)
    v_mfma_f32_16x16x32_bf16 v[220:223], v[140:143], v[36:39], v[220:223]
    buffer_load_dwordx4 v[32:35], v5, s[32:35], s70 offen sc1
    v_mfma_f32_16x16x32_bf16 v[216:219], v[136:139], v[36:39], v[216:219]
    ds_read_b64_tr_b16 v[116:117], v3 offset:12288
    v_mfma_f32_16x16x32_bf16 v[212:215], v[132:135], v[36:39], v[212:215]
    v_add_u32 v80, s54, v0
    v_add_u32 v81, s54, v3
    v_mfma_f32_16x16x32_bf16 v[208:211], v[128:131], v[36:39], v[208:211]
    s_waitcnt vmcnt(8)
    v_mfma_f32_16x16x32_bf16 v[224:227], v[128:131], v[40:43], v[224:227]
    buffer_load_dwordx4 v[36:39], v6, s[32:35], s70 offen sc1
    v_mfma_f32_16x16x32_bf16 v[228:231], v[132:135], v[40:43], v[228:231]
    ds_read_b64_tr_b16 v[118:119], v3 offset:14336
    v_mfma_f32_16x16x32_bf16 v[232:235], v[136:139], v[40:43], v[232:235]
    v_add_u32 v82, s54, v4
    v_add_u32_e64 v83, s54, v7
    v_mfma_f32_16x16x32_bf16 v[236:239], v[140:143], v[40:43], v[236:239]
RE8:
    s_waitcnt lgkmcnt(0)
    s_xor_b64 s[28:29], s[28:29], s[52:53]
    s_xor_b64 s[30:31], s[30:31], s[52:53]
    s_or_b64 s[28:29], s[28:29], s[30:31]
    s_cbranch_scc0 OK8
    s_sleep 1
    s_load_dwordx4 s[28:31], s[16:17], 48 glc
    s_sub_u32 s0, s0, 16
    s_cmp_lt_i32 s0, 0
    s_cbranch_scc0 RE8
    s_waitcnt lgkmcnt(0)
OK8:
    s_add_i32 s68, s68, -8192
    s_add_i32 s69, s69, -8192
    s_add_u32 s70, s60, s68
    s_waitcnt vmcnt(8)
    v_mfma_f32_16x16x32_bf16 v[252:255], v[140:143], v[44:47], v[252:255]
    buffer_load_dwordx4 v[40:43], v5, s[32:35], s70 offen sc1
    s_load_dwordx4 s[28:31], s[16:17], 64 glc
    v_mfma_f32_16x16x32_bf16 v[248:251], v[136:139], v[44:47], v[248:251]
    ds_read_b64_tr_b16 v[120:121], v4 offset:12288
    v_mfma_f32_16x16x32_bf16 v[244:247], v[132:135], v[44:47], v[244:247]
    ds_read_b64_tr_b16 v[122:123], v4 offset:14336
    v_mfma_f32_16x16x32_bf16 v[240:243], v[128:131], v[44:47], v[240:243]
    s_waitcnt vmcnt(8)
    v_mfma_f32_16x16x32_bf16 v[192:195], v[144:147], v[8:11], v[192:195]
    buffer_load_dwordx4 v[44:47], v6, s[32:35], s70 offen sc1
    v_mfma_f32_16x16x32_bf16 v[196:199], v[148:151], v[8:11], v[196:199]
    ds_read_b64_tr_b16 v[124:125], v7 offset:12288
    v_mfma_f32_16x16x32_bf16 v[200:203], v[152:155], v[8:11], v[200:203]
    v_mfma_f32_16x16x32_bf16 v[204:207], v[156:159], v[8:11], v[204:207]
    s_add_u32 s70, s60, s69
    s_waitcnt vmcnt(8)
    v_mfma_f32_16x16x32_bf16 v[220:223], v[156:159], v[12:15], v[220:223]
    buffer_load_dwordx4 v[8:11], v5, s[32:35], s70 offen sc1
    v_mfma_f32_16x16x32_bf16 v[216:219], v[152:155], v[12:15], v[216:219]
    ds_read_b64_tr_b16 v[126:127], v7 offset:14336
    v_mfma_f32_16x16x32_bf16 v[212:215], v[148:151], v[12:15], v[212:215]
    v_mfma_f32_16x16x32_bf16 v[208:211], v[144:147], v[12:15], v[208:211]
    s_waitcnt vmcnt(8)
    v_mfma_f32_16x16x32_bf16 v[224:227], v[144:147], v[16:19], v[224:227]
    buffer_load_dwordx4 v[12:15], v6, s[32:35], s70 offen sc1
    v_mfma_f32_16x16x32_bf16 v[228:231], v[148:151], v[16:19], v[228:231]
    ds_read_b64_tr_b16 v[128:129], v0 offset:0
    v_mfma_f32_16x16x32_bf16 v[232:235], v[152:155], v[16:19], v[232:235]
    ds_read_b64_tr_b16 v[130:131], v0 offset:2048
    v_mfma_f32_16x16x32_bf16 v[236:239], v[156:159], v[16:19], v[236:239]
    s_add_u32 s70, s61, s68
    s_waitcnt vmcnt(8)
    v_mfma_f32_16x16x32_bf16 v[252:255], v[156:159], v[20:23], v[252:255]
    buffer_load_dwordx4 v[16:19], v5, s[32:35], s70 offen sc1
    v_mfma_f32_16x16x32_bf16 v[248:251], v[152:155], v[20:23], v[248:251]
    ds_read_b64_tr_b16 v[132:133], v3 offset:0
    v_mfma_f32_16x16x32_bf16 v[244:247], v[148:151], v[20:23], v[244:247]
    v_mfma_f32_16x16x32_bf16 v[240:243], v[144:147], v[20:23], v[240:243]
    s_waitcnt vmcnt(8)
    v_mfma_f32_16x16x32_bf16 v[192:195], v[160:163], v[24:27], v[192:195]
    buffer_load_dwordx4 v[20:23], v6, s[32:35], s70 offen sc1
    v_mfma_f32_16x16x32_bf16 v[196:199], v[164:167], v[24:27], v[196:199]
    ds_read_b64_tr_b16 v[134:135], v3 offset:2048
    v_mfma_f32_16x16x32_bf16 v[200:203], v[168:171], v[24:27], v[200:203]
    v_mfma_f32_16x16x32_bf16 v[204:207], v[172:175], v[24:27], v[204:207]
    buffer_load_dwordx4 v[88:91], v84, s[24:27], s50 offen
    buffer_load_dwordx4 v[92:95], v84, s[24:27], s50 offen offset:64
    s_add_u32 s70, s61, s69
    s_waitcnt vmcnt(10)
    v_mfma_f32_16x16x32_bf16 v[220:223], v[172:175], v[28:31], v[220:223]
    buffer_load_dwordx4 v[24:27], v5, s[32:35], s70 offen sc1
    v_mfma_f32_16x16x32_bf16 v[216:219], v[168:171], v[28:31], v[216:219]
    ds_read_b64_tr_b16 v[136:137], v4 offset:0
    v_mfma_f32_16x16x32_bf16 v[212:215], v[164:167], v[28:31], v[212:215]
    ds_read_b64_tr_b16 v[138:139], v4 offset:2048
    v_mfma_f32_16x16x32_bf16 v[208:211], v[160:163], v[28:31], v[208:211]
    s_waitcnt vmcnt(10)
    v_mfma_f32_16x16x32_bf16 v[224:227], v[160:163], v[32:35], v[224:227]
    buffer_load_dwordx4 v[28:31], v6, s[32:35], s70 offen sc1
    v_mfma_f32_16x16x32_bf16 v[228:231], v[164:167], v[32:35], v[228:231]
    ds_read_b64_tr_b16 v[140:141], v7 offset:0
    v_mfma_f32_16x16x32_bf16 v[232:235], v[168:171], v[32:35], v[232:235]
    v_mfma_f32_16x16x32_bf16 v[236:239], v[172:175], v[32:35], v[236:239]
RE9:
    s_waitcnt lgkmcnt(0)
    s_xor_b64 s[28:29], s[28:29], s[52:53]
    s_xor_b64 s[30:31], s[30:31], s[52:53]
    s_or_b64 s[28:29], s[28:29], s[30:31]
    s_cbranch_scc0 OK9
    s_sleep 1
    s_load_dwordx4 s[28:31], s[16:17], 64 glc
    s_sub_u32 s0, s0, 16
    s_cmp_lt_i32 s0, 0
    s_cbranch_scc0 RE9
    s_waitcnt lgkmcnt(0)
OK9:
    s_add_i32 s68, s68, 114688
    s_add_i32 s69, s69, 114688
    s_add_u32 s70, s64, s69
    s_waitcnt vmcnt(10)
    v_mfma_f32_16x16x32_bf16 v[252:255], v[172:175], v[36:39], v[252:255]
    buffer_load_dwordx4 v[32:35], v6, s[32:35], s70 offen sc1
    v_mfma_f32_16x16x32_bf16 v[248:251], v[168:171], v[36:39], v[248:251]
    ds_read_b64_tr_b16 v[142:143], v7 offset:2048
    v_mfma_f32_16x16x32_bf16 v[244:247], v[164:167], v[36:39], v[244:247]
    v_mfma_f32_16x16x32_bf16 v[240:243], v[160:163], v[36:39], v[240:243]
    s_add_u32 s70, s65, s69
    s_waitcnt vmcnt(10)
    v_mfma_f32_16x16x32_bf16 v[192:195], v[176:179], v[40:43], v[192:195]
    buffer_load_dwordx4 v[36:39], v6, s[32:35], s70 offen sc1
    v_mfma_f32_16x16x32_bf16 v[196:199], v[180:183], v[40:43], v[196:199]
    ds_read_b64_tr_b16 v[144:145], v80 offset:0
    v_mfma_f32_16x16x32_bf16 v[200:203], v[184:187], v[40:43], v[200:203]
    ds_read_b64_tr_b16 v[146:147], v80 offset:2048
    v_mfma_f32_16x16x32_bf16 v[204:207], v[188:191], v[40:43], v[204:207]
    s_add_u32 s70, s66, s69
    s_waitcnt vmcnt(10)
    v_mfma_f32_16x16x32_bf16 v[220:223], v[188:191], v[44:47], v[220:223]
    buffer_load_dwordx4 v[40:43], v6, s[32:35], s70 offen sc1
    v_mfma_f32_16x16x32_bf16 v[216:219], v[184:187], v[44:47], v[216:219]
    ds_read_b64_tr_b16 v[148:149], v81 offset:0
    v_mfma_f32_16x16x32_bf16 v[212:215], v[180:183], v[44:47], v[212:215]
    v_mfma_f32_16x16x32_bf16 v[208:211], v[176:179], v[44:47], v[208:211]
    s_add_u32 s70, s67, s69
    s_waitcnt vmcnt(10)
    v_mfma_f32_16x16x32_bf16 v[224:227], v[176:179], v[8:11], v[224:227]
    buffer_load_dwordx4 v[44:47], v6, s[32:35], s70 offen sc1
    v_mfma_f32_16x16x32_bf16 v[228:231], v[180:183], v[8:11], v[228:231]
    ds_read_b64_tr_b16 v[150:151], v81 offset:2048
    v_mfma_f32_16x16x32_bf16 v[232:235], v[184:187], v[8:11], v[232:235]
    v_mfma_f32_16x16x32_bf16 v[236:239], v[188:191], v[8:11], v[236:239]
    s_add_u32 s70, s64, s69
    s_waitcnt vmcnt(10)
    v_mfma_f32_16x16x32_bf16 v[252:255], v[188:191], v[12:15], v[252:255]
    buffer_load_dwordx4 v[8:11], v5, s[32:35], s70 offen sc1
    v_mfma_f32_16x16x32_bf16 v[248:251], v[184:187], v[12:15], v[248:251]
    ds_read_b64_tr_b16 v[152:153], v82 offset:0
    v_mfma_f32_16x16x32_bf16 v[244:247], v[180:183], v[12:15], v[244:247]
    ds_read_b64_tr_b16 v[154:155], v82 offset:2048
    v_mfma_f32_16x16x32_bf16 v[240:243], v[176:179], v[12:15], v[240:243]
    s_add_u32 s70, s65, s69
    s_waitcnt vmcnt(10)
    v_mfma_f32_16x16x32_bf16 v[192:195], v[48:51], v[16:19], v[192:195]
    buffer_load_dwordx4 v[12:15], v5, s[32:35], s70 offen sc1
    v_mfma_f32_16x16x32_bf16 v[196:199], v[52:55], v[16:19], v[196:199]
    ds_read_b64_tr_b16 v[156:157], v83 offset:0
    v_mfma_f32_16x16x32_bf16 v[200:203], v[56:59], v[16:19], v[200:203]
    v_mfma_f32_16x16x32_bf16 v[204:207], v[60:63], v[16:19], v[204:207]
    s_add_u32 s70, s66, s69
    s_waitcnt vmcnt(10)
    v_mfma_f32_16x16x32_bf16 v[220:223], v[60:63], v[20:23], v[220:223]
    buffer_load_dwordx4 v[16:19], v5, s[32:35], s70 offen sc1
    v_mfma_f32_16x16x32_bf16 v[216:219], v[56:59], v[20:23], v[216:219]
    ds_read_b64_tr_b16 v[158:159], v83 offset:2048
    v_mfma_f32_16x16x32_bf16 v[212:215], v[52:55], v[20:23], v[212:215]
    v_mfma_f32_16x16x32_bf16 v[208:211], v[48:51], v[20:23], v[208:211]
    s_add_u32 s70, s67, s69
    s_waitcnt vmcnt(8)
    v_mfma_f32_16x16x32_bf16 v[224:227], v[48:51], v[24:27], v[224:227]
    buffer_load_dwordx4 v[20:23], v5, s[32:35], s70 offen sc1
    v_mfma_f32_16x16x32_bf16 v[228:231], v[52:55], v[24:27], v[228:231]
    v_mfma_f32_16x16x32_bf16 v[232:235], v[56:59], v[24:27], v[232:235]
    v_mfma_f32_16x16x32_bf16 v[236:239], v[60:63], v[24:27], v[236:239]
    s_add_u32 s70, s64, s68
    s_waitcnt vmcnt(8)
    v_mfma_f32_16x16x32_bf16 v[252:255], v[60:63], v[28:31], v[252:255]
    buffer_load_dwordx4 v[24:27], v6, s[32:35], s70 offen sc1
    v_mfma_f32_16x16x32_bf16 v[248:251], v[56:59], v[28:31], v[248:251]
    v_mfma_f32_16x16x32_bf16 v[244:247], v[52:55], v[28:31], v[244:247]
    v_mfma_f32_16x16x32_bf16 v[240:243], v[48:51], v[28:31], v[240:243]
    s_add_u32 s70, s65, s68
    s_waitcnt vmcnt(8)
    v_mfma_f32_16x16x32_bf16 v[240:243], v[64:67], v[32:35], v[240:243]
    buffer_load_dwordx4 v[28:31], v6, s[32:35], s70 offen sc1
    v_mfma_f32_16x16x32_bf16 v[244:247], v[68:71], v[32:35], v[244:247]
    v_mfma_f32_16x16x32_bf16 v[248:251], v[72:75], v[32:35], v[248:251]
    s_mov_b32 s54, 0xbf317218
    s_mov_b32 s55, 0xffff0000
    v_mfma_f32_16x16x32_bf16 v[252:255], v[76:79], v[32:35], v[252:255]
    s_add_u32 s70, s66, s68
    s_waitcnt vmcnt(8)
    v_mfma_f32_16x16x32_bf16 v[252:255], v[124:127], v[36:39], v[252:255]
    buffer_load_dwordx4 v[32:35], v6, s[32:35], s70 offen sc1
    v_mfma_f32_16x16x32_bf16 v[248:251], v[120:123], v[36:39], v[248:251]
    v_mfma_f32_16x16x32_bf16 v[244:247], v[116:119], v[36:39], v[244:247]
    s_xor_b32 s1, s3, 1
    s_lshl_b32 s1, s1, 14
    v_add_u32_e64 v161, s1, v85
    v_mfma_f32_16x16x32_bf16 v[240:243], v[112:115], v[36:39], v[240:243]
    s_add_u32 s70, s67, s68
    s_waitcnt vmcnt(8)
    v_mfma_f32_16x16x32_bf16 v[240:243], v[128:131], v[40:43], v[240:243]
    buffer_load_dwordx4 v[36:39], v6, s[32:35], s70 offen sc1
    v_mfma_f32_16x16x32_bf16 v[244:247], v[132:135], v[40:43], v[244:247]
    v_mfma_f32_16x16x32_bf16 v[248:251], v[136:139], v[40:43], v[248:251]
    s_xor_b32 s1, s3, 2
    s_lshl_b32 s1, s1, 14
    v_add_u32 v162, s1, v85
    s_waitcnt lgkmcnt(8)
    v_mfma_f32_16x16x32_bf16 v[252:255], v[140:143], v[40:43], v[252:255]
    s_add_u32 s70, s64, s68
    s_waitcnt vmcnt(8) lgkmcnt(0)
    v_mfma_f32_16x16x32_bf16 v[252:255], v[156:159], v[44:47], v[252:255]
    buffer_load_dwordx4 v[40:43], v5, s[32:35], s70 offen sc1
    v_mfma_f32_16x16x32_bf16 v[248:251], v[152:155], v[44:47], v[248:251]
    v_mfma_f32_16x16x32_bf16 v[244:247], v[148:151], v[44:47], v[244:247]
    s_xor_b32 s1, s3, 3
    s_lshl_b32 s1, s1, 14
    v_add_u32_e64 v163, s1, v85
    v_mfma_f32_16x16x32_bf16 v[240:243], v[144:147], v[44:47], v[240:243]
    s_add_u32 s70, s65, s68
    s_waitcnt vmcnt(8)
    v_mfma_f32_16x16x32_bf16 v[224:227], v[64:67], v[8:11], v[224:227]
    buffer_load_dwordx4 v[44:47], v5, s[32:35], s70 offen sc1
    v_mfma_f32_16x16x32_bf16 v[228:231], v[68:71], v[8:11], v[228:231]
    v_mfma_f32_16x16x32_bf16 v[232:235], v[72:75], v[8:11], v[232:235]
    ds_write_b128 v86, v[252:255] offset:11264
    v_mfma_f32_16x16x32_bf16 v[236:239], v[76:79], v[8:11], v[236:239]
    ds_write_b128 v86, v[248:251] offset:10240
    s_add_u32 s70, s66, s68
    s_waitcnt vmcnt(8)
    v_mfma_f32_16x16x32_bf16 v[236:239], v[124:127], v[12:15], v[236:239]
    buffer_load_dwordx4 v[8:11], v5, s[32:35], s70 offen sc1
    v_mfma_f32_16x16x32_bf16 v[232:235], v[120:123], v[12:15], v[232:235]
    v_mfma_f32_16x16x32_bf16 v[228:231], v[116:119], v[12:15], v[228:231]
    ds_write_b128 v86, v[244:247] offset:9216
    v_mfma_f32_16x16x32_bf16 v[224:227], v[112:115], v[12:15], v[224:227]
    ds_write_b128 v86, v[240:243] offset:8192
    s_add_u32 s70, s67, s68
    s_waitcnt vmcnt(8)
    v_mfma_f32_16x16x32_bf16 v[224:227], v[128:131], v[16:19], v[224:227]
    buffer_load_dwordx4 v[12:15], v5, s[32:35], s70 offen sc1
    v_mfma_f32_16x16x32_bf16 v[228:231], v[132:135], v[16:19], v[228:231]
    v_permlane16_swap_b32 v88, v90
    v_permlane16_swap_b32 v89, v91
    v_mfma_f32_16x16x32_bf16 v[232:235], v[136:139], v[16:19], v[232:235]
    v_mfma_f32_16x16x32_bf16 v[236:239], v[140:143], v[16:19], v[236:239]
    v_permlane16_swap_b32 v92, v94
    v_permlane16_swap_b32 v93, v95
    s_waitcnt vmcnt(8)
    v_mfma_f32_16x16x32_bf16 v[236:239], v[156:159], v[20:23], v[236:239]
    v_mfma_f32_16x16x32_bf16 v[232:235], v[152:155], v[20:23], v[232:235]
    v_lshlrev_b32 v96, 16, v88
    v_and_b32_e64 v97, s55, v88
    v_mfma_f32_16x16x32_bf16 v[228:231], v[148:151], v[20:23], v[228:231]
    v_lshlrev_b32 v98, 16, v89
    v_and_b32 v99, s55, v89
    v_mfma_f32_16x16x32_bf16 v[224:227], v[144:147], v[20:23], v[224:227]
    v_lshlrev_b32_e64 v100, 16, v90
    v_and_b32 v101, s55, v90
    s_waitcnt vmcnt(7)
    v_mfma_f32_16x16x32_bf16 v[208:211], v[64:67], v[24:27], v[208:211]
    v_mfma_f32_16x16x32_bf16 v[212:215], v[68:71], v[24:27], v[212:215]
    v_mfma_f32_16x16x32_bf16 v[216:219], v[72:75], v[24:27], v[216:219]
    ds_write_b128 v86, v[236:239] offset:7168
    v_mfma_f32_16x16x32_bf16 v[220:223], v[76:79], v[24:27], v[220:223]
    ds_write_b128 v86, v[232:235] offset:6144
    s_waitcnt vmcnt(6)
    v_mfma_f32_16x16x32_bf16 v[220:223], v[124:127], v[28:31], v[220:223]
    v_mfma_f32_16x16x32_bf16 v[216:219], v[120:123], v[28:31], v[216:219]
    v_mfma_f32_16x16x32_bf16 v[212:215], v[116:119], v[28:31], v[212:215]
    ds_write_b128 v86, v[228:231] offset:5120
    v_mfma_f32_16x16x32_bf16 v[208:211], v[112:115], v[28:31], v[208:211]
    ds_write_b128 v86, v[224:227] offset:4096
    s_waitcnt vmcnt(5)
    v_mfma_f32_16x16x32_bf16 v[208:211], v[128:131], v[32:35], v[208:211]
    v_mfma_f32_16x16x32_bf16 v[212:215], v[132:135], v[32:35], v[212:215]
    v_lshlrev_b32 v102, 16, v91
    v_and_b32 v103, s55, v91
    v_mfma_f32_16x16x32_bf16 v[216:219], v[136:139], v[32:35], v[216:219]
    v_lshlrev_b32 v104, 16, v92
    v_and_b32 v105, s55, v92
    v_mfma_f32_16x16x32_bf16 v[220:223], v[140:143], v[32:35], v[220:223]
    v_lshlrev_b32_e64 v106, 16, v93
    v_and_b32 v107, s55, v93
    s_waitcnt vmcnt(4)
    v_mfma_f32_16x16x32_bf16 v[220:223], v[156:159], v[36:39], v[220:223]
    v_mfma_f32_16x16x32_bf16 v[216:219], v[152:155], v[36:39], v[216:219]
    v_lshlrev_b32 v108, 16, v94
    v_and_b32 v109, s55, v94
    v_mfma_f32_16x16x32_bf16 v[212:215], v[148:151], v[36:39], v[212:215]
    v_lshlrev_b32 v110, 16, v95
    v_and_b32 v111, s55, v95
    v_mfma_f32_16x16x32_bf16 v[208:211], v[144:147], v[36:39], v[208:211]
    s_waitcnt vmcnt(3)
    v_mfma_f32_16x16x32_bf16 v[192:195], v[64:67], v[40:43], v[192:195]
    v_mfma_f32_16x16x32_bf16 v[196:199], v[68:71], v[40:43], v[196:199]
    v_mfma_f32_16x16x32_bf16 v[200:203], v[72:75], v[40:43], v[200:203]
    ds_write_b128 v86, v[220:223] offset:3072
    v_mfma_f32_16x16x32_bf16 v[204:207], v[76:79], v[40:43], v[204:207]
    ds_write_b128 v86, v[216:219] offset:2048
    s_waitcnt vmcnt(2)
    v_mfma_f32_16x16x32_bf16 v[204:207], v[124:127], v[44:47], v[204:207]
    v_mfma_f32_16x16x32_bf16 v[200:203], v[120:123], v[44:47], v[200:203]
    v_mfma_f32_16x16x32_bf16 v[196:199], v[116:119], v[44:47], v[196:199]
    ds_write_b128 v86, v[212:215] offset:1024
    v_mfma_f32_16x16x32_bf16 v[192:195], v[112:115], v[44:47], v[192:195]
    ds_write_b128 v86, v[208:211] offset:0
    s_waitcnt vmcnt(1)
    v_mfma_f32_16x16x32_bf16 v[192:195], v[128:131], v[8:11], v[192:195]
    v_mfma_f32_16x16x32_bf16 v[196:199], v[132:135], v[8:11], v[196:199]
    v_mfma_f32_16x16x32_bf16 v[200:203], v[136:139], v[8:11], v[200:203]
    v_mfma_f32_16x16x32_bf16 v[204:207], v[140:143], v[8:11], v[204:207]
    s_waitcnt lgkmcnt(0)
    s_barrier
    ds_read_b128 v[208:211], v161 offset:0
    ds_read_b128 v[224:227], v162 offset:4096
    ds_read_b128 v[240:243], v163 offset:8192
    ds_read_b128 v[212:215], v161 offset:1024
    ds_read_b128 v[228:231], v162 offset:5120
    ds_read_b128 v[244:247], v163 offset:9216
    ds_read_b128 v[216:219], v161 offset:2048
    ds_read_b128 v[232:235], v162 offset:6144
    ds_read_b128 v[248:251], v163 offset:10240
    ds_read_b128 v[220:223], v161 offset:3072
    ds_read_b128 v[236:239], v162 offset:7168
    ds_read_b128 v[252:255], v163 offset:11264
    s_waitcnt vmcnt(0)
    v_mfma_f32_16x16x32_bf16 v[204:207], v[156:159], v[12:15], v[204:207]
    v_mfma_f32_16x16x32_bf16 v[200:203], v[152:155], v[12:15], v[200:203]
    v_mfma_f32_16x16x32_bf16 v[196:199], v[148:151], v[12:15], v[196:199]
    v_mfma_f32_16x16x32_bf16 v[192:195], v[144:147], v[12:15], v[192:195]
    s_waitcnt lgkmcnt(11)
    v_fmac_f32 v96, s54, v208
    v_fmac_f32 v97, s54, v209
    v_fmac_f32 v98, s54, v210
    v_fmac_f32 v99, s54, v211
    s_waitcnt lgkmcnt(10)
    v_fmac_f32 v96, s54, v224
    v_fmac_f32 v97, s54, v225
    v_fmac_f32 v98, s54, v226
    v_fmac_f32 v99, s54, v227
    s_waitcnt lgkmcnt(9)
    v_fmac_f32 v96, s54, v240
    v_fmac_f32 v97, s54, v241
    v_fmac_f32 v98, s54, v242
    v_fmac_f32 v99, s54, v243
    v_fmac_f32 v96, s54, v192
    v_fmac_f32 v97, s54, v193
    v_fmac_f32 v98, s54, v194
    v_fmac_f32 v99, s54, v195
    s_waitcnt lgkmcnt(8)
    v_fmac_f32 v100, s54, v212
    v_fmac_f32 v101, s54, v213
    v_fmac_f32 v102, s54, v214
    v_fmac_f32 v103, s54, v215
    s_waitcnt lgkmcnt(7)
    v_fmac_f32 v100, s54, v228
    v_fmac_f32 v101, s54, v229
    v_fmac_f32 v102, s54, v230
    v_fmac_f32 v103, s54, v231
    s_waitcnt lgkmcnt(6)
    v_fmac_f32 v100, s54, v244
    v_fmac_f32 v101, s54, v245
    v_fmac_f32 v102, s54, v246
    v_fmac_f32 v103, s54, v247
    v_fmac_f32 v100, s54, v196
    v_fmac_f32 v101, s54, v197
    v_fmac_f32 v102, s54, v198
    v_fmac_f32 v103, s54, v199
    v_cvt_pk_bf16_f32 v88, v96, v97
    v_cvt_pk_bf16_f32 v89, v98, v99
    v_cvt_pk_bf16_f32 v90, v100, v101
    v_cvt_pk_bf16_f32 v91, v102, v103
    s_nop 0
    v_permlane16_swap_b32 v88, v90
    v_permlane16_swap_b32 v89, v91
    buffer_store_dwordx4 v[88:91], v84, s[44:47], s50 offen offset:0
    s_waitcnt lgkmcnt(5)
    v_fmac_f32 v104, s54, v216
    v_fmac_f32 v105, s54, v217
    v_fmac_f32 v106, s54, v218
    v_fmac_f32 v107, s54, v219
    s_waitcnt lgkmcnt(4)
    v_fmac_f32 v104, s54, v232
    v_fmac_f32 v105, s54, v233
    v_fmac_f32 v106, s54, v234
    v_fmac_f32 v107, s54, v235
    s_waitcnt lgkmcnt(3)
    v_fmac_f32 v104, s54, v248
    v_fmac_f32 v105, s54, v249
    v_fmac_f32 v106, s54, v250
    v_fmac_f32 v107, s54, v251
    v_fmac_f32 v104, s54, v200
    v_fmac_f32 v105, s54, v201
    v_fmac_f32 v106, s54, v202
    v_fmac_f32 v107, s54, v203
    s_waitcnt lgkmcnt(2)
    v_fmac_f32 v108, s54, v220
    v_fmac_f32 v109, s54, v221
    v_fmac_f32 v110, s54, v222
    v_fmac_f32 v111, s54, v223
    s_waitcnt lgkmcnt(1)
    v_fmac_f32 v108, s54, v236
    v_fmac_f32 v109, s54, v237
    v_fmac_f32 v110, s54, v238
    v_fmac_f32 v111, s54, v239
    s_waitcnt lgkmcnt(0)
    v_fmac_f32 v108, s54, v252
    v_fmac_f32 v109, s54, v253
    v_fmac_f32 v110, s54, v254
    v_fmac_f32 v111, s54, v255
    v_fmac_f32 v108, s54, v204
    v_fmac_f32 v109, s54, v205
    v_fmac_f32 v110, s54, v206
    v_fmac_f32_e64 v111, s54, v207
    v_cvt_pk_bf16_f32 v92, v104, v105
    v_cvt_pk_bf16_f32 v93, v106, v107
    v_cvt_pk_bf16_f32 v94, v108, v109
    v_cvt_pk_bf16_f32 v95, v110, v111
    s_nop 0
    v_permlane16_swap_b32 v92, v94
    v_permlane16_swap_b32 v93, v95
    buffer_store_dwordx4 v[92:95], v84, s[44:47], s50 offen offset:64
    s_endpgm
G2_A:
    s_barrier
    s_load_dwordx2 s[52:53], s[18:19], 0
    s_add_u32 m0, s14, 0
    s_add_u32 s55, s10, s4
    buffer_load_dwordx4 v192, s[28:31], s55 offen offset:0 lds
    buffer_load_dwordx4 v193, s[28:31], s55 offen offset:1024 lds
    buffer_load_dwordx4 v194, s[28:31], s55 offen offset:2048 lds
    buffer_load_dwordx4 v195, s[28:31], s55 offen offset:3072 lds
    s_add_u32 m0, s14, 16384
    s_add_u32 s55, s10, s5
    buffer_load_dwordx4 v192, s[28:31], s55 offen offset:0 lds
    buffer_load_dwordx4 v193, s[28:31], s55 offen offset:1024 lds
    buffer_load_dwordx4 v194, s[28:31], s55 offen offset:2048 lds
    buffer_load_dwordx4 v195, s[28:31], s55 offen offset:3072 lds
    s_add_u32 m0, s14, 32768
    s_add_u32 s55, s10, s6
    s_waitcnt vmcnt(8)
    buffer_load_dwordx4 v192, s[28:31], s55 offen offset:0 lds
    s_waitcnt vmcnt(8)
    buffer_load_dwordx4 v193, s[28:31], s55 offen offset:1024 lds
    s_waitcnt vmcnt(8)
    buffer_load_dwordx4 v194, s[28:31], s55 offen offset:2048 lds
    s_waitcnt vmcnt(8)
    buffer_load_dwordx4 v195, s[28:31], s55 offen offset:3072 lds
    s_add_u32 m0, s14, 49152
    s_add_u32 s55, s10, s7
    s_waitcnt vmcnt(8)
    buffer_load_dwordx4 v192, s[28:31], s55 offen offset:0 lds
    s_waitcnt vmcnt(8)
    buffer_load_dwordx4 v193, s[28:31], s55 offen offset:1024 lds
    s_waitcnt vmcnt(8)
    buffer_load_dwordx4 v194, s[28:31], s55 offen offset:2048 lds
    s_waitcnt vmcnt(8)
    buffer_load_dwordx4 v195, s[28:31], s55 offen offset:3072 lds
    s_add_u32 m0, s14, 65536
    s_add_u32 s55, s11, s4
    s_waitcnt vmcnt(8)
    buffer_load_dwordx4 v192, s[28:31], s55 offen offset:0 lds
    s_waitcnt vmcnt(8)
    buffer_load_dwordx4 v193, s[28:31], s55 offen offset:1024 lds
    s_waitcnt vmcnt(8)
    buffer_load_dwordx4 v194, s[28:31], s55 offen offset:2048 lds
    s_waitcnt vmcnt(8)
    buffer_load_dwordx4 v195, s[28:31], s55 offen offset:3072 lds
RE10:
    s_waitcnt lgkmcnt(0)
    s_cmp_lg_u32 s53, 0
    s_cbranch_scc1 OK10
    s_sleep 4
    s_load_dwordx2 s[52:53], s[18:19], 0 glc
    s_sub_u32 s0, s0, 16
    s_cmp_lt_i32 s0, 0
    s_cbranch_scc0 RE10
    s_waitcnt lgkmcnt(0)
OK10:
    s_mov_b32 s53, s52
    s_barrier
    s_add_u32 m0, s15, 0
    s_lshl4_add_u32 s55, s56, 0
    s_waitcnt vmcnt(8)
    buffer_load_dwordx4 v1, s[36:39], s55 offen offset:0 lds
    s_waitcnt vmcnt(8)
    buffer_load_dwordx4 v2, s[36:39], s55 offen offset:1024 lds
    s_add_u32 m0, s15, 2048
    s_lshl4_add_u32 s55, s56, 16384
    s_waitcnt vmcnt(8)
    buffer_load_dwordx4 v1, s[36:39], s55 offen offset:0 lds
    s_waitcnt vmcnt(8)
    buffer_load_dwordx4 v2, s[36:39], s55 offen offset:1024 lds
    s_add_u32 m0, s15, 4096
    s_lshl4_add_u32 s55, s57, 0
    s_waitcnt vmcnt(8)
    buffer_load_dwordx4 v1, s[36:39], s55 offen offset:0 lds
    s_waitcnt vmcnt(8)
    buffer_load_dwordx4 v2, s[36:39], s55 offen offset:1024 lds
    s_barrier
    s_add_u32 m0, s15, 6144
    s_lshl4_add_u32 s55, s57, 16384
    s_waitcnt vmcnt(8)
    buffer_load_dwordx4 v1, s[36:39], s55 offen offset:0 lds
    s_waitcnt vmcnt(8)
    buffer_load_dwordx4 v2, s[36:39], s55 offen offset:1024 lds
    s_add_u32 m0, s15, 8192
    s_lshl4_add_u32 s55, s58, 65536
    s_waitcnt vmcnt(8)
    buffer_load_dwordx4 v1, s[36:39], s55 offen offset:0 lds
    s_waitcnt vmcnt(8)
    buffer_load_dwordx4 v2, s[36:39], s55 offen offset:1024 lds
    s_add_u32 m0, s15, 10240
    s_lshl4_add_u32 s55, s58, 81920
    s_waitcnt vmcnt(8)
    buffer_load_dwordx4 v1, s[36:39], s55 offen offset:0 lds
    s_waitcnt vmcnt(8)
    buffer_load_dwordx4 v2, s[36:39], s55 offen offset:1024 lds
    s_barrier
    s_add_u32 m0, s14, 0
    s_add_u32 s55, s11, s5
    s_waitcnt vmcnt(8)
    ds_read_b64_tr_b16 v[48:49], v0 offset:0
    ds_read_b64_tr_b16 v[50:51], v0 offset:2048
    ds_read_b64_tr_b16 v[52:53], v3 offset:0
    ds_read_b64_tr_b16 v[54:55], v3 offset:2048
    ds_read_b64_tr_b16 v[56:57], v4 offset:0
    ds_read_b64_tr_b16 v[58:59], v4 offset:2048
    ds_read_b64_tr_b16 v[60:61], v7 offset:0
    ds_read_b64_tr_b16 v[62:63], v7 offset:2048
    buffer_load_dwordx4 v192, s[28:31], s55 offen offset:0 lds
    s_waitcnt vmcnt(8)
    buffer_load_dwordx4 v193, s[28:31], s55 offen offset:1024 lds
    s_waitcnt vmcnt(8)
    buffer_load_dwordx4 v194, s[28:31], s55 offen offset:2048 lds
    s_waitcnt vmcnt(8)
    buffer_load_dwordx4 v195, s[28:31], s55 offen offset:3072 lds
    s_add_u32 m0, s15, 12288
    s_lshl4_add_u32 s55, s59, 65536
    s_waitcnt vmcnt(8)
    ds_read_b64_tr_b16 v[64:65], v0 offset:4096
    ds_read_b64_tr_b16 v[66:67], v0 offset:6144
    ds_read_b64_tr_b16 v[68:69], v3 offset:4096
    ds_read_b64_tr_b16 v[70:71], v3 offset:6144
    ds_read_b64_tr_b16 v[72:73], v4 offset:4096
    ds_read_b64_tr_b16 v[74:75], v4 offset:6144
    ds_read_b64_tr_b16 v[76:77], v7 offset:4096
    ds_read_b64_tr_b16 v[78:79], v7 offset:6144
    buffer_load_dwordx4 v1, s[36:39], s55 offen offset:0 lds
    s_waitcnt vmcnt(8)
    buffer_load_dwordx4 v2, s[36:39], s55 offen offset:1024 lds
    s_barrier
    s_add_u32 m0, s14, 16384
    s_add_u32 s55, s11, s6
    s_waitcnt vmcnt(8)
    buffer_load_dwordx4 v192, s[28:31], s55 offen offset:0 lds
    s_waitcnt vmcnt(8)
    buffer_load_dwordx4 v193, s[28:31], s55 offen offset:1024 lds
    s_waitcnt vmcnt(8)
    ds_read_b64_tr_b16 v[80:81], v0 offset:8192
    ds_read_b64_tr_b16 v[82:83], v0 offset:10240
    ds_read_b64_tr_b16 v[84:85], v3 offset:8192
    ds_read_b64_tr_b16 v[86:87], v3 offset:10240
    ds_read_b64_tr_b16 v[88:89], v4 offset:8192
    ds_read_b64_tr_b16 v[90:91], v4 offset:10240
    ds_read_b64_tr_b16 v[92:93], v7 offset:8192
    ds_read_b64_tr_b16 v[94:95], v7 offset:10240
    buffer_load_dwordx4 v194, s[28:31], s55 offen offset:2048 lds
    s_waitcnt vmcnt(8)
    buffer_load_dwordx4 v195, s[28:31], s55 offen offset:3072 lds
    s_add_u32 m0, s15, 14336
    s_lshl4_add_u32 s55, s59, 81920
    s_waitcnt vmcnt(8)
    buffer_load_dwordx4 v1, s[36:39], s55 offen offset:0 lds
    s_waitcnt vmcnt(8)
    buffer_load_dwordx4 v2, s[36:39], s55 offen offset:1024 lds
    s_barrier
    s_add_u32 m0, s14, 32768
    s_add_u32 s55, s11, s7
    s_waitcnt vmcnt(8)
    buffer_load_dwordx4 v192, s[28:31], s55 offen offset:0 lds
    s_waitcnt vmcnt(8)
    buffer_load_dwordx4 v193, s[28:31], s55 offen offset:1024 lds
    s_waitcnt vmcnt(8)
    buffer_load_dwordx4 v194, s[28:31], s55 offen offset:2048 lds
    s_waitcnt vmcnt(8)
    buffer_load_dwordx4 v195, s[28:31], s55 offen offset:3072 lds
    s_waitcnt lgkmcnt(14)
    s_add_u32 m0, s15, 0
    s_lshl4_add_u32 s55, s56, 131072
    s_waitcnt vmcnt(8)
    buffer_load_dwordx4 v1, s[36:39], s55 offen offset:0 lds
    s_waitcnt vmcnt(8)
    buffer_load_dwordx4 v2, s[36:39], s55 offen offset:1024 lds
    s_add_u32 m0, s15, 2048
    s_lshl4_add_u32 s55, s56, 147456
    s_waitcnt vmcnt(8)
    buffer_load_dwordx4 v1, s[36:39], s55 offen offset:0 lds
    s_waitcnt vmcnt(8)
    buffer_load_dwordx4 v2, s[36:39], s55 offen offset:1024 lds
    s_barrier
    s_add_u32 m0, s14, 49152
    s_add_u32 s55, s12, s4
    s_waitcnt vmcnt(8)
    ds_read_b64_tr_b16 v[96:97], v0 offset:12288
    ds_read_b64_tr_b16 v[98:99], v0 offset:14336
    ds_read_b64_tr_b16 v[100:101], v3 offset:12288
    ds_read_b64_tr_b16 v[102:103], v3 offset:14336
    ds_read_b64_tr_b16 v[104:105], v4 offset:12288
    ds_read_b64_tr_b16 v[106:107], v4 offset:14336
    ds_read_b64_tr_b16 v[108:109], v7 offset:12288
    ds_read_b64_tr_b16 v[110:111], v7 offset:14336
    buffer_load_dwordx4 v192, s[28:31], s55 offen offset:0 lds
    s_waitcnt vmcnt(8)
    buffer_load_dwordx4 v193, s[28:31], s55 offen offset:1024 lds
    s_waitcnt vmcnt(8)
    buffer_load_dwordx4 v194, s[28:31], s55 offen offset:2048 lds
    s_waitcnt vmcnt(8)
    buffer_load_dwordx4 v195, s[28:31], s55 offen offset:3072 lds
    s_waitcnt lgkmcnt(14)
    s_add_u32 m0, s15, 4096
    s_lshl4_add_u32 s55, s57, 131072
    s_waitcnt vmcnt(8)
    buffer_load_dwordx4 v1, s[36:39], s55 offen offset:0 lds
    s_waitcnt vmcnt(8)
    buffer_load_dwordx4 v2, s[36:39], s55 offen offset:1024 lds
    s_add_u32 m0, s15, 6144
    s_lshl4_add_u32 s55, s57, 147456
    s_waitcnt vmcnt(8)
    buffer_load_dwordx4 v1, s[36:39], s55 offen offset:0 lds
    s_waitcnt vmcnt(8)
    buffer_load_dwordx4 v2, s[36:39], s55 offen offset:1024 lds
    s_barrier
    s_add_u32 m0, s14, 65536
    s_add_u32 s55, s12, s5
    s_waitcnt vmcnt(8)
    ds_read_b64_tr_b16 v[112:113], v0 offset:0
    ds_read_b64_tr_b16 v[114:115], v0 offset:2048
    ds_read_b64_tr_b16 v[116:117], v3 offset:0
    ds_read_b64_tr_b16 v[118:119], v3 offset:2048
    ds_read_b64_tr_b16 v[120:121], v4 offset:0
    ds_read_b64_tr_b16 v[122:123], v4 offset:2048
    ds_read_b64_tr_b16 v[124:125], v7 offset:0
    ds_read_b64_tr_b16 v[126:127], v7 offset:2048
    buffer_load_dwordx4 v192, s[28:31], s55 offen offset:0 lds
    s_waitcnt vmcnt(8)
    buffer_load_dwordx4 v193, s[28:31], s55 offen offset:1024 lds
    s_waitcnt vmcnt(8)
    buffer_load_dwordx4 v194, s[28:31], s55 offen offset:2048 lds
    s_waitcnt vmcnt(8)
    buffer_load_dwordx4 v195, s[28:31], s55 offen offset:3072 lds
    s_waitcnt lgkmcnt(14)
    s_add_u32 m0, s15, 8192
    s_lshl4_add_u32 s55, s58, 131072
    s_waitcnt vmcnt(8)
    buffer_load_dwordx4 v1, s[36:39], s55 offen offset:0 lds
    s_waitcnt vmcnt(8)
    buffer_load_dwordx4 v2, s[36:39], s55 offen offset:1024 lds
    s_add_u32 m0, s15, 10240
    s_lshl4_add_u32 s55, s58, 147456
    s_waitcnt vmcnt(8)
    buffer_load_dwordx4 v1, s[36:39], s55 offen offset:0 lds
    s_waitcnt vmcnt(8)
    buffer_load_dwordx4 v2, s[36:39], s55 offen offset:1024 lds
    s_barrier
    s_add_u32 m0, s14, 0
    s_add_u32 s55, s12, s6
    s_waitcnt vmcnt(8)
    ds_read_b64_tr_b16 v[128:129], v0 offset:4096
    ds_read_b64_tr_b16 v[130:131], v0 offset:6144
    ds_read_b64_tr_b16 v[132:133], v3 offset:4096
    ds_read_b64_tr_b16 v[134:135], v3 offset:6144
    ds_read_b64_tr_b16 v[136:137], v4 offset:4096
    ds_read_b64_tr_b16 v[138:139], v4 offset:6144
    ds_read_b64_tr_b16 v[140:141], v7 offset:4096
    ds_read_b64_tr_b16 v[142:143], v7 offset:6144
    buffer_load_dwordx4 v192, s[28:31], s55 offen offset:0 lds
    s_waitcnt vmcnt(8)
    buffer_load_dwordx4 v193, s[28:31], s55 offen offset:1024 lds
    s_waitcnt vmcnt(8)
    buffer_load_dwordx4 v194, s[28:31], s55 offen offset:2048 lds
    s_waitcnt vmcnt(8)
    buffer_load_dwordx4 v195, s[28:31], s55 offen offset:3072 lds
    s_waitcnt lgkmcnt(14)
    s_add_u32 m0, s15, 12288
    s_lshl4_add_u32 s55, s59, 131072
    s_waitcnt vmcnt(8)
    buffer_load_dwordx4 v1, s[36:39], s55 offen offset:0 lds
    s_waitcnt vmcnt(8)
    buffer_load_dwordx4 v2, s[36:39], s55 offen offset:1024 lds
    s_add_u32 m0, s15, 14336
    s_lshl4_add_u32 s55, s59, 147456
    s_waitcnt vmcnt(8)
    buffer_load_dwordx4 v1, s[36:39], s55 offen offset:0 lds
    s_waitcnt vmcnt(8)
    buffer_load_dwordx4 v2, s[36:39], s55 offen offset:1024 lds
    s_barrier
    s_add_u32 m0, s14, 16384
    s_add_u32 s55, s12, s7
    s_waitcnt vmcnt(8)
    ds_read_b64_tr_b16 v[144:145], v0 offset:8192
    ds_read_b64_tr_b16 v[146:147], v0 offset:10240
    ds_read_b64_tr_b16 v[148:149], v3 offset:8192
    ds_read_b64_tr_b16 v[150:151], v3 offset:10240
    ds_read_b64_tr_b16 v[152:153], v4 offset:8192
    ds_read_b64_tr_b16 v[154:155], v4 offset:10240
    ds_read_b64_tr_b16 v[156:157], v7 offset:8192
    ds_read_b64_tr_b16 v[158:159], v7 offset:10240
    buffer_load_dwordx4 v192, s[28:31], s55 offen offset:0 lds
    s_waitcnt vmcnt(8)
    buffer_load_dwordx4 v193, s[28:31], s55 offen offset:1024 lds
    s_waitcnt vmcnt(8)
    buffer_load_dwordx4 v194, s[28:31], s55 offen offset:2048 lds
    s_waitcnt vmcnt(8)
    buffer_load_dwordx4 v195, s[28:31], s55 offen offset:3072 lds
    s_waitcnt lgkmcnt(14)
    s_add_u32 m0, s15, 0
    s_lshl4_add_u32 s55, s60, 0
    s_waitcnt vmcnt(8)
    buffer_load_dwordx4 v1, s[36:39], s55 offen offset:0 lds
    s_waitcnt vmcnt(8)
    buffer_load_dwordx4 v2, s[36:39], s55 offen offset:1024 lds
    s_add_u32 m0, s15, 2048
    s_lshl4_add_u32 s55, s60, 16384
    s_waitcnt vmcnt(8)
    buffer_load_dwordx4 v1, s[36:39], s55 offen offset:0 lds
    s_waitcnt vmcnt(8)
    buffer_load_dwordx4 v2, s[36:39], s55 offen offset:1024 lds
    s_waitcnt lgkmcnt(8)
    s_add_u32 m0, s15, 4096
    s_lshl4_add_u32 s55, s58, 0
    s_waitcnt vmcnt(8)
    ds_read_b64_tr_b16 v[160:161], v0 offset:12288
    ds_read_b64_tr_b16 v[162:163], v0 offset:14336
    ds_read_b64_tr_b16 v[164:165], v3 offset:12288
    ds_read_b64_tr_b16 v[166:167], v3 offset:14336
    ds_read_b64_tr_b16 v[168:169], v4 offset:12288
    ds_read_b64_tr_b16 v[170:171], v4 offset:14336
    ds_read_b64_tr_b16 v[172:173], v7 offset:12288
    ds_read_b64_tr_b16 v[174:175], v7 offset:14336
    buffer_load_dwordx4 v1, s[36:39], s55 offen offset:0 lds
    s_waitcnt vmcnt(8)
    buffer_load_dwordx4 v2, s[36:39], s55 offen offset:1024 lds
    s_barrier
    s_add_u32 m0, s15, 6144
    s_lshl4_add_u32 s55, s58, 16384
    s_waitcnt vmcnt(8)
    buffer_load_dwordx4 v1, s[36:39], s55 offen offset:0 lds
    s_waitcnt vmcnt(8)
    buffer_load_dwordx4 v2, s[36:39], s55 offen offset:1024 lds
    s_waitcnt lgkmcnt(8)
    s_add_u32 m0, s15, 8192
    s_lshl4_add_u32 s55, s59, 0
    s_waitcnt vmcnt(8)
    buffer_load_dwordx4 v1, s[36:39], s55 offen offset:0 lds
    s_waitcnt vmcnt(8)
    buffer_load_dwordx4 v2, s[36:39], s55 offen offset:1024 lds
    s_add_u32 m0, s15, 10240
    s_lshl4_add_u32 s55, s59, 16384
    s_waitcnt vmcnt(8)
    buffer_load_dwordx4 v1, s[36:39], s55 offen offset:0 lds
    s_waitcnt vmcnt(8)
    buffer_load_dwordx4 v2, s[36:39], s55 offen offset:1024 lds
    s_waitcnt lgkmcnt(0)
    s_add_u32 m0, s15, 12288
    s_lshl4_add_u32 s55, s56, 65536
    s_waitcnt vmcnt(8)
    ds_read_b64_tr_b16 v[176:177], v0 offset:0
    ds_read_b64_tr_b16 v[178:179], v0 offset:2048
    ds_read_b64_tr_b16 v[180:181], v3 offset:0
    ds_read_b64_tr_b16 v[182:183], v3 offset:2048
    ds_read_b64_tr_b16 v[184:185], v4 offset:0
    ds_read_b64_tr_b16 v[186:187], v4 offset:2048
    ds_read_b64_tr_b16 v[188:189], v7 offset:0
    ds_read_b64_tr_b16 v[190:191], v7 offset:2048
    buffer_load_dwordx4 v1, s[36:39], s55 offen offset:0 lds
    s_waitcnt vmcnt(8)
    buffer_load_dwordx4 v2, s[36:39], s55 offen offset:1024 lds
    s_barrier
    s_add_u32 m0, s15, 14336
    s_lshl4_add_u32 s55, s56, 81920
    s_waitcnt vmcnt(8)
    buffer_load_dwordx4 v1, s[36:39], s55 offen offset:0 lds
    s_waitcnt vmcnt(8)
    buffer_load_dwordx4 v2, s[36:39], s55 offen offset:1024 lds
    s_load_dwordx4 s[28:31], s[16:17], 0 glc
    s_waitcnt lgkmcnt(0)
    s_add_u32 m0, s15, 0
    s_lshl4_add_u32 s55, s57, 65536
    s_waitcnt vmcnt(8)
    buffer_load_dwordx4 v1, s[36:39], s55 offen offset:0 lds
    s_waitcnt vmcnt(8)
    buffer_load_dwordx4 v2, s[36:39], s55 offen offset:1024 lds
    s_add_u32 m0, s15, 2048
    s_lshl4_add_u32 s55, s57, 81920
    s_waitcnt vmcnt(8)
    buffer_load_dwordx4 v1, s[36:39], s55 offen offset:0 lds
    s_waitcnt vmcnt(8)
    buffer_load_dwordx4 v2, s[36:39], s55 offen offset:1024 lds
    s_add_u32 m0, s14, 81920
    s_lshl4_add_u32 s55, s67, 0
    s_waitcnt vmcnt(8)
    buffer_load_dwordx4 v1, s[40:43], s55 offen offset:0 lds
    s_waitcnt vmcnt(8)
    buffer_load_dwordx4 v2, s[40:43], s55 offen offset:1024 lds
    s_add_u32 m0, s14, 83968
    s_lshl4_add_u32 s55, s67, 16384
    s_waitcnt vmcnt(8)
    buffer_load_dwordx4 v1, s[40:43], s55 offen offset:0 lds
    s_waitcnt vmcnt(8)
    buffer_load_dwordx4 v2, s[40:43], s55 offen offset:1024 lds
RE11:
    s_waitcnt lgkmcnt(0)
    s_xor_b64 s[28:29], s[28:29], s[52:53]
    s_xor_b64 s[30:31], s[30:31], s[52:53]
    s_or_b64 s[28:29], s[28:29], s[30:31]
    s_cbranch_scc0 OK11
    s_sleep 1
    s_load_dwordx4 s[28:31], s[16:17], 0 glc
    s_sub_u32 s0, s0, 16
    s_cmp_lt_i32 s0, 0
    s_cbranch_scc0 RE11
    s_waitcnt lgkmcnt(0)
OK11:
    s_add_u32 s70, s56, s68
    buffer_load_dwordx4 v[8:11], v5, s[32:35], s70 offen sc1
    buffer_load_dwordx4 v[12:15], v6, s[32:35], s70 offen sc1
    s_add_u32 s70, s56, s69
    buffer_load_dwordx4 v[16:19], v5, s[32:35], s70 offen sc1
    buffer_load_dwordx4 v[20:23], v6, s[32:35], s70 offen sc1
    s_add_u32 s70, s57, s68
    buffer_load_dwordx4 v[24:27], v5, s[32:35], s70 offen sc1
    buffer_load_dwordx4 v[28:31], v6, s[32:35], s70 offen sc1
    s_add_u32 s70, s57, s69
    buffer_load_dwordx4 v[32:35], v5, s[32:35], s70 offen sc1
    buffer_load_dwordx4 v[36:39], v6, s[32:35], s70 offen sc1
    s_add_u32 s70, s58, s68
    buffer_load_dwordx4 v[40:43], v5, s[32:35], s70 offen sc1
    buffer_load_dwordx4 v[44:47], v6, s[32:35], s70 offen sc1
    s_load_dwordx4 s[28:31], s[16:17], 16 glc
    s_waitcnt vmcnt(9)
    v_mfma_f32_16x16x32_bf16 v[192:195], v[48:51], v[8:11], 0
    v_mfma_f32_16x16x32_bf16 v[196:199], v[52:55], v[8:11], 0
    v_mfma_f32_16x16x32_bf16 v[200:203], v[56:59], v[8:11], 0
    v_mfma_f32_16x16x32_bf16 v[204:207], v[60:63], v[8:11], 0
    s_add_u32 s70, s58, s69
    s_waitcnt vmcnt(8)
    v_mfma_f32_16x16x32_bf16 v[220:223], v[60:63], v[12:15], 0
    buffer_load_dwordx4 v[8:11], v5, s[32:35], s70 offen sc1
    v_mfma_f32_16x16x32_bf16 v[216:219], v[56:59], v[12:15], 0
    v_mfma_f32_16x16x32_bf16 v[212:215], v[52:55], v[12:15], 0
    v_mfma_f32_16x16x32_bf16 v[208:211], v[48:51], v[12:15], 0
    s_waitcnt vmcnt(8)
    v_mfma_f32_16x16x32_bf16 v[224:227], v[48:51], v[16:19], 0
    buffer_load_dwordx4 v[12:15], v6, s[32:35], s70 offen sc1
    v_mfma_f32_16x16x32_bf16 v[228:231], v[52:55], v[16:19], 0
    v_mfma_f32_16x16x32_bf16 v[232:235], v[56:59], v[16:19], 0
    v_mfma_f32_16x16x32_bf16 v[236:239], v[60:63], v[16:19], 0
    s_add_u32 s70, s59, s68
    s_waitcnt vmcnt(8)
    v_mfma_f32_16x16x32_bf16 v[252:255], v[60:63], v[20:23], 0
    buffer_load_dwordx4 v[16:19], v5, s[32:35], s70 offen sc1
    v_mfma_f32_16x16x32_bf16 v[248:251], v[56:59], v[20:23], 0
    v_mfma_f32_16x16x32_bf16 v[244:247], v[52:55], v[20:23], 0
    v_mfma_f32_16x16x32_bf16 v[240:243], v[48:51], v[20:23], 0
    s_waitcnt vmcnt(8)
    v_mfma_f32_16x16x32_bf16 v[192:195], v[64:67], v[24:27], v[192:195]
    buffer_load_dwordx4 v[20:23], v6, s[32:35], s70 offen sc1
    v_mfma_f32_16x16x32_bf16 v[196:199], v[68:71], v[24:27], v[196:199]
    ds_read_b64_tr_b16 v[48:49], v0 offset:4096
    v_mfma_f32_16x16x32_bf16 v[200:203], v[72:75], v[24:27], v[200:203]
    ds_read_b64_tr_b16 v[50:51], v0 offset:6144
    v_mfma_f32_16x16x32_bf16 v[204:207], v[76:79], v[24:27], v[204:207]
    ds_read_b64_tr_b16 v[52:53], v3 offset:4096
    s_add_u32 s70, s59, s69
    s_waitcnt vmcnt(8)
    v_mfma_f32_16x16x32_bf16 v[220:223], v[76:79], v[28:31], v[220:223]
    buffer_load_dwordx4 v[24:27], v5, s[32:35], s70 offen sc1
    v_mfma_f32_16x16x32_bf16 v[216:219], v[72:75], v[28:31], v[216:219]
    ds_read_b64_tr_b16 v[54:55], v3 offset:6144
    v_mfma_f32_16x16x32_bf16 v[212:215], v[68:71], v[28:31], v[212:215]
    ds_read_b64_tr_b16 v[56:57], v4 offset:4096
    v_mfma_f32_16x16x32_bf16 v[208:211], v[64:67], v[28:31], v[208:211]
    ds_read_b64_tr_b16 v[58:59], v4 offset:6144
    s_waitcnt vmcnt(8)
    v_mfma_f32_16x16x32_bf16 v[224:227], v[64:67], v[32:35], v[224:227]
    buffer_load_dwordx4 v[28:31], v6, s[32:35], s70 offen sc1
    v_mfma_f32_16x16x32_bf16 v[228:231], v[68:71], v[32:35], v[228:231]
    ds_read_b64_tr_b16 v[60:61], v7 offset:4096
    v_mfma_f32_16x16x32_bf16 v[232:235], v[72:75], v[32:35], v[232:235]
    ds_read_b64_tr_b16 v[62:63], v7 offset:6144
    v_mfma_f32_16x16x32_bf16 v[236:239], v[76:79], v[32:35], v[236:239]
RE12:
    s_waitcnt lgkmcnt(0)
    s_xor_b64 s[28:29], s[28:29], s[52:53]
    s_xor_b64 s[30:31], s[30:31], s[52:53]
    s_or_b64 s[28:29], s[28:29], s[30:31]
    s_cbranch_scc0 OK12
    s_sleep 1
    s_load_dwordx4 s[28:31], s[16:17], 16 glc
    s_sub_u32 s0, s0, 16
    s_cmp_lt_i32 s0, 0
    s_cbranch_scc0 RE12
    s_waitcnt lgkmcnt(0)
OK12:
    s_add_i32 s68, s68, 4096
    s_add_i32 s69, s69, 4096
    s_add_u32 s70, s56, s68
    s_waitcnt vmcnt(8)
    v_mfma_f32_16x16x32_bf16 v[252:255], v[76:79], v[36:39], v[252:255]
    buffer_load_dwordx4 v[32:35], v5, s[32:35], s70 offen sc1
    v_mfma_f32_16x16x32_bf16 v[248:251], v[72:75], v[36:39], v[248:251]
    v_mfma_f32_16x16x32_bf16 v[244:247], v[68:71], v[36:39], v[244:247]
    v_mfma_f32_16x16x32_bf16 v[240:243], v[64:67], v[36:39], v[240:243]
    s_waitcnt vmcnt(8)
    v_mfma_f32_16x16x32_bf16 v[192:195], v[48:51], v[40:43], v[192:195]
    buffer_load_dwordx4 v[36:39], v6, s[32:35], s70 offen sc1
    v_mfma_f32_16x16x32_bf16 v[196:199], v[52:55], v[40:43], v[196:199]
    ds_read_b64_tr_b16 v[64:65], v0 offset:8192
    v_mfma_f32_16x16x32_bf16 v[200:203], v[56:59], v[40:43], v[200:203]
    ds_read_b64_tr_b16 v[66:67], v0 offset:10240
    v_mfma_f32_16x16x32_bf16 v[204:207], v[60:63], v[40:43], v[204:207]
    ds_read_b64_tr_b16 v[68:69], v3 offset:8192
    s_add_u32 s70, s56, s69
    s_waitcnt vmcnt(8)
    v_mfma_f32_16x16x32_bf16 v[220:223], v[60:63], v[44:47], v[220:223]
    buffer_load_dwordx4 v[40:43], v5, s[32:35], s70 offen sc1
    v_mfma_f32_16x16x32_bf16 v[216:219], v[56:59], v[44:47], v[216:219]
    ds_read_b64_tr_b16 v[70:71], v3 offset:10240
    v_mfma_f32_16x16x32_bf16 v[212:215], v[52:55], v[44:47], v[212:215]
    ds_read_b64_tr_b16 v[72:73], v4 offset:8192
    v_mfma_f32_16x16x32_bf16 v[208:211], v[48:51], v[44:47], v[208:211]
    ds_read_b64_tr_b16 v[74:75], v4 offset:10240
    s_waitcnt vmcnt(8)
    v_mfma_f32_16x16x32_bf16 v[224:227], v[48:51], v[8:11], v[224:227]
    buffer_load_dwordx4 v[44:47], v6, s[32:35], s70 offen sc1
    v_mfma_f32_16x16x32_bf16 v[228:231], v[52:55], v[8:11], v[228:231]
    ds_read_b64_tr_b16 v[76:77], v7 offset:8192
    v_mfma_f32_16x16x32_bf16 v[232:235], v[56:59], v[8:11], v[232:235]
    ds_read_b64_tr_b16 v[78:79], v7 offset:10240
    v_mfma_f32_16x16x32_bf16 v[236:239], v[60:63], v[8:11], v[236:239]
    s_add_u32 m0, s15, 4096
    s_lshl4_add_u32 s55, s61, 0
    buffer_load_dwordx4 v1, s[36:39], s55 offen offset:0 lds
    buffer_load_dwordx4 v2, s[36:39], s55 offen offset:1024 lds
    s_add_u32 s70, s57, s68
    s_waitcnt vmcnt(10)
    v_mfma_f32_16x16x32_bf16 v[252:255], v[60:63], v[12:15], v[252:255]
    buffer_load_dwordx4 v[8:11], v5, s[32:35], s70 offen sc1
    v_mfma_f32_16x16x32_bf16 v[248:251], v[56:59], v[12:15], v[248:251]
    v_mfma_f32_16x16x32_bf16 v[244:247], v[52:55], v[12:15], v[244:247]
    v_mfma_f32_16x16x32_bf16 v[240:243], v[48:51], v[12:15], v[240:243]
    s_add_u32 m0, s15, 6144
    s_lshl4_add_u32 s55, s61, 16384
    buffer_load_dwordx4 v1, s[36:39], s55 offen offset:0 lds
    buffer_load_dwordx4 v2, s[36:39], s55 offen offset:1024 lds
    s_waitcnt vmcnt(12) lgkmcnt(6)
    v_mfma_f32_16x16x32_bf16 v[192:195], v[64:67], v[16:19], v[192:195]
    buffer_load_dwordx4 v[12:15], v6, s[32:35], s70 offen sc1
    s_waitcnt lgkmcnt(4)
    v_mfma_f32_16x16x32_bf16 v[196:199], v[68:71], v[16:19], v[196:199]
    ds_read_b64_tr_b16 v[48:49], v0 offset:12288
    s_waitcnt lgkmcnt(3)
    v_mfma_f32_16x16x32_bf16 v[200:203], v[72:75], v[16:19], v[200:203]
    ds_read_b64_tr_b16 v[50:51], v0 offset:14336
    s_waitcnt lgkmcnt(2)
    v_mfma_f32_16x16x32_bf16 v[204:207], v[76:79], v[16:19], v[204:207]
    ds_read_b64_tr_b16 v[52:53], v3 offset:12288
    s_add_u32 s70, s57, s69
    s_waitcnt vmcnt(12)
    v_mfma_f32_16x16x32_bf16 v[220:223], v[76:79], v[20:23], v[220:223]
    buffer_load_dwordx4 v[16:19], v5, s[32:35], s70 offen sc1
    v_mfma_f32_16x16x32_bf16 v[216:219], v[72:75], v[20:23], v[216:219]
    ds_read_b64_tr_b16 v[54:55], v3 offset:14336
    v_mfma_f32_16x16x32_bf16 v[212:215], v[68:71], v[20:23], v[212:215]
    ds_read_b64_tr_b16 v[56:57], v4 offset:12288
    v_mfma_f32_16x16x32_bf16 v[208:211], v[64:67], v[20:23], v[208:211]
    ds_read_b64_tr_b16 v[58:59], v4 offset:14336
    s_waitcnt vmcnt(12)
    v_mfma_f32_16x16x32_bf16 v[224:227], v[64:67], v[24:27], v[224:227]
    buffer_load_dwordx4 v[20:23], v6, s[32:35], s70 offen sc1
    v_mfma_f32_16x16x32_bf16 v[228:231], v[68:71], v[24:27], v[228:231]
    ds_read_b64_tr_b16 v[60:61], v7 offset:12288
    v_mfma_f32_16x16x32_bf16 v[232:235], v[72:75], v[24:27], v[232:235]
    ds_read_b64_tr_b16 v[62:63], v7 offset:14336
    v_mfma_f32_16x16x32_bf16 v[236:239], v[76:79], v[24:27], v[236:239]
    s_add_u32 m0, s15, 8192
    s_lshl4_add_u32 s55, s64, 0
    buffer_load_dwordx4 v1, s[40:43], s55 offen offset:0 lds
    buffer_load_dwordx4 v2, s[40:43], s55 offen offset:1024 lds
    s_add_u32 s70, s58, s68
    s_waitcnt vmcnt(14)
    v_mfma_f32_16x16x32_bf16 v[252:255], v[76:79], v[28:31], v[252:255]
    buffer_load_dwordx4 v[24:27], v5, s[32:35], s70 offen sc1
    s_load_dwordx4 s[28:31], s[16:17], 32 glc
    v_mfma_f32_16x16x32_bf16 v[248:251], v[72:75], v[28:31], v[248:251]
    v_mfma_f32_16x16x32_bf16 v[244:247], v[68:71], v[28:31], v[244:247]
    v_mfma_f32_16x16x32_bf16 v[240:243], v[64:67], v[28:31], v[240:243]
    s_add_u32 m0, s15, 10240
    s_lshl4_add_u32 s55, s64, 16384
    buffer_load_dwordx4 v1, s[40:43], s55 offen offset:0 lds
    buffer_load_dwordx4 v2, s[40:43], s55 offen offset:1024 lds
    s_waitcnt vmcnt(16) lgkmcnt(6)
    v_mfma_f32_16x16x32_bf16 v[192:195], v[48:51], v[32:35], v[192:195]
    buffer_load_dwordx4 v[28:31], v6, s[32:35], s70 offen sc1
    s_waitcnt lgkmcnt(4)
    v_mfma_f32_16x16x32_bf16 v[196:199], v[52:55], v[32:35], v[196:199]
    ds_read_b64_tr_b16 v[64:65], v0 offset:0
    s_waitcnt lgkmcnt(3)
    v_mfma_f32_16x16x32_bf16 v[200:203], v[56:59], v[32:35], v[200:203]
    ds_read_b64_tr_b16 v[66:67], v0 offset:2048
    s_waitcnt lgkmcnt(2)
    v_mfma_f32_16x16x32_bf16 v[204:207], v[60:63], v[32:35], v[204:207]
    ds_read_b64_tr_b16 v[68:69], v3 offset:0
    s_add_u32 s70, s58, s69
    s_waitcnt vmcnt(16)
    v_mfma_f32_16x16x32_bf16 v[220:223], v[60:63], v[36:39], v[220:223]
    buffer_load_dwordx4 v[32:35], v5, s[32:35], s70 offen sc1
    v_mfma_f32_16x16x32_bf16 v[216:219], v[56:59], v[36:39], v[216:219]
    ds_read_b64_tr_b16 v[70:71], v3 offset:2048
    v_mfma_f32_16x16x32_bf16 v[212:215], v[52:55], v[36:39], v[212:215]
    ds_read_b64_tr_b16 v[72:73], v4 offset:0
    v_mfma_f32_16x16x32_bf16 v[208:211], v[48:51], v[36:39], v[208:211]
    ds_read_b64_tr_b16 v[74:75], v4 offset:2048
    s_waitcnt vmcnt(16)
    v_mfma_f32_16x16x32_bf16 v[224:227], v[48:51], v[40:43], v[224:227]
    buffer_load_dwordx4 v[36:39], v6, s[32:35], s70 offen sc1
    v_mfma_f32_16x16x32_bf16 v[228:231], v[52:55], v[40:43], v[228:231]
    ds_read_b64_tr_b16 v[76:77], v7 offset:0
    v_mfma_f32_16x16x32_bf16 v[232:235], v[56:59], v[40:43], v[232:235]
    ds_read_b64_tr_b16 v[78:79], v7 offset:2048
    v_mfma_f32_16x16x32_bf16 v[236:239], v[60:63], v[40:43], v[236:239]
    s_add_u32 m0, s15, 12288
    s_lshl4_add_u32 s55, s65, 0
    buffer_load_dwordx4 v1, s[40:43], s55 offen offset:0 lds
    buffer_load_dwordx4 v2, s[40:43], s55 offen offset:1024 lds
    s_add_u32 s70, s59, s68
    s_waitcnt vmcnt(18)
    v_mfma_f32_16x16x32_bf16 v[252:255], v[60:63], v[44:47], v[252:255]
    buffer_load_dwordx4 v[40:43], v5, s[32:35], s70 offen sc1
    v_mfma_f32_16x16x32_bf16 v[248:251], v[56:59], v[44:47], v[248:251]
    v_mfma_f32_16x16x32_bf16 v[244:247], v[52:55], v[44:47], v[244:247]
    v_mfma_f32_16x16x32_bf16 v[240:243], v[48:51], v[44:47], v[240:243]
    s_add_u32 m0, s15, 14336
    s_lshl4_add_u32 s55, s65, 16384
    buffer_load_dwordx4 v1, s[40:43], s55 offen offset:0 lds
    buffer_load_dwordx4 v2, s[40:43], s55 offen offset:1024 lds
    s_waitcnt vmcnt(18) lgkmcnt(6)
    v_mfma_f32_16x16x32_bf16 v[192:195], v[64:67], v[8:11], v[192:195]
    buffer_load_dwordx4 v[44:47], v6, s[32:35], s70 offen sc1
    s_waitcnt lgkmcnt(4)
    v_mfma_f32_16x16x32_bf16 v[196:199], v[68:71], v[8:11], v[196:199]
    s_waitcnt lgkmcnt(2)
    v_mfma_f32_16x16x32_bf16 v[200:203], v[72:75], v[8:11], v[200:203]
    s_waitcnt lgkmcnt(0)
    v_mfma_f32_16x16x32_bf16 v[204:207], v[76:79], v[8:11], v[204:207]
    s_add_u32 s70, s59, s69
    s_waitcnt vmcnt(16)
    v_mfma_f32_16x16x32_bf16 v[220:223], v[76:79], v[12:15], v[220:223]
    buffer_load_dwordx4 v[8:11], v5, s[32:35], s70 offen sc1
    v_mfma_f32_16x16x32_bf16 v[216:219], v[72:75], v[12:15], v[216:219]
    v_mfma_f32_16x16x32_bf16 v[212:215], v[68:71], v[12:15], v[212:215]
    v_mfma_f32_16x16x32_bf16 v[208:211], v[64:67], v[12:15], v[208:211]
    s_waitcnt vmcnt(16)
    v_mfma_f32_16x16x32_bf16 v[224:227], v[64:67], v[16:19], v[224:227]
    buffer_load_dwordx4 v[12:15], v6, s[32:35], s70 offen sc1
    v_mfma_f32_16x16x32_bf16 v[228:231], v[68:71], v[16:19], v[228:231]
    v_mfma_f32_16x16x32_bf16 v[232:235], v[72:75], v[16:19], v[232:235]
    v_mfma_f32_16x16x32_bf16 v[236:239], v[76:79], v[16:19], v[236:239]
    s_add_u32 m0, s15, 0
    s_lshl4_add_u32 s55, s66, 0
    buffer_load_dwordx4 v1, s[40:43], s55 offen offset:0 lds
    buffer_load_dwordx4 v2, s[40:43], s55 offen offset:1024 lds
RE13:
    s_waitcnt lgkmcnt(0)
    s_xor_b64 s[28:29], s[28:29], s[52:53]
    s_xor_b64 s[30:31], s[30:31], s[52:53]
    s_or_b64 s[28:29], s[28:29], s[30:31]
    s_cbranch_scc0 OK13
    s_sleep 1
    s_load_dwordx4 s[28:31], s[16:17], 32 glc
    s_sub_u32 s0, s0, 16
    s_cmp_lt_i32 s0, 0
    s_cbranch_scc0 RE13
    s_waitcnt lgkmcnt(0)
OK13:
    s_add_i32 s68, s68, 4096
    s_add_i32 s69, s69, 4096
    s_add_u32 s70, s56, s68
    s_waitcnt vmcnt(18)
    v_mfma_f32_16x16x32_bf16 v[252:255], v[76:79], v[20:23], v[252:255]
    buffer_load_dwordx4 v[16:19], v5, s[32:35], s70 offen sc1
    v_mfma_f32_16x16x32_bf16 v[248:251], v[72:75], v[20:23], v[248:251]
    v_mfma_f32_16x16x32_bf16 v[244:247], v[68:71], v[20:23], v[244:247]
    v_mfma_f32_16x16x32_bf16 v[240:243], v[64:67], v[20:23], v[240:243]
    s_add_u32 m0, s15, 2048
    s_lshl4_add_u32 s55, s66, 16384
    buffer_load_dwordx4 v1, s[40:43], s55 offen offset:0 lds
    buffer_load_dwordx4 v2, s[40:43], s55 offen offset:1024 lds
    s_waitcnt vmcnt(18)
    v_mfma_f32_16x16x32_bf16 v[192:195], v[80:83], v[24:27], v[192:195]
    buffer_load_dwordx4 v[20:23], v6, s[32:35], s70 offen sc1
    v_mfma_f32_16x16x32_bf16 v[196:199], v[84:87], v[24:27], v[196:199]
    ds_read_b64_tr_b16 v[48:49], v0 offset:4096
    v_mfma_f32_16x16x32_bf16 v[200:203], v[88:91], v[24:27], v[200:203]
    ds_read_b64_tr_b16 v[50:51], v0 offset:6144
    v_mfma_f32_16x16x32_bf16 v[204:207], v[92:95], v[24:27], v[204:207]
    s_add_u32 s70, s56, s69
    s_waitcnt vmcnt(16)
    v_mfma_f32_16x16x32_bf16 v[220:223], v[92:95], v[28:31], v[220:223]
    buffer_load_dwordx4 v[24:27], v5, s[32:35], s70 offen sc1
    v_mfma_f32_16x16x32_bf16 v[216:219], v[88:91], v[28:31], v[216:219]
    ds_read_b64_tr_b16 v[52:53], v3 offset:4096
    v_mfma_f32_16x16x32_bf16 v[212:215], v[84:87], v[28:31], v[212:215]
    v_mfma_f32_16x16x32_bf16 v[208:211], v[80:83], v[28:31], v[208:211]
    s_waitcnt vmcnt(16)
    v_mfma_f32_16x16x32_bf16 v[224:227], v[80:83], v[32:35], v[224:227]
    buffer_load_dwordx4 v[28:31], v6, s[32:35], s70 offen sc1
    v_mfma_f32_16x16x32_bf16 v[228:231], v[84:87], v[32:35], v[228:231]
    ds_read_b64_tr_b16 v[54:55], v3 offset:6144
    v_mfma_f32_16x16x32_bf16 v[232:235], v[88:91], v[32:35], v[232:235]
    v_mfma_f32_16x16x32_bf16 v[236:239], v[92:95], v[32:35], v[236:239]
    s_add_u32 s70, s57, s68
    s_waitcnt vmcnt(16)
    v_mfma_f32_16x16x32_bf16 v[252:255], v[92:95], v[36:39], v[252:255]
    buffer_load_dwordx4 v[32:35], v5, s[32:35], s70 offen sc1
    v_mfma_f32_16x16x32_bf16 v[248:251], v[88:91], v[36:39], v[248:251]
    ds_read_b64_tr_b16 v[56:57], v4 offset:4096
    v_mfma_f32_16x16x32_bf16 v[244:247], v[84:87], v[36:39], v[244:247]
    ds_read_b64_tr_b16 v[58:59], v4 offset:6144
    v_mfma_f32_16x16x32_bf16 v[240:243], v[80:83], v[36:39], v[240:243]
    s_waitcnt vmcnt(14)
    v_mfma_f32_16x16x32_bf16 v[192:195], v[96:99], v[40:43], v[192:195]
    buffer_load_dwordx4 v[36:39], v6, s[32:35], s70 offen sc1
    v_mfma_f32_16x16x32_bf16 v[196:199], v[100:103], v[40:43], v[196:199]
    ds_read_b64_tr_b16 v[60:61], v7 offset:4096
    v_mfma_f32_16x16x32_bf16 v[200:203], v[104:107], v[40:43], v[200:203]
    v_mbcnt_lo_u32_b32 v85, -1, 0
    v_mbcnt_hi_u32_b32 v85, -1, v85
    v_mfma_f32_16x16x32_bf16 v[204:207], v[108:111], v[40:43], v[204:207]
    s_add_u32 s70, s57, s69
    s_waitcnt vmcnt(12)
    v_mfma_f32_16x16x32_bf16 v[220:223], v[108:111], v[44:47], v[220:223]
    buffer_load_dwordx4 v[40:43], v5, s[32:35], s70 offen sc1
    v_mfma_f32_16x16x32_bf16 v[216:219], v[104:107], v[44:47], v[216:219]
    ds_read_b64_tr_b16 v[62:63], v7 offset:6144
    v_mfma_f32_16x16x32_bf16 v[212:215], v[100:103], v[44:47], v[212:215]
    v_and_b32 v84, 15, v85
    v_lshlrev_b32_e64 v84, 10, v84
    v_mfma_f32_16x16x32_bf16 v[208:211], v[96:99], v[44:47], v[208:211]
    s_waitcnt vmcnt(12)
    v_mfma_f32_16x16x32_bf16 v[224:227], v[96:99], v[8:11], v[224:227]
    buffer_load_dwordx4 v[44:47], v6, s[32:35], s70 offen sc1
    v_mfma_f32_16x16x32_bf16 v[228:231], v[100:103], v[8:11], v[228:231]
    ds_read_b64_tr_b16 v[64:65], v0 offset:8192
    v_mfma_f32_16x16x32_bf16 v[232:235], v[104:107], v[8:11], v[232:235]
    ds_read_b64_tr_b16 v[66:67], v0 offset:10240
    v_mfma_f32_16x16x32_bf16 v[236:239], v[108:111], v[8:11], v[236:239]
    s_add_u32 s70, s58, s68
    s_waitcnt vmcnt(12)
    v_mfma_f32_16x16x32_bf16 v[252:255], v[108:111], v[12:15], v[252:255]
    buffer_load_dwordx4 v[8:11], v5, s[32:35], s70 offen sc1
    s_load_dwordx4 s[28:31], s[16:17], 48 glc
    v_mfma_f32_16x16x32_bf16 v[248:251], v[104:107], v[12:15], v[248:251]
    ds_read_b64_tr_b16 v[68:69], v3 offset:8192
    v_mfma_f32_16x16x32_bf16 v[244:247], v[100:103], v[12:15], v[244:247]
    v_bfe_u32 v86, v85, 4, 1
    v_lshl_add_u32 v84, v86, 5, v84
    v_mfma_f32_16x16x32_bf16 v[240:243], v[96:99], v[12:15], v[240:243]
    s_waitcnt vmcnt(10)
    v_mfma_f32_16x16x32_bf16 v[192:195], v[112:115], v[16:19], v[192:195]
    buffer_load_dwordx4 v[12:15], v6, s[32:35], s70 offen sc1
    v_mfma_f32_16x16x32_bf16 v[196:199], v[116:119], v[16:19], v[196:199]
    ds_read_b64_tr_b16 v[70:71], v3 offset:10240
    v_mfma_f32_16x16x32_bf16 v[200:203], v[120:123], v[16:19], v[200:203]
    v_lshrrev_b32_e64 v86, 5, v85
    v_lshl_add_u32 v84, v86, 4, v84
    v_mfma_f32_16x16x32_bf16 v[204:207], v[124:127], v[16:19], v[204:207]
    s_add_u32 s70, s58, s69
    s_waitcnt vmcnt(8)
    v_mfma_f32_16x16x32_bf16 v[220:223], v[124:127], v[20:23], v[220:223]
    buffer_load_dwordx4 v[16:19], v5, s[32:35], s70 offen sc1
    v_mfma_f32_16x16x32_bf16 v[216:219], v[120:123], v[20:23], v[216:219]
    ds_read_b64_tr_b16 v[72:73], v4 offset:8192
    v_mfma_f32_16x16x32_bf16 v[212:215], v[116:119], v[20:23], v[212:215]
    ds_read_b64_tr_b16 v[74:75], v4 offset:10240
    v_mfma_f32_16x16x32_bf16 v[208:211], v[112:115], v[20:23], v[208:211]
    s_waitcnt vmcnt(8)
    v_mfma_f32_16x16x32_bf16 v[224:227], v[112:115], v[24:27], v[224:227]
    buffer_load_dwordx4 v[20:23], v6, s[32:35], s70 offen sc1
    v_mfma_f32_16x16x32_bf16 v[228:231], v[116:119], v[24:27], v[228:231]
    ds_read_b64_tr_b16 v[76:77], v7 offset:8192
    v_mfma_f32_16x16x32_bf16 v[232:235], v[120:123], v[24:27], v[232:235]
    v_lshlrev_b32 v85, 4, v85
    v_add_u32_e64 v86, s15, v85
    v_mfma_f32_16x16x32_bf16 v[236:239], v[124:127], v[24:27], v[236:239]
    s_add_u32 s70, s59, s68
    s_waitcnt vmcnt(8)
    v_mfma_f32_16x16x32_bf16 v[252:255], v[124:127], v[28:31], v[252:255]
    buffer_load_dwordx4 v[24:27], v5, s[32:35], s70 offen sc1
    v_mfma_f32_16x16x32_bf16 v[248:251], v[120:123], v[28:31], v[248:251]
    ds_read_b64_tr_b16 v[78:79], v7 offset:10240
    v_mfma_f32_16x16x32_bf16 v[244:247], v[116:119], v[28:31], v[244:247]
    s_sub_u32 s54, s14, s15
    s_add_u32 s54, s54, 81920
    v_mfma_f32_16x16x32_bf16 v[240:243], v[112:115], v[28:31], v[240:243]
    s_waitcnt vmcnt(8)
    v_mfma_f32_16x16x32_bf16 v[192:195], v[128:131], v[32:35], v[192:195]
    buffer_load_dwordx4 v[28:31], v6, s[32:35], s70 offen sc1
    v_mfma_f32_16x16x32_bf16 v[196:199], v[132:135], v[32:35], v[196:199]
    ds_read_b64_tr_b16 v[112:113], v0 offset:12288
    v_mfma_f32_16x16x32_bf16 v[200:203], v[136:139], v[32:35], v[200:203]
    ds_read_b64_tr_b16 v[114:115], v0 offset:14336
    v_mfma_f32_16x16x32_bf16 v[204:207], v[140:143], v[32:35], v[204:207]
    s_add_u32 s70, s59, s69
    s_waitcnt vmcnt(8)
    v_mfma_f32_16x16x32_bf16 v[220:223], v[140:143], v[36:39], v[220:223]
    buffer_load_dwordx4 v[32:35], v5, s[32:35], s70 offen sc1
    v_mfma_f32_16x16x32_bf16 v[216:219], v[136:139], v[36:39], v[216:219]
    ds_read_b64_tr_b16 v[116:117], v3 offset:12288
    v_mfma_f32_16x16x32_bf16 v[212:215], v[132:135], v[36:39], v[212:215]
    v_add_u32 v80, s54, v0
    v_add_u32 v81, s54, v3
    v_mfma_f32_16x16x32_bf16 v[208:211], v[128:131], v[36:39], v[208:211]
    s_waitcnt vmcnt(8)
    v_mfma_f32_16x16x32_bf16 v[224:227], v[128:131], v[40:43], v[224:227]
    buffer_load_dwordx4 v[36:39], v6, s[32:35], s70 offen sc1
    v_mfma_f32_16x16x32_bf16 v[228:231], v[132:135], v[40:43], v[228:231]
    ds_read_b64_tr_b16 v[118:119], v3 offset:14336
    v_mfma_f32_16x16x32_bf16 v[232:235], v[136:139], v[40:43], v[232:235]
    v_add_u32 v82, s54, v4
    v_add_u32_e64 v83, s54, v7
    v_mfma_f32_16x16x32_bf16 v[236:239], v[140:143], v[40:43], v[236:239]
RE14:
    s_waitcnt lgkmcnt(0)
    s_xor_b64 s[28:29], s[28:29], s[52:53]
    s_xor_b64 s[30:31], s[30:31], s[52:53]
    s_or_b64 s[28:29], s[28:29], s[30:31]
    s_cbranch_scc0 OK14
    s_sleep 1
    s_load_dwordx4 s[28:31], s[16:17], 48 glc
    s_sub_u32 s0, s0, 16
    s_cmp_lt_i32 s0, 0
    s_cbranch_scc0 RE14
    s_waitcnt lgkmcnt(0)
OK14:
    s_add_i32 s68, s68, -8192
    s_add_i32 s69, s69, -8192
    s_add_u32 s70, s60, s68
    s_waitcnt vmcnt(8)
    v_mfma_f32_16x16x32_bf16 v[252:255], v[140:143], v[44:47], v[252:255]
    buffer_load_dwordx4 v[40:43], v5, s[32:35], s70 offen sc1
    s_load_dwordx4 s[28:31], s[16:17], 64 glc
    v_mfma_f32_16x16x32_bf16 v[248:251], v[136:139], v[44:47], v[248:251]
    ds_read_b64_tr_b16 v[120:121], v4 offset:12288
    v_mfma_f32_16x16x32_bf16 v[244:247], v[132:135], v[44:47], v[244:247]
    ds_read_b64_tr_b16 v[122:123], v4 offset:14336
    v_mfma_f32_16x16x32_bf16 v[240:243], v[128:131], v[44:47], v[240:243]
    s_waitcnt vmcnt(8)
    v_mfma_f32_16x16x32_bf16 v[192:195], v[144:147], v[8:11], v[192:195]
    buffer_load_dwordx4 v[44:47], v6, s[32:35], s70 offen sc1
    v_mfma_f32_16x16x32_bf16 v[196:199], v[148:151], v[8:11], v[196:199]
    ds_read_b64_tr_b16 v[124:125], v7 offset:12288
    v_mfma_f32_16x16x32_bf16 v[200:203], v[152:155], v[8:11], v[200:203]
    v_mfma_f32_16x16x32_bf16 v[204:207], v[156:159], v[8:11], v[204:207]
    s_add_u32 s70, s60, s69
    s_waitcnt vmcnt(8)
    v_mfma_f32_16x16x32_bf16 v[220:223], v[156:159], v[12:15], v[220:223]
    buffer_load_dwordx4 v[8:11], v5, s[32:35], s70 offen sc1
    v_mfma_f32_16x16x32_bf16 v[216:219], v[152:155], v[12:15], v[216:219]
    ds_read_b64_tr_b16 v[126:127], v7 offset:14336
    v_mfma_f32_16x16x32_bf16 v[212:215], v[148:151], v[12:15], v[212:215]
    v_mfma_f32_16x16x32_bf16 v[208:211], v[144:147], v[12:15], v[208:211]
    s_waitcnt vmcnt(8)
    v_mfma_f32_16x16x32_bf16 v[224:227], v[144:147], v[16:19], v[224:227]
    buffer_load_dwordx4 v[12:15], v6, s[32:35], s70 offen sc1
    v_mfma_f32_16x16x32_bf16 v[228:231], v[148:151], v[16:19], v[228:231]
    ds_read_b64_tr_b16 v[128:129], v0 offset:0
    v_mfma_f32_16x16x32_bf16 v[232:235], v[152:155], v[16:19], v[232:235]
    ds_read_b64_tr_b16 v[130:131], v0 offset:2048
    v_mfma_f32_16x16x32_bf16 v[236:239], v[156:159], v[16:19], v[236:239]
    s_add_u32 s70, s61, s68
    s_waitcnt vmcnt(8)
    v_mfma_f32_16x16x32_bf16 v[252:255], v[156:159], v[20:23], v[252:255]
    buffer_load_dwordx4 v[16:19], v5, s[32:35], s70 offen sc1
    v_mfma_f32_16x16x32_bf16 v[248:251], v[152:155], v[20:23], v[248:251]
    ds_read_b64_tr_b16 v[132:133], v3 offset:0
    v_mfma_f32_16x16x32_bf16 v[244:247], v[148:151], v[20:23], v[244:247]
    v_mfma_f32_16x16x32_bf16 v[240:243], v[144:147], v[20:23], v[240:243]
    s_waitcnt vmcnt(8)
    v_mfma_f32_16x16x32_bf16 v[192:195], v[160:163], v[24:27], v[192:195]
    buffer_load_dwordx4 v[20:23], v6, s[32:35], s70 offen sc1
    v_mfma_f32_16x16x32_bf16 v[196:199], v[164:167], v[24:27], v[196:199]
    ds_read_b64_tr_b16 v[134:135], v3 offset:2048
    v_mfma_f32_16x16x32_bf16 v[200:203], v[168:171], v[24:27], v[200:203]
    v_mfma_f32_16x16x32_bf16 v[204:207], v[172:175], v[24:27], v[204:207]
    buffer_load_dwordx4 v[88:91], v84, s[24:27], s50 offen
    buffer_load_dwordx4 v[92:95], v84, s[24:27], s50 offen offset:64
    s_add_u32 s70, s61, s69
    s_waitcnt vmcnt(10)
    v_mfma_f32_16x16x32_bf16 v[220:223], v[172:175], v[28:31], v[220:223]
    buffer_load_dwordx4 v[24:27], v5, s[32:35], s70 offen sc1
    v_mfma_f32_16x16x32_bf16 v[216:219], v[168:171], v[28:31], v[216:219]
    ds_read_b64_tr_b16 v[136:137], v4 offset:0
    v_mfma_f32_16x16x32_bf16 v[212:215], v[164:167], v[28:31], v[212:215]
    ds_read_b64_tr_b16 v[138:139], v4 offset:2048
    v_mfma_f32_16x16x32_bf16 v[208:211], v[160:163], v[28:31], v[208:211]
    s_waitcnt vmcnt(10)
    v_mfma_f32_16x16x32_bf16 v[224:227], v[160:163], v[32:35], v[224:227]
    buffer_load_dwordx4 v[28:31], v6, s[32:35], s70 offen sc1
    v_mfma_f32_16x16x32_bf16 v[228:231], v[164:167], v[32:35], v[228:231]
    ds_read_b64_tr_b16 v[140:141], v7 offset:0
    v_mfma_f32_16x16x32_bf16 v[232:235], v[168:171], v[32:35], v[232:235]
    v_mfma_f32_16x16x32_bf16 v[236:239], v[172:175], v[32:35], v[236:239]
RE15:
    s_waitcnt lgkmcnt(0)
    s_xor_b64 s[28:29], s[28:29], s[52:53]
    s_xor_b64 s[30:31], s[30:31], s[52:53]
    s_or_b64 s[28:29], s[28:29], s[30:31]
    s_cbranch_scc0 OK15
    s_sleep 1
    s_load_dwordx4 s[28:31], s[16:17], 64 glc
    s_sub_u32 s0, s0, 16
    s_cmp_lt_i32 s0, 0
    s_cbranch_scc0 RE15
    s_waitcnt lgkmcnt(0)
OK15:
    s_add_i32 s68, s68, 114688
    s_add_i32 s69, s69, 114688
    s_add_u32 s70, s64, s69
    s_waitcnt vmcnt(10)
    v_mfma_f32_16x16x32_bf16 v[252:255], v[172:175], v[36:39], v[252:255]
    buffer_load_dwordx4 v[32:35], v6, s[32:35], s70 offen sc1
    v_mfma_f32_16x16x32_bf16 v[248:251], v[168:171], v[36:39], v[248:251]
    ds_read_b64_tr_b16 v[142:143], v7 offset:2048
    v_mfma_f32_16x16x32_bf16 v[244:247], v[164:167], v[36:39], v[244:247]
    v_mfma_f32_16x16x32_bf16 v[240:243], v[160:163], v[36:39], v[240:243]
    s_add_u32 s70, s65, s69
    s_waitcnt vmcnt(10)
    v_mfma_f32_16x16x32_bf16 v[192:195], v[176:179], v[40:43], v[192:195]
    buffer_load_dwordx4 v[36:39], v6, s[32:35], s70 offen sc1
    v_mfma_f32_16x16x32_bf16 v[196:199], v[180:183], v[40:43], v[196:199]
    ds_read_b64_tr_b16 v[144:145], v80 offset:0
    v_mfma_f32_16x16x32_bf16 v[200:203], v[184:187], v[40:43], v[200:203]
    ds_read_b64_tr_b16 v[146:147], v80 offset:2048
    v_mfma_f32_16x16x32_bf16 v[204:207], v[188:191], v[40:43], v[204:207]
    s_add_u32 s70, s66, s69
    s_waitcnt vmcnt(10)
    v_mfma_f32_16x16x32_bf16 v[220:223], v[188:191], v[44:47], v[220:223]
    buffer_load_dwordx4 v[40:43], v6, s[32:35], s70 offen sc1
    v_mfma_f32_16x16x32_bf16 v[216:219], v[184:187], v[44:47], v[216:219]
    ds_read_b64_tr_b16 v[148:149], v81 offset:0
    v_mfma_f32_16x16x32_bf16 v[212:215], v[180:183], v[44:47], v[212:215]
    v_mfma_f32_16x16x32_bf16 v[208:211], v[176:179], v[44:47], v[208:211]
    s_add_u32 s70, s67, s69
    s_waitcnt vmcnt(10)
    v_mfma_f32_16x16x32_bf16 v[224:227], v[176:179], v[8:11], v[224:227]
    buffer_load_dwordx4 v[44:47], v6, s[32:35], s70 offen sc1
    v_mfma_f32_16x16x32_bf16 v[228:231], v[180:183], v[8:11], v[228:231]
    ds_read_b64_tr_b16 v[150:151], v81 offset:2048
    v_mfma_f32_16x16x32_bf16 v[232:235], v[184:187], v[8:11], v[232:235]
    v_mfma_f32_16x16x32_bf16 v[236:239], v[188:191], v[8:11], v[236:239]
    s_add_u32 s70, s64, s69
    s_waitcnt vmcnt(10)
    v_mfma_f32_16x16x32_bf16 v[252:255], v[188:191], v[12:15], v[252:255]
    buffer_load_dwordx4 v[8:11], v5, s[32:35], s70 offen sc1
    v_mfma_f32_16x16x32_bf16 v[248:251], v[184:187], v[12:15], v[248:251]
    ds_read_b64_tr_b16 v[152:153], v82 offset:0
    v_mfma_f32_16x16x32_bf16 v[244:247], v[180:183], v[12:15], v[244:247]
    ds_read_b64_tr_b16 v[154:155], v82 offset:2048
    v_mfma_f32_16x16x32_bf16 v[240:243], v[176:179], v[12:15], v[240:243]
    s_add_u32 s70, s65, s69
    s_waitcnt vmcnt(10)
    v_mfma_f32_16x16x32_bf16 v[192:195], v[48:51], v[16:19], v[192:195]
    buffer_load_dwordx4 v[12:15], v5, s[32:35], s70 offen sc1
    v_mfma_f32_16x16x32_bf16 v[196:199], v[52:55], v[16:19], v[196:199]
    ds_read_b64_tr_b16 v[156:157], v83 offset:0
    v_mfma_f32_16x16x32_bf16 v[200:203], v[56:59], v[16:19], v[200:203]
    v_mfma_f32_16x16x32_bf16 v[204:207], v[60:63], v[16:19], v[204:207]
    s_add_u32 s70, s66, s69
    s_waitcnt vmcnt(10)
    v_mfma_f32_16x16x32_bf16 v[220:223], v[60:63], v[20:23], v[220:223]
    buffer_load_dwordx4 v[16:19], v5, s[32:35], s70 offen sc1
    v_mfma_f32_16x16x32_bf16 v[216:219], v[56:59], v[20:23], v[216:219]
    ds_read_b64_tr_b16 v[158:159], v83 offset:2048
    v_mfma_f32_16x16x32_bf16 v[212:215], v[52:55], v[20:23], v[212:215]
    v_mfma_f32_16x16x32_bf16 v[208:211], v[48:51], v[20:23], v[208:211]
    s_add_u32 s70, s67, s69
    s_waitcnt vmcnt(8)
    v_mfma_f32_16x16x32_bf16 v[224:227], v[48:51], v[24:27], v[224:227]
    buffer_load_dwordx4 v[20:23], v5, s[32:35], s70 offen sc1
    v_mfma_f32_16x16x32_bf16 v[228:231], v[52:55], v[24:27], v[228:231]
    v_mfma_f32_16x16x32_bf16 v[232:235], v[56:59], v[24:27], v[232:235]
    v_mfma_f32_16x16x32_bf16 v[236:239], v[60:63], v[24:27], v[236:239]
    s_add_u32 s70, s64, s68
    s_waitcnt vmcnt(8)
    v_mfma_f32_16x16x32_bf16 v[252:255], v[60:63], v[28:31], v[252:255]
    buffer_load_dwordx4 v[24:27], v6, s[32:35], s70 offen sc1
    v_mfma_f32_16x16x32_bf16 v[248:251], v[56:59], v[28:31], v[248:251]
    v_mfma_f32_16x16x32_bf16 v[244:247], v[52:55], v[28:31], v[244:247]
    v_mfma_f32_16x16x32_bf16 v[240:243], v[48:51], v[28:31], v[240:243]
    s_add_u32 s70, s65, s68
    s_waitcnt vmcnt(8)
    v_mfma_f32_16x16x32_bf16 v[240:243], v[64:67], v[32:35], v[240:243]
    buffer_load_dwordx4 v[28:31], v6, s[32:35], s70 offen sc1
    v_mfma_f32_16x16x32_bf16 v[244:247], v[68:71], v[32:35], v[244:247]
    v_mfma_f32_16x16x32_bf16 v[248:251], v[72:75], v[32:35], v[248:251]
    s_mov_b32 s54, 0xbf317218
    s_mov_b32 s55, 0xffff0000
    v_mfma_f32_16x16x32_bf16 v[252:255], v[76:79], v[32:35], v[252:255]
    s_add_u32 s70, s66, s68
    s_waitcnt vmcnt(8)
    v_mfma_f32_16x16x32_bf16 v[252:255], v[124:127], v[36:39], v[252:255]
    buffer_load_dwordx4 v[32:35], v6, s[32:35], s70 offen sc1
    v_mfma_f32_16x16x32_bf16 v[248:251], v[120:123], v[36:39], v[248:251]
    v_mfma_f32_16x16x32_bf16 v[244:247], v[116:119], v[36:39], v[244:247]
    s_xor_b32 s1, s3, 1
    s_lshl_b32 s1, s1, 14
    v_add_u32_e64 v161, s1, v85
    v_mfma_f32_16x16x32_bf16 v[240:243], v[112:115], v[36:39], v[240:243]
    s_add_u32 s70, s67, s68
    s_waitcnt vmcnt(8)
    v_mfma_f32_16x16x32_bf16 v[240:243], v[128:131], v[40:43], v[240:243]
    buffer_load_dwordx4 v[36:39], v6, s[32:35], s70 offen sc1
    v_mfma_f32_16x16x32_bf16 v[244:247], v[132:135], v[40:43], v[244:247]
    v_mfma_f32_16x16x32_bf16 v[248:251], v[136:139], v[40:43], v[248:251]
    s_xor_b32 s1, s3, 2
    s_lshl_b32 s1, s1, 14
    v_add_u32 v162, s1, v85
    s_waitcnt lgkmcnt(8)
    v_mfma_f32_16x16x32_bf16 v[252:255], v[140:143], v[40:43], v[252:255]
    s_add_u32 s70, s64, s68
    s_waitcnt vmcnt(8) lgkmcnt(0)
    v_mfma_f32_16x16x32_bf16 v[252:255], v[156:159], v[44:47], v[252:255]
    buffer_load_dwordx4 v[40:43], v5, s[32:35], s70 offen sc1
    v_mfma_f32_16x16x32_bf16 v[248:251], v[152:155], v[44:47], v[248:251]
    v_mfma_f32_16x16x32_bf16 v[244:247], v[148:151], v[44:47], v[244:247]
    s_xor_b32 s1, s3, 3
    s_lshl_b32 s1, s1, 14
    v_add_u32_e64 v163, s1, v85
    v_mfma_f32_16x16x32_bf16 v[240:243], v[144:147], v[44:47], v[240:243]
    s_add_u32 s70, s65, s68
    s_waitcnt vmcnt(8)
    v_mfma_f32_16x16x32_bf16 v[224:227], v[64:67], v[8:11], v[224:227]
    buffer_load_dwordx4 v[44:47], v5, s[32:35], s70 offen sc1
    v_mfma_f32_16x16x32_bf16 v[228:231], v[68:71], v[8:11], v[228:231]
    v_mfma_f32_16x16x32_bf16 v[232:235], v[72:75], v[8:11], v[232:235]
    ds_write_b128 v86, v[252:255] offset:11264
    v_mfma_f32_16x16x32_bf16 v[236:239], v[76:79], v[8:11], v[236:239]
    ds_write_b128 v86, v[248:251] offset:10240
    s_add_u32 s70, s66, s68
    s_waitcnt vmcnt(8)
    v_mfma_f32_16x16x32_bf16 v[236:239], v[124:127], v[12:15], v[236:239]
    buffer_load_dwordx4 v[8:11], v5, s[32:35], s70 offen sc1
    v_mfma_f32_16x16x32_bf16 v[232:235], v[120:123], v[12:15], v[232:235]
    v_mfma_f32_16x16x32_bf16 v[228:231], v[116:119], v[12:15], v[228:231]
    ds_write_b128 v86, v[244:247] offset:9216
    v_mfma_f32_16x16x32_bf16 v[224:227], v[112:115], v[12:15], v[224:227]
    ds_write_b128 v86, v[240:243] offset:8192
    s_add_u32 s70, s67, s68
    s_waitcnt vmcnt(8)
    v_mfma_f32_16x16x32_bf16 v[224:227], v[128:131], v[16:19], v[224:227]
    buffer_load_dwordx4 v[12:15], v5, s[32:35], s70 offen sc1
    v_mfma_f32_16x16x32_bf16 v[228:231], v[132:135], v[16:19], v[228:231]
    v_permlane16_swap_b32 v88, v90
    v_permlane16_swap_b32 v89, v91
    v_mfma_f32_16x16x32_bf16 v[232:235], v[136:139], v[16:19], v[232:235]
    v_mfma_f32_16x16x32_bf16 v[236:239], v[140:143], v[16:19], v[236:239]
    v_permlane16_swap_b32 v92, v94
    v_permlane16_swap_b32 v93, v95
    s_waitcnt vmcnt(8)
    v_mfma_f32_16x16x32_bf16 v[236:239], v[156:159], v[20:23], v[236:239]
    v_mfma_f32_16x16x32_bf16 v[232:235], v[152:155], v[20:23], v[232:235]
    v_lshlrev_b32 v96, 16, v88
    v_and_b32_e64 v97, s55, v88
    v_mfma_f32_16x16x32_bf16 v[228:231], v[148:151], v[20:23], v[228:231]
    v_lshlrev_b32 v98, 16, v89
    v_and_b32 v99, s55, v89
    v_mfma_f32_16x16x32_bf16 v[224:227], v[144:147], v[20:23], v[224:227]
    v_lshlrev_b32_e64 v100, 16, v90
    v_and_b32 v101, s55, v90
    s_waitcnt vmcnt(7)
    v_mfma_f32_16x16x32_bf16 v[208:211], v[64:67], v[24:27], v[208:211]
    v_mfma_f32_16x16x32_bf16 v[212:215], v[68:71], v[24:27], v[212:215]
    v_mfma_f32_16x16x32_bf16 v[216:219], v[72:75], v[24:27], v[216:219]
    ds_write_b128 v86, v[236:239] offset:7168
    v_mfma_f32_16x16x32_bf16 v[220:223], v[76:79], v[24:27], v[220:223]
    ds_write_b128 v86, v[232:235] offset:6144
    s_waitcnt vmcnt(6)
    v_mfma_f32_16x16x32_bf16 v[220:223], v[124:127], v[28:31], v[220:223]
    v_mfma_f32_16x16x32_bf16 v[216:219], v[120:123], v[28:31], v[216:219]
    v_mfma_f32_16x16x32_bf16 v[212:215], v[116:119], v[28:31], v[212:215]
    ds_write_b128 v86, v[228:231] offset:5120
    v_mfma_f32_16x16x32_bf16 v[208:211], v[112:115], v[28:31], v[208:211]
    ds_write_b128 v86, v[224:227] offset:4096
    s_waitcnt vmcnt(5)
    v_mfma_f32_16x16x32_bf16 v[208:211], v[128:131], v[32:35], v[208:211]
    v_mfma_f32_16x16x32_bf16 v[212:215], v[132:135], v[32:35], v[212:215]
    v_lshlrev_b32 v102, 16, v91
    v_and_b32 v103, s55, v91
    v_mfma_f32_16x16x32_bf16 v[216:219], v[136:139], v[32:35], v[216:219]
    v_lshlrev_b32 v104, 16, v92
    v_and_b32 v105, s55, v92
    v_mfma_f32_16x16x32_bf16 v[220:223], v[140:143], v[32:35], v[220:223]
    v_lshlrev_b32_e64 v106, 16, v93
    v_and_b32 v107, s55, v93
    s_waitcnt vmcnt(4)
    v_mfma_f32_16x16x32_bf16 v[220:223], v[156:159], v[36:39], v[220:223]
    v_mfma_f32_16x16x32_bf16 v[216:219], v[152:155], v[36:39], v[216:219]
    v_lshlrev_b32 v108, 16, v94
    v_and_b32 v109, s55, v94
    v_mfma_f32_16x16x32_bf16 v[212:215], v[148:151], v[36:39], v[212:215]
    v_lshlrev_b32 v110, 16, v95
    v_and_b32 v111, s55, v95
    v_mfma_f32_16x16x32_bf16 v[208:211], v[144:147], v[36:39], v[208:211]
    s_waitcnt vmcnt(3)
    v_mfma_f32_16x16x32_bf16 v[192:195], v[64:67], v[40:43], v[192:195]
    v_mfma_f32_16x16x32_bf16 v[196:199], v[68:71], v[40:43], v[196:199]
    v_mfma_f32_16x16x32_bf16 v[200:203], v[72:75], v[40:43], v[200:203]
    ds_write_b128 v86, v[220:223] offset:3072
    v_mfma_f32_16x16x32_bf16 v[204:207], v[76:79], v[40:43], v[204:207]
    ds_write_b128 v86, v[216:219] offset:2048
    s_waitcnt vmcnt(2)
    v_mfma_f32_16x16x32_bf16 v[204:207], v[124:127], v[44:47], v[204:207]
    v_mfma_f32_16x16x32_bf16 v[200:203], v[120:123], v[44:47], v[200:203]
    v_mfma_f32_16x16x32_bf16 v[196:199], v[116:119], v[44:47], v[196:199]
    ds_write_b128 v86, v[212:215] offset:1024
    v_mfma_f32_16x16x32_bf16 v[192:195], v[112:115], v[44:47], v[192:195]
    ds_write_b128 v86, v[208:211] offset:0
    s_waitcnt vmcnt(1)
    v_mfma_f32_16x16x32_bf16 v[192:195], v[128:131], v[8:11], v[192:195]
    v_mfma_f32_16x16x32_bf16 v[196:199], v[132:135], v[8:11], v[196:199]
    v_mfma_f32_16x16x32_bf16 v[200:203], v[136:139], v[8:11], v[200:203]
    v_mfma_f32_16x16x32_bf16 v[204:207], v[140:143], v[8:11], v[204:207]
    s_waitcnt lgkmcnt(0)
    s_barrier
    ds_read_b128 v[208:211], v161 offset:0
    ds_read_b128 v[224:227], v162 offset:4096
    ds_read_b128 v[240:243], v163 offset:8192
    ds_read_b128 v[212:215], v161 offset:1024
    ds_read_b128 v[228:231], v162 offset:5120
    ds_read_b128 v[244:247], v163 offset:9216
    ds_read_b128 v[216:219], v161 offset:2048
    ds_read_b128 v[232:235], v162 offset:6144
    ds_read_b128 v[248:251], v163 offset:10240
    ds_read_b128 v[220:223], v161 offset:3072
    ds_read_b128 v[236:239], v162 offset:7168
    ds_read_b128 v[252:255], v163 offset:11264
    s_waitcnt vmcnt(0)
    v_mfma_f32_16x16x32_bf16 v[204:207], v[156:159], v[12:15], v[204:207]
    v_mfma_f32_16x16x32_bf16 v[200:203], v[152:155], v[12:15], v[200:203]
    v_mfma_f32_16x16x32_bf16 v[196:199], v[148:151], v[12:15], v[196:199]
    v_mfma_f32_16x16x32_bf16 v[192:195], v[144:147], v[12:15], v[192:195]
    s_waitcnt lgkmcnt(11)
    v_fmac_f32 v96, s54, v208
    v_fmac_f32 v97, s54, v209
    v_fmac_f32 v98, s54, v210
    v_fmac_f32 v99, s54, v211
    s_waitcnt lgkmcnt(10)
    v_fmac_f32 v96, s54, v224
    v_fmac_f32 v97, s54, v225
    v_fmac_f32 v98, s54, v226
    v_fmac_f32 v99, s54, v227
    s_waitcnt lgkmcnt(9)
    v_fmac_f32 v96, s54, v240
    v_fmac_f32 v97, s54, v241
    v_fmac_f32 v98, s54, v242
    v_fmac_f32 v99, s54, v243
    v_fmac_f32 v96, s54, v192
    v_fmac_f32 v97, s54, v193
    v_fmac_f32 v98, s54, v194
    v_fmac_f32 v99, s54, v195
    s_waitcnt lgkmcnt(8)
    v_fmac_f32 v100, s54, v212
    v_fmac_f32 v101, s54, v213
    v_fmac_f32 v102, s54, v214
    v_fmac_f32 v103, s54, v215
    s_waitcnt lgkmcnt(7)
    v_fmac_f32 v100, s54, v228
    v_fmac_f32 v101, s54, v229
    v_fmac_f32 v102, s54, v230
    v_fmac_f32 v103, s54, v231
    s_waitcnt lgkmcnt(6)
    v_fmac_f32 v100, s54, v244
    v_fmac_f32 v101, s54, v245
    v_fmac_f32 v102, s54, v246
    v_fmac_f32 v103, s54, v247
    v_fmac_f32 v100, s54, v196
    v_fmac_f32 v101, s54, v197
    v_fmac_f32 v102, s54, v198
    v_fmac_f32 v103, s54, v199
    v_cvt_pk_bf16_f32 v88, v96, v97
    v_cvt_pk_bf16_f32 v89, v98, v99
    v_cvt_pk_bf16_f32 v90, v100, v101
    v_cvt_pk_bf16_f32 v91, v102, v103
    s_nop 0
    v_permlane16_swap_b32 v88, v90
    v_permlane16_swap_b32 v89, v91
    buffer_store_dwordx4 v[88:91], v84, s[44:47], s50 offen offset:0
    s_waitcnt lgkmcnt(5)
    v_fmac_f32 v104, s54, v216
    v_fmac_f32 v105, s54, v217
    v_fmac_f32 v106, s54, v218
    v_fmac_f32 v107, s54, v219
    s_waitcnt lgkmcnt(4)
    v_fmac_f32 v104, s54, v232
    v_fmac_f32 v105, s54, v233
    v_fmac_f32 v106, s54, v234
    v_fmac_f32 v107, s54, v235
    s_waitcnt lgkmcnt(3)
    v_fmac_f32 v104, s54, v248
    v_fmac_f32 v105, s54, v249
    v_fmac_f32 v106, s54, v250
    v_fmac_f32 v107, s54, v251
    v_fmac_f32 v104, s54, v200
    v_fmac_f32 v105, s54, v201
    v_fmac_f32 v106, s54, v202
    v_fmac_f32 v107, s54, v203
    s_waitcnt lgkmcnt(2)
    v_fmac_f32 v108, s54, v220
    v_fmac_f32 v109, s54, v221
    v_fmac_f32 v110, s54, v222
    v_fmac_f32 v111, s54, v223
    s_waitcnt lgkmcnt(1)
    v_fmac_f32 v108, s54, v236
    v_fmac_f32 v109, s54, v237
    v_fmac_f32 v110, s54, v238
    v_fmac_f32 v111, s54, v239
    s_waitcnt lgkmcnt(0)
    v_fmac_f32 v108, s54, v252
    v_fmac_f32 v109, s54, v253
    v_fmac_f32 v110, s54, v254
    v_fmac_f32 v111, s54, v255
    v_fmac_f32 v108, s54, v204
    v_fmac_f32 v109, s54, v205
    v_fmac_f32 v110, s54, v206
    v_fmac_f32_e64 v111, s54, v207
    v_cvt_pk_bf16_f32 v92, v104, v105
    v_cvt_pk_bf16_f32 v93, v106, v107
    v_cvt_pk_bf16_f32 v94, v108, v109
    v_cvt_pk_bf16_f32 v95, v110, v111
    s_nop 0
    v_permlane16_swap_b32 v92, v94
    v_permlane16_swap_b32 v93, v95
    buffer_store_dwordx4 v[92:95], v84, s[44:47], s50 offen offset:64
    s_endpgm
K_END:
    s_endpgm
K_LAST:
.set CODE_BYTES, K_LAST-parallel_sum__linear_attn_block__dense_activation_silu__prompt_kernel
.section .rodata,"a"
.p2align 6
.amdhsa_kernel parallel_sum__linear_attn_block__dense_activation_silu__prompt_kernel
  .amdhsa_next_free_vgpr 256
  .amdhsa_next_free_sgpr 102
  .amdhsa_accum_offset 256
  .amdhsa_group_segment_fixed_size 0
  .amdhsa_kernarg_size 72
  .amdhsa_user_sgpr_count 2
  .amdhsa_user_sgpr_kernarg_segment_ptr 1
  .amdhsa_system_sgpr_workgroup_id_x 1
.end_amdhsa_kernel
```
